```python
import torch

def _softmax(x, axis=-1):
    return torch.softmax(x, dim=axis)
def _gelu(x):
    return torch.nn.functional.gelu(x, approximate="tanh")
def _silu(x):
    return torch.nn.functional.silu(x)
def _sigmoid(x):
    return torch.sigmoid(x)
def _layernorm(x, axis=-1, eps=1e-5):
    m = x.mean(dim=axis, keepdim=True)
    v = x.var(dim=axis, keepdim=True, unbiased=False)
    return (x - m) / torch.sqrt(v + eps)
def _scatter_add(tgt, idx, src, axis=0):
    return tgt.clone().index_add_(axis, idx, src)
def _segment_sum(src, seg, n):
    out = torch.zeros((n,) + src.shape[1:], dtype=src.dtype)
    return out.index_add_(0, seg, src)
def _pad(x, pw):
    flat = tuple(v for pair in reversed(pw) for v in pair)
    return torch.nn.functional.pad(x, flat)

kernel_name = 'gated_mix__linear_attn_block__mixer_token_mlp__prompt'

def setup_inputs():

    _w = (lambda a: (lambda t: t.to(torch.bfloat16) if t.is_floating_point() else t)(torch.as_tensor(a)))
    def _A_setup():
        B, S, D = 1, 2048, 512
        return {
            "x": _w((lambda *s: torch.randn(*s, dtype=torch.bfloat16) * 0.05)(B, S, D)),
            "wqkv": _w((lambda *s: torch.randn(*s, dtype=torch.bfloat16) * 0.4)(D, 3 * D)),
            "wo": _w((lambda *s: torch.randn(*s, dtype=torch.bfloat16) * 0.05)(D, D)),
        }
    _A_in = _A_setup()

    def _B_setup():
        B, S, D, F = 1, 2048, 512, 1792
        return {
            "x": _w((lambda *s: torch.randn(*s, dtype=torch.bfloat16) * 0.05)(B, S, D)),
            "w1": _w((lambda *s: torch.randn(*s, dtype=torch.bfloat16) * 0.4)(S, F) * (S ** -0.5)),
            "b1": _w((lambda *s: torch.randn(*s, dtype=torch.bfloat16) * 3.2)(F) * 0.02),
            "w2": _w((lambda *s: torch.randn(*s, dtype=torch.bfloat16) * 0.05)(F, S) * (F ** -0.5)),
            "b2": _w((lambda *s: torch.randn(*s, dtype=torch.bfloat16) * 0.1)(S) * 0.02),
        }
    _B_in = _B_setup()

    return {
        "A_x": _A_in["x"],
        "A_wqkv": _A_in["wqkv"],
        "A_wo": _A_in["wo"],
        "B_x": _B_in["x"],
        "B_w1": _B_in["w1"],
        "B_b1": _B_in["b1"],
        "B_w2": _B_in["w2"],
        "B_b2": _B_in["b2"],
        "gate_w": _w((lambda *s: torch.randn(*s, dtype=torch.bfloat16) * 0.05)(512) * 16.0),
    }

def reference(A_x, A_wqkv, A_wo, B_x, B_w1, B_b1, B_w2, B_b2, gate_w):
    def _A_ref(x, wqkv, wo):
        B, S, D = x.shape
        H = 32; Dh = D // H
        qkv = (lambda x, *d: x.permute(*d))((x @ wqkv).reshape(B, S, 3, H, Dh), 2, 0, 3, 1, 4)
        q, k, v = qkv[0], qkv[1], qkv[2]
        phi = lambda t: torch.where(t > 0, t + 1, torch.exp(t)) + 1e-6
        pq, pk = phi(q), phi(k)
        kv = torch.einsum("bhsd,bhse->bhde", pk, v)
        z = torch.einsum("bhsd->bhd", pk)
        num = torch.einsum("bhqd,bhde->bhqe", pq, kv)
        den = torch.einsum("bhqd,bhd->bhq", pq, z)[..., None] + 1e-6
        o = num / den
        return (lambda x, *d: x.permute(*d))(o, 0, 2, 1, 3).reshape(B, S, D) @ wo

    def _B_ref(x, w1, b1, w2, b2):
        B, S, D = x.shape
        h = _layernorm(x, axis=-1)
        u = torch.einsum("bsd,sf->bdf", h, w1) + b1
        u = _gelu(u)
        y = torch.einsum("bdf,fs->bds", u, w2) + b2
        return (lambda x, *d: x.permute(*d))(y, 0, 2, 1)

    x = A_x
    g = _sigmoid((x * gate_w).sum(-1, keepdims=True))
    a = _A_ref(x, A_wqkv, A_wo)
    b = _B_ref(x, B_w1, B_b1, B_w2, B_b2)
    return g * a + (1 - g) * b
```

```asm
; @launch grid=(256,1,1) block=(384,1,1) lds=161856
.amdgcn_target "amdgcn-amd-amdhsa--gfx950"
.text
.globl gated_mix__linear_attn_block__mixer_token_mlp__prompt_kernel
.p2align 8
.type gated_mix__linear_attn_block__mixer_token_mlp__prompt_kernel,@function
gated_mix__linear_attn_block__mixer_token_mlp__prompt_kernel:
    s_cmp_ge_u32 s2, 256
    s_cbranch_scc0 k_go
    s_endpgm
k_go:
    s_load_dwordx16 s[16:31], s[0:1], 0
    s_load_dwordx8 s[32:39], s[0:1], 64
    v_lshrrev_b32 v2, 6, v0
    v_and_b32 v1, 63, v0
    s_getpc_b64 s[60:61]
k_pc:
    s_lshl_b32 s3, s2, 10
    s_and_b32 s3, s3, 0xe000
    v_lshlrev_b32 v3, 7, v1
    v_lshl_add_u32 v3, v2, 11, v3
    v_add_u32 v3, s3, v3
    v_min_u32 v3, k_end-k_pc-4, v3
    s_mov_b64 exec, 0xffff
    global_load_dword v3, v3, s[60:61]
    s_mov_b64 exec, -1
    v_readfirstlane_b32 s3, v2
    s_and_b32 s4, s2, 7
    s_lshr_b32 s5, s2, 3
    s_and_b32 s9, s5, 3
    s_lshr_b32 s10, s5, 2
    s_lshr_b32 s11, s4, 1
    s_lshl_b32 s6, s11, 3
    s_add_u32 s6, s6, s10
    s_mul_i32 s8, s11, 7
    s_add_u32 s8, s8, s10
    s_and_b32 s11, s4, 1
    s_lshl_b32 s7, s11, 2
    s_add_u32 s7, s7, s9
    s_cmp_ge_u32 s3, 4
    s_cbranch_scc1 ld_entry
    s_lshl_b32 s13, s6, 6
    s_lshl_b32 s14, s7, 3
    s_add_u32 s13, s13, s14
    s_lshl_b32 s14, s3, 1
    s_add_u32 s13, s13, s14
    s_lshl_b32 s14, s13, 10
    v_lshlrev_b32 v4, 4, v1
    s_waitcnt lgkmcnt(0)
    s_mov_b32 s44, s16
    s_mov_b32 s45, s17
    s_mov_b32 s46, 0x200000
    s_mov_b32 s47, 0x20000
    s_mov_b32 s48, s32
    s_mov_b32 s49, s33
    s_mov_b32 s50, 0x400
    s_mov_b32 s51, 0x20000
    buffer_load_dwordx4 v[200:203], v4, s[44:47], s14 offen
    buffer_load_dwordx4 v[204:207], v4, s[44:47], s14 offen offset:1024
    buffer_load_dwordx4 v[208:211], v4, s[48:51], 0 offen
    s_branch c_main
ld_entry:
    v_lshrrev_b32 v23, 3, v1
    v_bfe_u32 v2, v1, 4, 1
    v_lshlrev_b32 v2, 2, v2
    v_xor_b32 v2, v1, v2
    v_and_b32 v2, 7, v2
    v_lshlrev_b32 v22, 4, v2
    v_mul_u32_u24 v4, 3072, v23
    v_add_u32 v4, v4, v22
    v_add_u32 v5, 23552, v4
    v_add_u32 v6, 47104, v4
    v_add_u32 v7, 70656, v4
    v_xor_b32 v5, 32, v5
    v_xor_b32 v7, 32, v7
    s_add_u32 s60, s9, s10
    s_and_b32 s62, s4, 2
    s_lshl_b32 s62, s62, 1
    s_lshl_b32 s65, s7, 7
    s_waitcnt lgkmcnt(0)
    s_mov_b32 s44, s18
    s_mov_b32 s45, s19
    s_mov_b32 s46, 0x180000
    s_mov_b32 s47, 0x20000
    s_cmp_eq_u32 s3, 5
    s_cbranch_scc1 fl_entry
    s_add_u32 s68, s60, 0
    s_and_b32 s68, s68, 3
    s_or_b32 s68, s68, s62
    s_mul_i32 s68, s68, 196608
    s_add_u32 s68, s68, s65
    s_mov_b32 m0, 0
    s_add_u32 s69, s68, 98304
    buffer_load_dwordx4 v4, s[44:47], s68 offen offset:0 lds
    buffer_load_dwordx4 v5, s[44:47], s68 offen offset:1024 lds
    buffer_load_dwordx4 v6, s[44:47], s68 offen offset:2048 lds
    buffer_load_dwordx4 v7, s[44:47], s68 offen offset:3072 lds
    s_mov_b32 m0, 4096
    s_nop 0
    buffer_load_dwordx4 v4, s[44:47], s69 offen offset:0 lds
    buffer_load_dwordx4 v5, s[44:47], s69 offen offset:1024 lds
    buffer_load_dwordx4 v6, s[44:47], s69 offen offset:2048 lds
    buffer_load_dwordx4 v7, s[44:47], s69 offen offset:3072 lds
    s_add_u32 s68, s68, 1024
    s_mov_b32 m0, 8192
    s_add_u32 s69, s68, 98304
    buffer_load_dwordx4 v4, s[44:47], s68 offen offset:0 lds
    buffer_load_dwordx4 v5, s[44:47], s68 offen offset:1024 lds
    buffer_load_dwordx4 v6, s[44:47], s68 offen offset:2048 lds
    buffer_load_dwordx4 v7, s[44:47], s68 offen offset:3072 lds
    s_mov_b32 m0, 12288
    s_nop 0
    buffer_load_dwordx4 v4, s[44:47], s69 offen offset:0 lds
    buffer_load_dwordx4 v5, s[44:47], s69 offen offset:1024 lds
    buffer_load_dwordx4 v6, s[44:47], s69 offen offset:2048 lds
    buffer_load_dwordx4 v7, s[44:47], s69 offen offset:3072 lds
    s_branch tl_main
c_main:
    s_and_b32 s11, s3, 1
    s_lshr_b32 s12, s3, 1
    s_mov_b32 s40, s38
    s_mov_b32 s41, s39
    s_mov_b32 s42, 0x2000000
    s_mov_b32 s43, 0x20000
    s_mov_b32 s52, s26
    s_mov_b32 s53, s27
    s_mov_b32 s54, 0xe00
    s_mov_b32 s55, 0x20000
    s_mov_b32 s56, s30
    s_mov_b32 s57, s31
    s_mov_b32 s58, 0x1000
    s_mov_b32 s59, 0x20000
    s_mov_b32 s64, s34
    s_mov_b32 s65, s35
    s_mov_b32 s66, 0x200000
    s_mov_b32 s67, 0x20000
    v_lshrrev_b32 v2, 4, v1
    v_lshlrev_b32 v2, 3, v2
    s_lshl_b32 s15, s11, 6
    s_lshl_b32 s68, s8, 7
    s_add_u32 s15, s15, s68
    buffer_load_dwordx2 v[132:133], v2, s[52:55], s15 offen offset:0
    buffer_load_dwordx2 v[134:135], v2, s[52:55], s15 offen offset:32
    v_and_b32 v2, 15, v1
    s_lshl_b32 s15, s6, 6
    s_lshl_b32 s68, s12, 5
    s_add_u32 s15, s15, s68
    v_add_u32 v5, s15, v2
    v_lshlrev_b32 v2, 1, v5
    buffer_load_ushort v6, v2, s[56:59], 0 offen
    buffer_load_ushort v8, v2, s[56:59], 0 offen offset:32
    v_lshrrev_b32 v7, 3, v1
    v_lshlrev_b32 v7, 18, v7
    s_lshl_b32 s15, s11, 2
    s_lshl_b32 s68, s12, 1
    s_or_b32 s15, s15, s68
    v_xor_b32 v198, s15, v1
    v_and_b32 v198, 7, v198
    v_lshl_add_u32 v7, v198, 4, v7
    s_lshl_b32 s62, s13, 7
    s_add_u32 s62, s62, 0x10000
    s_lshl_b32 s63, s13, 3
    s_add_u32 s63, s63, 0x650000
    v_mov_b32 v198, 0
    s_mov_b32 s15, 0x3f803f80
    v_mov_b32 v228, 0
    v_mov_b32 v229, 0
    v_mov_b32 v230, 0
    v_mov_b32 v231, 0
    s_waitcnt vmcnt(4)
    v_dot2_f32_bf16 v228, v200, s15, v228
    v_dot2_f32_bf16 v229, v204, s15, v229
    v_dot2_f32_bf16 v230, v200, v208, v230
    v_dot2_f32_bf16 v231, v204, v208, v231
    v_dot2_f32_bf16 v228, v201, s15, v228
    v_dot2_f32_bf16 v229, v205, s15, v229
    v_dot2_f32_bf16 v230, v201, v209, v230
    v_dot2_f32_bf16 v231, v205, v209, v231
    v_dot2_f32_bf16 v228, v202, s15, v228
    v_dot2_f32_bf16 v229, v206, s15, v229
    v_dot2_f32_bf16 v230, v202, v210, v230
    v_dot2_f32_bf16 v231, v206, v210, v231
    v_dot2_f32_bf16 v228, v203, s15, v228
    v_dot2_f32_bf16 v229, v207, s15, v229
    v_dot2_f32_bf16 v230, v203, v211, v230
    v_dot2_f32_bf16 v231, v207, v211, v231
    v_lshlrev_b32 v212, 16, v200
    v_and_b32 v213, 0xffff0000, v200
    v_lshlrev_b32 v214, 16, v201
    v_and_b32 v215, 0xffff0000, v201
    v_lshlrev_b32 v216, 16, v202
    v_and_b32 v217, 0xffff0000, v202
    v_lshlrev_b32 v218, 16, v203
    v_and_b32 v219, 0xffff0000, v203
    v_lshlrev_b32 v220, 16, v204
    v_and_b32 v221, 0xffff0000, v204
    v_lshlrev_b32 v222, 16, v205
    v_and_b32 v223, 0xffff0000, v205
    v_lshlrev_b32 v224, 16, v206
    v_and_b32 v225, 0xffff0000, v206
    v_lshlrev_b32 v226, 16, v207
    v_and_b32 v227, 0xffff0000, v207
    v_add_f32_dpp v228, v228, v228 row_shr:1 row_mask:0xf bank_mask:0xf
    v_add_f32_dpp v229, v229, v229 row_shr:1 row_mask:0xf bank_mask:0xf
    v_add_f32_dpp v230, v230, v230 row_shr:1 row_mask:0xf bank_mask:0xf
    v_add_f32_dpp v231, v231, v231 row_shr:1 row_mask:0xf bank_mask:0xf
    v_add_f32_dpp v228, v228, v228 row_shr:2 row_mask:0xf bank_mask:0xf
    v_add_f32_dpp v229, v229, v229 row_shr:2 row_mask:0xf bank_mask:0xf
    v_add_f32_dpp v230, v230, v230 row_shr:2 row_mask:0xf bank_mask:0xf
    v_add_f32_dpp v231, v231, v231 row_shr:2 row_mask:0xf bank_mask:0xf
    v_add_f32_dpp v228, v228, v228 row_shr:4 row_mask:0xf bank_mask:0xf
    v_add_f32_dpp v229, v229, v229 row_shr:4 row_mask:0xf bank_mask:0xf
    v_add_f32_dpp v230, v230, v230 row_shr:4 row_mask:0xf bank_mask:0xf
    v_add_f32_dpp v231, v231, v231 row_shr:4 row_mask:0xf bank_mask:0xf
    v_add_f32_dpp v228, v228, v228 row_shr:8 row_mask:0xf bank_mask:0xf
    v_add_f32_dpp v229, v229, v229 row_shr:8 row_mask:0xf bank_mask:0xf
    v_add_f32_dpp v230, v230, v230 row_shr:8 row_mask:0xf bank_mask:0xf
    v_add_f32_dpp v231, v231, v231 row_shr:8 row_mask:0xf bank_mask:0xf
    v_add_f32_dpp v228, v228, v228 row_bcast:15 row_mask:0xa bank_mask:0xf
    v_add_f32_dpp v229, v229, v229 row_bcast:15 row_mask:0xa bank_mask:0xf
    v_add_f32_dpp v230, v230, v230 row_bcast:15 row_mask:0xa bank_mask:0xf
    v_add_f32_dpp v231, v231, v231 row_bcast:15 row_mask:0xa bank_mask:0xf
    v_add_f32_dpp v228, v228, v228 row_bcast:31 row_mask:0xc bank_mask:0xf
    v_add_f32_dpp v229, v229, v229 row_bcast:31 row_mask:0xc bank_mask:0xf
    v_add_f32_dpp v230, v230, v230 row_bcast:31 row_mask:0xc bank_mask:0xf
    v_add_f32_dpp v231, v231, v231 row_bcast:31 row_mask:0xc bank_mask:0xf
    v_mul_f32 v228, 0x3b000000, v228
    v_mul_f32 v229, 0x3b000000, v229
    v_mul_f32 v230, 0xbfb8aa3b, v230
    v_mul_f32 v231, 0xbfb8aa3b, v231
    v_readlane_b32 s68, v228, 63
    v_readlane_b32 s69, v229, 63
    v_exp_f32 v230, v230
    v_exp_f32 v231, v231
    v_subrev_f32 v212, s68, v212
    v_subrev_f32 v213, s68, v213
    v_subrev_f32 v214, s68, v214
    v_subrev_f32 v215, s68, v215
    v_subrev_f32 v216, s68, v216
    v_subrev_f32 v217, s68, v217
    v_subrev_f32 v218, s68, v218
    v_subrev_f32 v219, s68, v219
    v_subrev_f32 v220, s69, v220
    v_subrev_f32 v221, s69, v221
    v_subrev_f32 v222, s69, v222
    v_subrev_f32 v223, s69, v223
    v_subrev_f32 v224, s69, v224
    v_subrev_f32 v225, s69, v225
    v_subrev_f32 v226, s69, v226
    v_subrev_f32 v227, s69, v227
    v_add_f32 v230, 1.0, v230
    v_add_f32 v231, 1.0, v231
    v_mul_f32 v228, v212, v212
    v_mul_f32 v229, v220, v220
    v_fmac_f32 v228, v213, v213
    v_fmac_f32 v229, v221, v221
    v_fmac_f32 v228, v214, v214
    v_fmac_f32 v229, v222, v222
    v_fmac_f32 v228, v215, v215
    v_fmac_f32 v229, v223, v223
    v_fmac_f32 v228, v216, v216
    v_fmac_f32 v229, v224, v224
    v_fmac_f32 v228, v217, v217
    v_fmac_f32 v229, v225, v225
    v_fmac_f32 v228, v218, v218
    v_fmac_f32 v229, v226, v226
    v_fmac_f32 v228, v219, v219
    v_fmac_f32 v229, v227, v227
    v_rcp_f32 v232, v230
    v_rcp_f32 v234, v231
    v_add_f32_dpp v228, v228, v228 row_shr:1 row_mask:0xf bank_mask:0xf
    v_add_f32_dpp v229, v229, v229 row_shr:1 row_mask:0xf bank_mask:0xf
    s_nop 0
    v_add_f32_dpp v228, v228, v228 row_shr:2 row_mask:0xf bank_mask:0xf
    v_add_f32_dpp v229, v229, v229 row_shr:2 row_mask:0xf bank_mask:0xf
    s_nop 0
    v_add_f32_dpp v228, v228, v228 row_shr:4 row_mask:0xf bank_mask:0xf
    v_add_f32_dpp v229, v229, v229 row_shr:4 row_mask:0xf bank_mask:0xf
    s_nop 0
    v_add_f32_dpp v228, v228, v228 row_shr:8 row_mask:0xf bank_mask:0xf
    v_add_f32_dpp v229, v229, v229 row_shr:8 row_mask:0xf bank_mask:0xf
    s_nop 0
    v_add_f32_dpp v228, v228, v228 row_bcast:15 row_mask:0xa bank_mask:0xf
    v_add_f32_dpp v229, v229, v229 row_bcast:15 row_mask:0xa bank_mask:0xf
    s_nop 0
    v_add_f32_dpp v228, v228, v228 row_bcast:31 row_mask:0xc bank_mask:0xf
    v_add_f32_dpp v229, v229, v229 row_bcast:31 row_mask:0xc bank_mask:0xf
    v_sub_f32 v233, 1.0, v232
    v_sub_f32 v235, 1.0, v234
    v_mov_b32 v230, 0x3727c5ac
    v_fmac_f32 v230, 0x3b000000, v228
    v_mov_b32 v231, 0x3727c5ac
    v_fmac_f32 v231, 0x3b000000, v229
    v_rsq_f32 v230, v230
    v_rsq_f32 v231, v231
    s_nop 0
    v_readlane_b32 s68, v230, 63
    v_readlane_b32 s69, v231, 63
    s_nop 0
    v_mul_f32 v212, s68, v212
    v_mul_f32 v213, s68, v213
    v_mul_f32 v214, s68, v214
    v_mul_f32 v215, s68, v215
    v_mul_f32 v216, s68, v216
    v_mul_f32 v217, s68, v217
    v_mul_f32 v218, s68, v218
    v_mul_f32 v219, s68, v219
    v_cvt_pk_bf16_f32 v200, v212, v213
    v_cvt_pk_bf16_f32 v201, v214, v215
    v_cvt_pk_bf16_f32 v202, v216, v217
    v_cvt_pk_bf16_f32 v203, v218, v219
    buffer_store_dwordx4 v[200:203], v7, s[40:43], s62 offen sc1
    v_mul_f32 v220, s69, v220
    v_mul_f32 v221, s69, v221
    v_mul_f32 v222, s69, v222
    v_mul_f32 v223, s69, v223
    v_mul_f32 v224, s69, v224
    v_mul_f32 v225, s69, v225
    v_mul_f32 v226, s69, v226
    v_mul_f32 v227, s69, v227
    v_cvt_pk_bf16_f32 v204, v220, v221
    v_cvt_pk_bf16_f32 v205, v222, v223
    v_cvt_pk_bf16_f32 v206, v224, v225
    v_cvt_pk_bf16_f32 v207, v226, v227
    buffer_store_dwordx4 v[204:207], v7, s[40:43], s62 offen offset:128 sc1
    s_mov_b32 exec_lo, 0
    s_mov_b32 exec_hi, 0x80000000
    buffer_store_dwordx4 v[232:235], v198, s[40:43], s63 offen sc1
    s_mov_b64 exec, -1
    v_mov_b32 v20, 0
    v_mov_b32 v21, 0
    v_mov_b32 v22, 0
    v_mov_b32 v23, 0
    s_lshl_b32 s68, s5, 2
    s_add_u32 s68, s68, s3
    s_cmp_lg_u32 s68, 127
    s_cbranch_scc1 c_nozero
    s_mul_i32 s68, s4, 4352
    s_add_u32 s68, s68, 0x620000
    buffer_store_dwordx4 v[20:23], v4, s[40:43], s68 offen offset:0 sc1
    buffer_store_dwordx4 v[20:23], v4, s[40:43], s68 offen offset:1024 sc1
    buffer_store_dwordx4 v[20:23], v4, s[40:43], s68 offen offset:2048 sc1
    buffer_store_dwordx4 v[20:23], v4, s[40:43], s68 offen offset:3072 sc1
    s_add_u32 s68, s68, 4096
    s_mov_b64 exec, 0xffff
    buffer_store_dwordx4 v[20:23], v4, s[40:43], s68 offen sc1
    s_mov_b64 exec, 0x3f
    v_lshlrev_b32 v2, 8, v1
    s_mul_i32 s68, s4, 1536
    s_add_u32 s68, s68, 0x660000
    buffer_store_dword v20, v2, s[40:43], s68 offen sc1
    s_mov_b64 exec, -1
c_nozero:
    v_lshrrev_b32 v2, 2, v1
    v_lshlrev_b32 v2, 7, v2
    v_and_b32 v220, 3, v1
    v_lshl_add_u32 v2, v220, 3, v2
    v_bfe_u32 v220, v1, 3, 1
    v_lshl_add_u32 v2, v220, 6, v2
    v_bfe_u32 v220, v1, 4, 1
    v_lshl_add_u32 v2, v220, 5, v2
    s_lshl_b32 s15, s11, 6
    v_xor_b32 v221, s15, v2
    v_add_u32 v10, 0x0, v221
    v_add_u32 v11, 0x10000, v221
    v_xor_b32 v221, 32, v221
    v_add_u32 v12, 0x0, v221
    v_add_u32 v13, 0x10000, v221
    s_lshl_b32 s15, s12, 6
    v_xor_b32 v221, s15, v2
    v_add_u32 v14, 0x0, v221
    v_add_u32 v15, 0x10000, v221
    v_add_u32 v16, 0x20000, v221
    v_xor_b32 v221, 32, v221
    v_add_u32 v17, 0x0, v221
    v_add_u32 v18, 0x10000, v221
    v_add_u32 v19, 0x20000, v221
    v_lshrrev_b32 v220, 4, v1
    v_lshl_add_u32 v2, v220, 9, v2
    s_lshl_b32 s15, s12, 6
    v_xor_b32 v221, s15, v2
    v_add_u32 v236, 0x0, v221
    v_add_u32 v237, 0x10000, v221
    v_add_u32 v238, 0x20000, v221
    v_xor_b32 v221, 32, v221
    v_add_u32 v239, 0x0, v221
    v_add_u32 v240, 0x10000, v221
    v_add_u32 v241, 0x20000, v221
    s_lshl_b32 s15, s12, 11
    v_add_u32 v221, s15, v4
    v_add_u32 v242, 0x10000, v221
    v_add_u32 v243, 0x20000, v221
    s_lshl_b32 s15, s11, 11
    v_add_u32 v221, s15, v4
    v_add_u32 v244, 0x10000, v221
    v_add_u32 v245, 0x20000, v221
    v_bfe_u32 v9, v1, 4, 1
    v_lshlrev_b32 v9, 10, v9
    v_lshrrev_b32 v220, 5, v1
    v_lshl_add_u32 v9, v220, 8, v9
    v_and_b32 v220, 15, v1
    v_lshl_add_u32 v9, v220, 4, v9
    v_and_b32 v2, 15, v1
    s_lshl_b32 s15, s11, 5
    v_add_u32 v2, s15, v2
    v_bfe_u32 v220, v2, 1, 3
    v_lshlrev_b32 v2, 7, v2
    v_lshrrev_b32 v221, 4, v1
    v_xor_b32 v220, v220, v221
    v_xor_b32 v221, 0, v220
    v_lshl_add_u32 v221, v221, 4, v2
    v_add_u32 v246, 0x10000, v221
    v_add_u32 v247, 0x20000, v221
    v_xor_b32 v221, 4, v220
    v_lshl_add_u32 v221, v221, 4, v2
    v_add_u32 v248, 0x10000, v221
    v_add_u32 v249, 0x20000, v221
    v_mov_b32 v2, 161792
    ds_write_b128 v2, v[20:23]
    s_waitcnt vmcnt(3)
    v_lshlrev_b32 v196, 16, v132
    v_and_b32 v197, 0xffff0000, v132
    v_lshlrev_b32 v198, 16, v133
    v_and_b32 v199, 0xffff0000, v133
    v_lshlrev_b32 v200, 16, v134
    v_and_b32 v201, 0xffff0000, v134
    v_lshlrev_b32 v202, 16, v135
    v_and_b32 v203, 0xffff0000, v135
    v_lshlrev_b32 v204, 16, v132
    v_and_b32 v205, 0xffff0000, v132
    v_lshlrev_b32 v206, 16, v133
    v_and_b32 v207, 0xffff0000, v133
    v_lshlrev_b32 v208, 16, v134
    v_and_b32 v209, 0xffff0000, v134
    v_lshlrev_b32 v210, 16, v135
    v_and_b32 v211, 0xffff0000, v135
    v_lshlrev_b32 v6, 16, v6
    v_lshlrev_b32 v8, 16, v8
    s_mov_b32 s68, 0x3fb8aa3b
    s_mov_b32 s69, 0x358637bd
    v_bfe_u32 v2, v1, 4, 1
    v_cmp_ne_u32 vcc, 0, v2
    v_mul_u32_u24 v2, 1088, v2
    v_and_b32 v220, 15, v1
    v_lshl_add_u32 v2, v220, 2, v2
    v_lshlrev_b32 v221, 2, v220
    v_lshrrev_b32 v220, 4, v1
    v_lshl_add_u32 v221, v220, 8, v221
    s_lshl_b32 s70, s7, 2
    s_lshl_b32 s71, s12, 1
    s_add_u32 s70, s70, s71
    s_mul_i32 s71, s70, 1088
    s_add_u32 s71, s71, 0x620000
    s_mul_i32 s73, s12, 3072
    s_add_u32 s73, s73, 155648
    v_add_u32 v7, s73, v4
    v_mov_b32 v232, 0x3f803f80
    v_mov_b32 v233, 0x3f803f80
    v_mov_b32 v234, 0x3f803f80
    v_mov_b32 v235, 0x3f803f80
    v_and_b32 v222, 15, v1
    v_lshlrev_b32 v222, 6, v222
    v_lshl_add_u32 v222, v220, 4, v222
    s_mul_i32 s73, s12, 2176
    s_add_u32 s73, s73, 155648
    v_add_u32 v223, s73, v222
    v_lshlrev_b32 v9, 4, v220
    v_add_u32 v250, s73, v9
    s_lshl_b32 s72, s6, 16
    s_lshl_b32 s73, s70, 11
    s_add_u32 s72, s72, s73
    s_lshl_b32 s73, s11, 11
    s_add_u32 s72, s72, s73
    s_add_u32 s72, s72, 0x410000
    s_lshl_b32 s62, s2, 14
    s_lshl_b32 s63, s3, 12
    s_add_u32 s62, s62, s63
    s_xor_b32 s63, s62, 0x4000
    s_add_u32 s62, s62, 0x800000
    s_add_u32 s63, s63, 0x800000
    s_waitcnt lgkmcnt(0)
    s_barrier
    ds_read_b128 v[68:71], v247 offset:16384
    ds_read_b128 v[72:75], v247 offset:18432
    ds_read_b64_tr_b16 v[84:85], v236 offset:8192
    ds_read_b64_tr_b16 v[86:87], v236 offset:8704
    ds_read_b64_tr_b16 v[88:89], v239 offset:8192
    ds_read_b64_tr_b16 v[90:91], v239 offset:8704
    ds_read_b64_tr_b16 v[92:93], v238 offset:8192
    ds_read_b64_tr_b16 v[94:95], v238 offset:8704
    ds_read_b64_tr_b16 v[96:97], v241 offset:8192
    ds_read_b64_tr_b16 v[98:99], v241 offset:8704
    ds_read_b64_tr_b16 v[76:77], v236 offset:0
    ds_read_b64_tr_b16 v[78:79], v236 offset:512
    ds_read_b64_tr_b16 v[80:81], v239 offset:0
    ds_read_b64_tr_b16 v[82:83], v239 offset:512
    ds_read_b128 v[100:103], v249 offset:16384
    ds_read_b128 v[104:107], v249 offset:18432
    ds_read_b64_tr_b16 v[116:117], v236 offset:12288
    ds_read_b64_tr_b16 v[118:119], v236 offset:12800
    ds_read_b64_tr_b16 v[120:121], v239 offset:12288
    ds_read_b64_tr_b16 v[122:123], v239 offset:12800
    ds_read_b64_tr_b16 v[124:125], v238 offset:12288
    ds_read_b64_tr_b16 v[126:127], v238 offset:12800
    ds_read_b64_tr_b16 v[128:129], v241 offset:12288
    ds_read_b64_tr_b16 v[130:131], v241 offset:12800
    ds_read_b64_tr_b16 v[108:109], v236 offset:4096
    ds_read_b64_tr_b16 v[110:111], v236 offset:4608
    ds_read_b64_tr_b16 v[112:113], v239 offset:4096
    ds_read_b64_tr_b16 v[114:115], v239 offset:4608
    s_waitcnt vmcnt(0)
    s_waitcnt lgkmcnt(0)
    s_barrier
    v_mfma_f32_16x16x32_bf16 v[36:39], v[68:71], v[84:87], 0
    ds_read_b128 v[132:135], v247 offset:0
    ds_read_b128 v[136:139], v247 offset:2048
    v_mfma_f32_16x16x32_bf16 v[52:55], v[68:71], v[92:95], 0
    ds_read_b64_tr_b16 v[148:149], v236 offset:24576
    ds_read_b64_tr_b16 v[150:151], v236 offset:25088
    v_mfma_f32_16x16x32_bf16 v[20:23], v[76:79], v[68:71], 0
    ds_read_b64_tr_b16 v[152:153], v239 offset:24576
    ds_read_b64_tr_b16 v[154:155], v239 offset:25088
    ds_read_b64_tr_b16 v[156:157], v237 offset:57344
    v_mfma_f32_16x16x32_bf16 v[40:43], v[72:75], v[84:87], 0
    ds_read_b64_tr_b16 v[158:159], v237 offset:57856
    ds_read_b64_tr_b16 v[160:161], v240 offset:57344
    v_mfma_f32_16x16x32_bf16 v[56:59], v[72:75], v[92:95], 0
    ds_read_b64_tr_b16 v[162:163], v240 offset:57856
    ds_read_b64_tr_b16 v[140:141], v236 offset:16384
    v_mfma_f32_16x16x32_bf16 v[28:31], v[80:83], v[68:71], 0
    ds_read_b64_tr_b16 v[142:143], v236 offset:16896
    ds_read_b64_tr_b16 v[144:145], v239 offset:16384
    ds_read_b64_tr_b16 v[146:147], v239 offset:16896
    v_mfma_f32_16x16x32_bf16 v[48:51], v[72:75], v[88:91], 0
    ds_read_b128 v[164:167], v249 offset:0
    ds_read_b128 v[168:171], v249 offset:2048
    v_mfma_f32_16x16x32_bf16 v[64:67], v[72:75], v[96:99], 0
    ds_read_b64_tr_b16 v[180:181], v236 offset:28672
    ds_read_b64_tr_b16 v[182:183], v236 offset:29184
    v_mfma_f32_16x16x32_bf16 v[32:35], v[80:83], v[72:75], 0
    ds_read_b64_tr_b16 v[184:185], v239 offset:28672
    ds_read_b64_tr_b16 v[186:187], v239 offset:29184
    ds_read_b64_tr_b16 v[188:189], v237 offset:61440
    v_mfma_f32_16x16x32_bf16 v[44:47], v[68:71], v[88:91], 0
    ds_read_b64_tr_b16 v[190:191], v237 offset:61952
    ds_read_b64_tr_b16 v[192:193], v240 offset:61440
    v_mfma_f32_16x16x32_bf16 v[60:63], v[68:71], v[96:99], 0
    ds_read_b64_tr_b16 v[194:195], v240 offset:61952
    ds_read_b64_tr_b16 v[172:173], v236 offset:20480
    v_mfma_f32_16x16x32_bf16 v[24:27], v[76:79], v[72:75], 0
    ds_read_b64_tr_b16 v[174:175], v236 offset:20992
    ds_read_b64_tr_b16 v[176:177], v239 offset:20480
    ds_read_b64_tr_b16 v[178:179], v239 offset:20992
    v_mfma_f32_16x16x32_bf16 v[36:39], v[100:103], v[116:119], v[36:39]
    v_mfma_f32_16x16x32_bf16 v[52:55], v[100:103], v[124:127], v[52:55]
    v_mfma_f32_16x16x32_bf16 v[20:23], v[108:111], v[100:103], v[20:23]
    v_mfma_f32_16x16x32_bf16 v[40:43], v[104:107], v[116:119], v[40:43]
    v_mfma_f32_16x16x32_bf16 v[56:59], v[104:107], v[124:127], v[56:59]
    v_mfma_f32_16x16x32_bf16 v[28:31], v[112:115], v[100:103], v[28:31]
    v_mfma_f32_16x16x32_bf16 v[48:51], v[104:107], v[120:123], v[48:51]
    v_mfma_f32_16x16x32_bf16 v[64:67], v[104:107], v[128:131], v[64:67]
    v_mfma_f32_16x16x32_bf16 v[32:35], v[112:115], v[104:107], v[32:35]
    v_mfma_f32_16x16x32_bf16 v[44:47], v[100:103], v[120:123], v[44:47]
    v_mfma_f32_16x16x32_bf16 v[60:63], v[100:103], v[128:131], v[60:63]
    v_mfma_f32_16x16x32_bf16 v[24:27], v[108:111], v[104:107], v[24:27]
    s_waitcnt lgkmcnt(0)
    s_barrier
    v_mfma_f32_16x16x32_bf16 v[36:39], v[132:135], v[148:151], v[36:39]
    ds_read_b128 v[68:71], v246 offset:49152
    ds_read_b128 v[72:75], v246 offset:51200
    v_mfma_f32_16x16x32_bf16 v[52:55], v[132:135], v[156:159], v[52:55]
    ds_read_b64_tr_b16 v[84:85], v236 offset:57344
    ds_read_b64_tr_b16 v[86:87], v236 offset:57856
    v_mfma_f32_16x16x32_bf16 v[20:23], v[140:143], v[132:135], v[20:23]
    ds_read_b64_tr_b16 v[88:89], v239 offset:57344
    ds_read_b64_tr_b16 v[90:91], v239 offset:57856
    ds_read_b64_tr_b16 v[92:93], v237 offset:40960
    v_mfma_f32_16x16x32_bf16 v[40:43], v[136:139], v[148:151], v[40:43]
    ds_read_b64_tr_b16 v[94:95], v237 offset:41472
    ds_read_b64_tr_b16 v[96:97], v240 offset:40960
    v_mfma_f32_16x16x32_bf16 v[56:59], v[136:139], v[156:159], v[56:59]
    ds_read_b64_tr_b16 v[98:99], v240 offset:41472
    ds_read_b64_tr_b16 v[76:77], v236 offset:49152
    v_mfma_f32_16x16x32_bf16 v[28:31], v[144:147], v[132:135], v[28:31]
    ds_read_b64_tr_b16 v[78:79], v236 offset:49664
    ds_read_b64_tr_b16 v[80:81], v239 offset:49152
    ds_read_b64_tr_b16 v[82:83], v239 offset:49664
    v_mfma_f32_16x16x32_bf16 v[48:51], v[136:139], v[152:155], v[48:51]
    ds_read_b128 v[100:103], v248 offset:49152
    ds_read_b128 v[104:107], v248 offset:51200
    v_mfma_f32_16x16x32_bf16 v[64:67], v[136:139], v[160:163], v[64:67]
    ds_read_b64_tr_b16 v[116:117], v236 offset:61440
    ds_read_b64_tr_b16 v[118:119], v236 offset:61952
    v_mfma_f32_16x16x32_bf16 v[32:35], v[144:147], v[136:139], v[32:35]
    ds_read_b64_tr_b16 v[120:121], v239 offset:61440
    ds_read_b64_tr_b16 v[122:123], v239 offset:61952
    ds_read_b64_tr_b16 v[124:125], v237 offset:45056
    v_mfma_f32_16x16x32_bf16 v[44:47], v[132:135], v[152:155], v[44:47]
    ds_read_b64_tr_b16 v[126:127], v237 offset:45568
    ds_read_b64_tr_b16 v[128:129], v240 offset:45056
    v_mfma_f32_16x16x32_bf16 v[60:63], v[132:135], v[160:163], v[60:63]
    ds_read_b64_tr_b16 v[130:131], v240 offset:45568
    ds_read_b64_tr_b16 v[108:109], v236 offset:53248
    v_mfma_f32_16x16x32_bf16 v[24:27], v[140:143], v[136:139], v[24:27]
    ds_read_b64_tr_b16 v[110:111], v236 offset:53760
    ds_read_b64_tr_b16 v[112:113], v239 offset:53248
    ds_read_b64_tr_b16 v[114:115], v239 offset:53760
    v_mfma_f32_16x16x32_bf16 v[36:39], v[164:167], v[180:183], v[36:39]
    v_mfma_f32_16x16x32_bf16 v[52:55], v[164:167], v[188:191], v[52:55]
    v_mfma_f32_16x16x32_bf16 v[20:23], v[172:175], v[164:167], v[20:23]
    v_mfma_f32_16x16x32_bf16 v[40:43], v[168:171], v[180:183], v[40:43]
    v_mfma_f32_16x16x32_bf16 v[56:59], v[168:171], v[188:191], v[56:59]
    v_mfma_f32_16x16x32_bf16 v[28:31], v[176:179], v[164:167], v[28:31]
    v_mfma_f32_16x16x32_bf16 v[48:51], v[168:171], v[184:187], v[48:51]
    v_mfma_f32_16x16x32_bf16 v[64:67], v[168:171], v[192:195], v[64:67]
    v_mfma_f32_16x16x32_bf16 v[32:35], v[176:179], v[168:171], v[32:35]
    v_mfma_f32_16x16x32_bf16 v[44:47], v[164:167], v[184:187], v[44:47]
    v_mfma_f32_16x16x32_bf16 v[60:63], v[164:167], v[192:195], v[60:63]
    v_mfma_f32_16x16x32_bf16 v[24:27], v[172:175], v[168:171], v[24:27]
    s_waitcnt lgkmcnt(0)
    s_barrier
    v_mfma_f32_16x16x32_bf16 v[36:39], v[68:71], v[84:87], v[36:39]
    ds_read_b128 v[132:135], v247 offset:16384
    ds_read_b128 v[136:139], v247 offset:18432
    v_mfma_f32_16x16x32_bf16 v[52:55], v[68:71], v[92:95], v[52:55]
    ds_read_b64_tr_b16 v[148:149], v236 offset:8192
    ds_read_b64_tr_b16 v[150:151], v236 offset:8704
    v_mfma_f32_16x16x32_bf16 v[20:23], v[76:79], v[68:71], v[20:23]
    ds_read_b64_tr_b16 v[152:153], v239 offset:8192
    ds_read_b64_tr_b16 v[154:155], v239 offset:8704
    ds_read_b64_tr_b16 v[156:157], v238 offset:8192
    v_mfma_f32_16x16x32_bf16 v[40:43], v[72:75], v[84:87], v[40:43]
    ds_read_b64_tr_b16 v[158:159], v238 offset:8704
    ds_read_b64_tr_b16 v[160:161], v241 offset:8192
    v_mfma_f32_16x16x32_bf16 v[56:59], v[72:75], v[92:95], v[56:59]
    ds_read_b64_tr_b16 v[162:163], v241 offset:8704
    ds_read_b64_tr_b16 v[140:141], v236 offset:0
    v_mfma_f32_16x16x32_bf16 v[28:31], v[80:83], v[68:71], v[28:31]
    ds_read_b64_tr_b16 v[142:143], v236 offset:512
    ds_read_b64_tr_b16 v[144:145], v239 offset:0
    ds_read_b64_tr_b16 v[146:147], v239 offset:512
    v_mfma_f32_16x16x32_bf16 v[48:51], v[72:75], v[88:91], v[48:51]
    ds_read_b128 v[164:167], v249 offset:16384
    ds_read_b128 v[168:171], v249 offset:18432
    v_mfma_f32_16x16x32_bf16 v[64:67], v[72:75], v[96:99], v[64:67]
    ds_read_b64_tr_b16 v[180:181], v236 offset:12288
    ds_read_b64_tr_b16 v[182:183], v236 offset:12800
    v_mfma_f32_16x16x32_bf16 v[32:35], v[80:83], v[72:75], v[32:35]
    ds_read_b64_tr_b16 v[184:185], v239 offset:12288
    ds_read_b64_tr_b16 v[186:187], v239 offset:12800
    ds_read_b64_tr_b16 v[188:189], v238 offset:12288
    v_mfma_f32_16x16x32_bf16 v[44:47], v[68:71], v[88:91], v[44:47]
    ds_read_b64_tr_b16 v[190:191], v238 offset:12800
    ds_read_b64_tr_b16 v[192:193], v241 offset:12288
    v_mfma_f32_16x16x32_bf16 v[60:63], v[68:71], v[96:99], v[60:63]
    ds_read_b64_tr_b16 v[194:195], v241 offset:12800
    ds_read_b64_tr_b16 v[172:173], v236 offset:4096
    v_mfma_f32_16x16x32_bf16 v[24:27], v[76:79], v[72:75], v[24:27]
    ds_read_b64_tr_b16 v[174:175], v236 offset:4608
    ds_read_b64_tr_b16 v[176:177], v239 offset:4096
    ds_read_b64_tr_b16 v[178:179], v239 offset:4608
    v_mfma_f32_16x16x32_bf16 v[36:39], v[100:103], v[116:119], v[36:39]
    v_mfma_f32_16x16x32_bf16 v[52:55], v[100:103], v[124:127], v[52:55]
    v_mfma_f32_16x16x32_bf16 v[20:23], v[108:111], v[100:103], v[20:23]
    v_mfma_f32_16x16x32_bf16 v[40:43], v[104:107], v[116:119], v[40:43]
    v_mfma_f32_16x16x32_bf16 v[56:59], v[104:107], v[124:127], v[56:59]
    v_mfma_f32_16x16x32_bf16 v[28:31], v[112:115], v[100:103], v[28:31]
    v_mfma_f32_16x16x32_bf16 v[48:51], v[104:107], v[120:123], v[48:51]
    v_mfma_f32_16x16x32_bf16 v[64:67], v[104:107], v[128:131], v[64:67]
    v_mfma_f32_16x16x32_bf16 v[32:35], v[112:115], v[104:107], v[32:35]
    v_mfma_f32_16x16x32_bf16 v[44:47], v[100:103], v[120:123], v[44:47]
    v_mfma_f32_16x16x32_bf16 v[60:63], v[100:103], v[128:131], v[60:63]
    v_mfma_f32_16x16x32_bf16 v[24:27], v[108:111], v[104:107], v[24:27]
    s_waitcnt lgkmcnt(0)
    s_barrier
    v_mfma_f32_16x16x32_bf16 v[36:39], v[132:135], v[148:151], v[36:39]
    ds_read_b128 v[68:71], v247 offset:0
    ds_read_b128 v[72:75], v247 offset:2048
    v_mfma_f32_16x16x32_bf16 v[52:55], v[132:135], v[156:159], v[52:55]
    ds_read_b64_tr_b16 v[84:85], v236 offset:24576
    ds_read_b64_tr_b16 v[86:87], v236 offset:25088
    v_mfma_f32_16x16x32_bf16 v[20:23], v[140:143], v[132:135], v[20:23]
    ds_read_b64_tr_b16 v[88:89], v239 offset:24576
    ds_read_b64_tr_b16 v[90:91], v239 offset:25088
    ds_read_b64_tr_b16 v[92:93], v237 offset:57344
    v_mfma_f32_16x16x32_bf16 v[40:43], v[136:139], v[148:151], v[40:43]
    ds_read_b64_tr_b16 v[94:95], v237 offset:57856
    ds_read_b64_tr_b16 v[96:97], v240 offset:57344
    v_mfma_f32_16x16x32_bf16 v[56:59], v[136:139], v[156:159], v[56:59]
    ds_read_b64_tr_b16 v[98:99], v240 offset:57856
    ds_read_b64_tr_b16 v[76:77], v236 offset:16384
    v_mfma_f32_16x16x32_bf16 v[28:31], v[144:147], v[132:135], v[28:31]
    ds_read_b64_tr_b16 v[78:79], v236 offset:16896
    ds_read_b64_tr_b16 v[80:81], v239 offset:16384
    ds_read_b64_tr_b16 v[82:83], v239 offset:16896
    v_mfma_f32_16x16x32_bf16 v[48:51], v[136:139], v[152:155], v[48:51]
    ds_read_b128 v[100:103], v249 offset:0
    ds_read_b128 v[104:107], v249 offset:2048
    v_mfma_f32_16x16x32_bf16 v[64:67], v[136:139], v[160:163], v[64:67]
    ds_read_b64_tr_b16 v[116:117], v236 offset:28672
    ds_read_b64_tr_b16 v[118:119], v236 offset:29184
    v_mfma_f32_16x16x32_bf16 v[32:35], v[144:147], v[136:139], v[32:35]
    ds_read_b64_tr_b16 v[120:121], v239 offset:28672
    ds_read_b64_tr_b16 v[122:123], v239 offset:29184
    ds_read_b64_tr_b16 v[124:125], v237 offset:61440
    v_mfma_f32_16x16x32_bf16 v[44:47], v[132:135], v[152:155], v[44:47]
    ds_read_b64_tr_b16 v[126:127], v237 offset:61952
    ds_read_b64_tr_b16 v[128:129], v240 offset:61440
    v_mfma_f32_16x16x32_bf16 v[60:63], v[132:135], v[160:163], v[60:63]
    ds_read_b64_tr_b16 v[130:131], v240 offset:61952
    ds_read_b64_tr_b16 v[108:109], v236 offset:20480
    v_mfma_f32_16x16x32_bf16 v[24:27], v[140:143], v[136:139], v[24:27]
    ds_read_b64_tr_b16 v[110:111], v236 offset:20992
    ds_read_b64_tr_b16 v[112:113], v239 offset:20480
    ds_read_b64_tr_b16 v[114:115], v239 offset:20992
    v_mfma_f32_16x16x32_bf16 v[36:39], v[164:167], v[180:183], v[36:39]
    v_mfma_f32_16x16x32_bf16 v[52:55], v[164:167], v[188:191], v[52:55]
    v_mfma_f32_16x16x32_bf16 v[20:23], v[172:175], v[164:167], v[20:23]
    v_mfma_f32_16x16x32_bf16 v[40:43], v[168:171], v[180:183], v[40:43]
    v_mfma_f32_16x16x32_bf16 v[56:59], v[168:171], v[188:191], v[56:59]
    v_mfma_f32_16x16x32_bf16 v[28:31], v[176:179], v[164:167], v[28:31]
    v_mfma_f32_16x16x32_bf16 v[48:51], v[168:171], v[184:187], v[48:51]
    v_mfma_f32_16x16x32_bf16 v[64:67], v[168:171], v[192:195], v[64:67]
    v_mfma_f32_16x16x32_bf16 v[32:35], v[176:179], v[168:171], v[32:35]
    v_mfma_f32_16x16x32_bf16 v[44:47], v[164:167], v[184:187], v[44:47]
    v_mfma_f32_16x16x32_bf16 v[60:63], v[164:167], v[192:195], v[60:63]
    v_mfma_f32_16x16x32_bf16 v[24:27], v[172:175], v[168:171], v[24:27]
    s_waitcnt lgkmcnt(0)
    s_barrier
    v_mfma_f32_16x16x32_bf16 v[36:39], v[68:71], v[84:87], v[36:39]
    ds_read_b128 v[132:135], v246 offset:49152
    ds_read_b128 v[136:139], v246 offset:51200
    v_mfma_f32_16x16x32_bf16 v[52:55], v[68:71], v[92:95], v[52:55]
    ds_read_b64_tr_b16 v[148:149], v236 offset:57344
    ds_read_b64_tr_b16 v[150:151], v236 offset:57856
    v_mfma_f32_16x16x32_bf16 v[20:23], v[76:79], v[68:71], v[20:23]
    ds_read_b64_tr_b16 v[152:153], v239 offset:57344
    ds_read_b64_tr_b16 v[154:155], v239 offset:57856
    ds_read_b64_tr_b16 v[156:157], v237 offset:40960
    v_mfma_f32_16x16x32_bf16 v[40:43], v[72:75], v[84:87], v[40:43]
    ds_read_b64_tr_b16 v[158:159], v237 offset:41472
    ds_read_b64_tr_b16 v[160:161], v240 offset:40960
    v_mfma_f32_16x16x32_bf16 v[56:59], v[72:75], v[92:95], v[56:59]
    ds_read_b64_tr_b16 v[162:163], v240 offset:41472
    ds_read_b64_tr_b16 v[140:141], v236 offset:49152
    v_mfma_f32_16x16x32_bf16 v[28:31], v[80:83], v[68:71], v[28:31]
    ds_read_b64_tr_b16 v[142:143], v236 offset:49664
    ds_read_b64_tr_b16 v[144:145], v239 offset:49152
    ds_read_b64_tr_b16 v[146:147], v239 offset:49664
    v_mfma_f32_16x16x32_bf16 v[48:51], v[72:75], v[88:91], v[48:51]
    ds_read_b128 v[164:167], v248 offset:49152
    ds_read_b128 v[168:171], v248 offset:51200
    v_mfma_f32_16x16x32_bf16 v[64:67], v[72:75], v[96:99], v[64:67]
    ds_read_b64_tr_b16 v[180:181], v236 offset:61440
    ds_read_b64_tr_b16 v[182:183], v236 offset:61952
    v_mfma_f32_16x16x32_bf16 v[32:35], v[80:83], v[72:75], v[32:35]
    ds_read_b64_tr_b16 v[184:185], v239 offset:61440
    ds_read_b64_tr_b16 v[186:187], v239 offset:61952
    ds_read_b64_tr_b16 v[188:189], v237 offset:45056
    v_mfma_f32_16x16x32_bf16 v[44:47], v[68:71], v[88:91], v[44:47]
    ds_read_b64_tr_b16 v[190:191], v237 offset:45568
    ds_read_b64_tr_b16 v[192:193], v240 offset:45056
    v_mfma_f32_16x16x32_bf16 v[60:63], v[68:71], v[96:99], v[60:63]
    ds_read_b64_tr_b16 v[194:195], v240 offset:45568
    ds_read_b64_tr_b16 v[172:173], v236 offset:53248
    v_mfma_f32_16x16x32_bf16 v[24:27], v[76:79], v[72:75], v[24:27]
    ds_read_b64_tr_b16 v[174:175], v236 offset:53760
    ds_read_b64_tr_b16 v[176:177], v239 offset:53248
    ds_read_b64_tr_b16 v[178:179], v239 offset:53760
    v_mfma_f32_16x16x32_bf16 v[36:39], v[100:103], v[116:119], v[36:39]
    v_mfma_f32_16x16x32_bf16 v[52:55], v[100:103], v[124:127], v[52:55]
    v_mfma_f32_16x16x32_bf16 v[20:23], v[108:111], v[100:103], v[20:23]
    v_mfma_f32_16x16x32_bf16 v[40:43], v[104:107], v[116:119], v[40:43]
    v_mfma_f32_16x16x32_bf16 v[56:59], v[104:107], v[124:127], v[56:59]
    v_mfma_f32_16x16x32_bf16 v[28:31], v[112:115], v[100:103], v[28:31]
    v_mfma_f32_16x16x32_bf16 v[48:51], v[104:107], v[120:123], v[48:51]
    v_mfma_f32_16x16x32_bf16 v[64:67], v[104:107], v[128:131], v[64:67]
    v_mfma_f32_16x16x32_bf16 v[32:35], v[112:115], v[104:107], v[32:35]
    v_mfma_f32_16x16x32_bf16 v[44:47], v[100:103], v[120:123], v[44:47]
    v_mfma_f32_16x16x32_bf16 v[60:63], v[100:103], v[128:131], v[60:63]
    v_mfma_f32_16x16x32_bf16 v[24:27], v[108:111], v[104:107], v[24:27]
    s_waitcnt lgkmcnt(0)
    s_barrier
    v_mfma_f32_16x16x32_bf16 v[36:39], v[132:135], v[148:151], v[36:39]
    ds_read_b128 v[68:71], v247 offset:16384
    ds_read_b128 v[72:75], v247 offset:18432
    v_mfma_f32_16x16x32_bf16 v[52:55], v[132:135], v[156:159], v[52:55]
    ds_read_b64_tr_b16 v[84:85], v236 offset:8192
    ds_read_b64_tr_b16 v[86:87], v236 offset:8704
    v_mfma_f32_16x16x32_bf16 v[20:23], v[140:143], v[132:135], v[20:23]
    ds_read_b64_tr_b16 v[88:89], v239 offset:8192
    ds_read_b64_tr_b16 v[90:91], v239 offset:8704
    ds_read_b64_tr_b16 v[92:93], v238 offset:8192
    v_mfma_f32_16x16x32_bf16 v[40:43], v[136:139], v[148:151], v[40:43]
    ds_read_b64_tr_b16 v[94:95], v238 offset:8704
    ds_read_b64_tr_b16 v[96:97], v241 offset:8192
    v_mfma_f32_16x16x32_bf16 v[56:59], v[136:139], v[156:159], v[56:59]
    ds_read_b64_tr_b16 v[98:99], v241 offset:8704
    ds_read_b64_tr_b16 v[76:77], v236 offset:0
    v_mfma_f32_16x16x32_bf16 v[28:31], v[144:147], v[132:135], v[28:31]
    ds_read_b64_tr_b16 v[78:79], v236 offset:512
    ds_read_b64_tr_b16 v[80:81], v239 offset:0
    ds_read_b64_tr_b16 v[82:83], v239 offset:512
    v_mfma_f32_16x16x32_bf16 v[48:51], v[136:139], v[152:155], v[48:51]
    ds_read_b128 v[100:103], v249 offset:16384
    ds_read_b128 v[104:107], v249 offset:18432
    v_mfma_f32_16x16x32_bf16 v[64:67], v[136:139], v[160:163], v[64:67]
    ds_read_b64_tr_b16 v[116:117], v236 offset:12288
    ds_read_b64_tr_b16 v[118:119], v236 offset:12800
    v_mfma_f32_16x16x32_bf16 v[32:35], v[144:147], v[136:139], v[32:35]
    ds_read_b64_tr_b16 v[120:121], v239 offset:12288
    ds_read_b64_tr_b16 v[122:123], v239 offset:12800
    ds_read_b64_tr_b16 v[124:125], v238 offset:12288
    v_mfma_f32_16x16x32_bf16 v[44:47], v[132:135], v[152:155], v[44:47]
    ds_read_b64_tr_b16 v[126:127], v238 offset:12800
    ds_read_b64_tr_b16 v[128:129], v241 offset:12288
    v_mfma_f32_16x16x32_bf16 v[60:63], v[132:135], v[160:163], v[60:63]
    ds_read_b64_tr_b16 v[130:131], v241 offset:12800
    ds_read_b64_tr_b16 v[108:109], v236 offset:4096
    v_mfma_f32_16x16x32_bf16 v[24:27], v[140:143], v[136:139], v[24:27]
    ds_read_b64_tr_b16 v[110:111], v236 offset:4608
    ds_read_b64_tr_b16 v[112:113], v239 offset:4096
    ds_read_b64_tr_b16 v[114:115], v239 offset:4608
    v_mfma_f32_16x16x32_bf16 v[36:39], v[164:167], v[180:183], v[36:39]
    v_mfma_f32_16x16x32_bf16 v[52:55], v[164:167], v[188:191], v[52:55]
    v_mfma_f32_16x16x32_bf16 v[20:23], v[172:175], v[164:167], v[20:23]
    v_mfma_f32_16x16x32_bf16 v[40:43], v[168:171], v[180:183], v[40:43]
    v_mfma_f32_16x16x32_bf16 v[56:59], v[168:171], v[188:191], v[56:59]
    v_mfma_f32_16x16x32_bf16 v[28:31], v[176:179], v[164:167], v[28:31]
    v_mfma_f32_16x16x32_bf16 v[48:51], v[168:171], v[184:187], v[48:51]
    v_mfma_f32_16x16x32_bf16 v[64:67], v[168:171], v[192:195], v[64:67]
    v_mfma_f32_16x16x32_bf16 v[32:35], v[176:179], v[168:171], v[32:35]
    v_mfma_f32_16x16x32_bf16 v[44:47], v[164:167], v[184:187], v[44:47]
    v_mfma_f32_16x16x32_bf16 v[60:63], v[164:167], v[192:195], v[60:63]
    v_mfma_f32_16x16x32_bf16 v[24:27], v[172:175], v[168:171], v[24:27]
    s_waitcnt lgkmcnt(0)
    s_barrier
    v_mfma_f32_16x16x32_bf16 v[36:39], v[68:71], v[84:87], v[36:39]
    ds_read_b128 v[132:135], v247 offset:0
    ds_read_b128 v[136:139], v247 offset:2048
    v_mfma_f32_16x16x32_bf16 v[52:55], v[68:71], v[92:95], v[52:55]
    ds_read_b64_tr_b16 v[148:149], v236 offset:24576
    ds_read_b64_tr_b16 v[150:151], v236 offset:25088
    v_mfma_f32_16x16x32_bf16 v[20:23], v[76:79], v[68:71], v[20:23]
    ds_read_b64_tr_b16 v[152:153], v239 offset:24576
    ds_read_b64_tr_b16 v[154:155], v239 offset:25088
    ds_read_b64_tr_b16 v[156:157], v237 offset:57344
    v_mfma_f32_16x16x32_bf16 v[40:43], v[72:75], v[84:87], v[40:43]
    ds_read_b64_tr_b16 v[158:159], v237 offset:57856
    ds_read_b64_tr_b16 v[160:161], v240 offset:57344
    v_mfma_f32_16x16x32_bf16 v[56:59], v[72:75], v[92:95], v[56:59]
    ds_read_b64_tr_b16 v[162:163], v240 offset:57856
    ds_read_b64_tr_b16 v[140:141], v236 offset:16384
    v_mfma_f32_16x16x32_bf16 v[28:31], v[80:83], v[68:71], v[28:31]
    ds_read_b64_tr_b16 v[142:143], v236 offset:16896
    ds_read_b64_tr_b16 v[144:145], v239 offset:16384
    ds_read_b64_tr_b16 v[146:147], v239 offset:16896
    v_mfma_f32_16x16x32_bf16 v[48:51], v[72:75], v[88:91], v[48:51]
    ds_read_b128 v[164:167], v249 offset:0
    ds_read_b128 v[168:171], v249 offset:2048
    v_mfma_f32_16x16x32_bf16 v[64:67], v[72:75], v[96:99], v[64:67]
    ds_read_b64_tr_b16 v[180:181], v236 offset:28672
    ds_read_b64_tr_b16 v[182:183], v236 offset:29184
    v_mfma_f32_16x16x32_bf16 v[32:35], v[80:83], v[72:75], v[32:35]
    ds_read_b64_tr_b16 v[184:185], v239 offset:28672
    ds_read_b64_tr_b16 v[186:187], v239 offset:29184
    ds_read_b64_tr_b16 v[188:189], v237 offset:61440
    v_mfma_f32_16x16x32_bf16 v[44:47], v[68:71], v[88:91], v[44:47]
    ds_read_b64_tr_b16 v[190:191], v237 offset:61952
    ds_read_b64_tr_b16 v[192:193], v240 offset:61440
    v_mfma_f32_16x16x32_bf16 v[60:63], v[68:71], v[96:99], v[60:63]
    ds_read_b64_tr_b16 v[194:195], v240 offset:61952
    ds_read_b64_tr_b16 v[172:173], v236 offset:20480
    v_mfma_f32_16x16x32_bf16 v[24:27], v[76:79], v[72:75], v[24:27]
    ds_read_b64_tr_b16 v[174:175], v236 offset:20992
    ds_read_b64_tr_b16 v[176:177], v239 offset:20480
    ds_read_b64_tr_b16 v[178:179], v239 offset:20992
    v_mfma_f32_16x16x32_bf16 v[36:39], v[100:103], v[116:119], v[36:39]
    v_mfma_f32_16x16x32_bf16 v[52:55], v[100:103], v[124:127], v[52:55]
    v_mfma_f32_16x16x32_bf16 v[20:23], v[108:111], v[100:103], v[20:23]
    v_mfma_f32_16x16x32_bf16 v[40:43], v[104:107], v[116:119], v[40:43]
    v_mfma_f32_16x16x32_bf16 v[56:59], v[104:107], v[124:127], v[56:59]
    v_mfma_f32_16x16x32_bf16 v[28:31], v[112:115], v[100:103], v[28:31]
    v_mfma_f32_16x16x32_bf16 v[48:51], v[104:107], v[120:123], v[48:51]
    v_mfma_f32_16x16x32_bf16 v[64:67], v[104:107], v[128:131], v[64:67]
    v_mfma_f32_16x16x32_bf16 v[32:35], v[112:115], v[104:107], v[32:35]
    v_mfma_f32_16x16x32_bf16 v[44:47], v[100:103], v[120:123], v[44:47]
    v_mfma_f32_16x16x32_bf16 v[60:63], v[100:103], v[128:131], v[60:63]
    v_mfma_f32_16x16x32_bf16 v[24:27], v[108:111], v[104:107], v[24:27]
    s_waitcnt lgkmcnt(0)
    v_mfma_f32_16x16x32_bf16 v[36:39], v[132:135], v[148:151], v[36:39]
    v_mfma_f32_16x16x32_bf16 v[40:43], v[136:139], v[148:151], v[40:43]
    v_mfma_f32_16x16x32_bf16 v[48:51], v[136:139], v[152:155], v[48:51]
    v_mfma_f32_16x16x32_bf16 v[44:47], v[132:135], v[152:155], v[44:47]
    v_mfma_f32_16x16x32_bf16 v[36:39], v[164:167], v[180:183], v[36:39]
    v_mfma_f32_16x16x32_bf16 v[40:43], v[168:171], v[180:183], v[40:43]
    v_mfma_f32_16x16x32_bf16 v[48:51], v[168:171], v[184:187], v[48:51]
    v_mfma_f32_16x16x32_bf16 v[44:47], v[164:167], v[184:187], v[44:47]
    v_mfma_f32_16x16x32_bf16 v[52:55], v[132:135], v[156:159], v[52:55]
    v_mfma_f32_16x16x32_bf16 v[56:59], v[136:139], v[156:159], v[56:59]
    v_mfma_f32_16x16x32_bf16 v[64:67], v[136:139], v[160:163], v[64:67]
    s_nop 1
    v_mul_f32 v100, s68, v36
    v_mul_f32 v101, s68, v37
    v_mul_f32 v102, s68, v38
    v_mfma_f32_16x16x32_bf16 v[60:63], v[132:135], v[160:163], v[60:63]
    v_mul_f32 v103, s68, v39
    v_mul_f32 v104, s68, v40
    v_mul_f32 v105, s68, v41
    v_mfma_f32_16x16x32_bf16 v[52:55], v[164:167], v[188:191], v[52:55]
    v_mul_f32 v106, s68, v42
    v_mul_f32 v107, s68, v43
    v_mul_f32 v108, s68, v44
    v_mfma_f32_16x16x32_bf16 v[56:59], v[168:171], v[188:191], v[56:59]
    v_mul_f32 v109, s68, v45
    v_mul_f32 v110, s68, v46
    v_mul_f32 v111, s68, v47
    v_mfma_f32_16x16x32_bf16 v[64:67], v[168:171], v[192:195], v[64:67]
    v_mul_f32 v112, s68, v48
    v_mul_f32 v113, s68, v49
    v_mul_f32 v114, s68, v50
    v_mfma_f32_16x16x32_bf16 v[60:63], v[164:167], v[192:195], v[60:63]
    v_mul_f32 v115, s68, v51
    v_exp_f32_e64 v100, v100 clamp
    v_max_f32 v36, 0, v36
    v_mfma_f32_16x16x32_bf16 v[20:23], v[140:143], v[132:135], v[20:23]
    v_exp_f32_e64 v101, v101 clamp
    v_max_f32 v37, 0, v37
    v_exp_f32_e64 v102, v102 clamp
    v_mfma_f32_16x16x32_bf16 v[28:31], v[144:147], v[132:135], v[28:31]
    v_max_f32 v38, 0, v38
    v_exp_f32_e64 v103, v103 clamp
    v_max_f32 v39, 0, v39
    v_mfma_f32_16x16x32_bf16 v[32:35], v[144:147], v[136:139], v[32:35]
    v_exp_f32_e64 v104, v104 clamp
    v_max_f32 v40, 0, v40
    v_exp_f32_e64 v105, v105 clamp
    v_mfma_f32_16x16x32_bf16 v[24:27], v[140:143], v[136:139], v[24:27]
    v_max_f32 v41, 0, v41
    v_exp_f32_e64 v106, v106 clamp
    v_max_f32 v42, 0, v42
    v_mfma_f32_16x16x32_bf16 v[20:23], v[172:175], v[164:167], v[20:23]
    v_exp_f32_e64 v107, v107 clamp
    v_max_f32 v43, 0, v43
    v_exp_f32_e64 v108, v108 clamp
    v_mfma_f32_16x16x32_bf16 v[28:31], v[176:179], v[164:167], v[28:31]
    v_max_f32 v44, 0, v44
    v_exp_f32_e64 v109, v109 clamp
    v_max_f32 v45, 0, v45
    v_mfma_f32_16x16x32_bf16 v[32:35], v[176:179], v[168:171], v[32:35]
    v_exp_f32_e64 v110, v110 clamp
    v_max_f32 v46, 0, v46
    v_exp_f32_e64 v111, v111 clamp
    v_mfma_f32_16x16x32_bf16 v[24:27], v[172:175], v[168:171], v[24:27]
    v_max_f32 v47, 0, v47
    v_exp_f32_e64 v112, v112 clamp
    v_max_f32 v48, 0, v48
    v_exp_f32_e64 v113, v113 clamp
    v_max_f32 v49, 0, v49
    v_exp_f32_e64 v114, v114 clamp
    v_max_f32 v50, 0, v50
    v_exp_f32_e64 v115, v115 clamp
    v_max_f32 v51, 0, v51
    v_add_f32 v36, v36, v100
    v_add_f32 v37, v37, v101
    v_add_f32 v38, v38, v102
    v_add_f32 v39, v39, v103
    v_add_f32 v40, v40, v104
    v_add_f32 v41, v41, v105
    v_add_f32 v42, v42, v106
    v_add_f32 v43, v43, v107
    v_add_f32 v44, v44, v108
    v_add_f32 v45, v45, v109
    v_add_f32 v46, v46, v110
    v_add_f32 v47, v47, v111
    v_add_f32 v48, v48, v112
    v_add_f32 v49, v49, v113
    v_add_f32 v50, v50, v114
    v_add_f32 v51, v51, v115
    v_add_f32 v36, s69, v36
    v_add_f32 v37, s69, v37
    v_add_f32 v38, s69, v38
    v_add_f32 v39, s69, v39
    v_add_f32 v40, s69, v40
    v_add_f32 v41, s69, v41
    v_add_f32 v42, s69, v42
    v_add_f32 v43, s69, v43
    v_add_f32 v44, s69, v44
    v_add_f32 v45, s69, v45
    v_add_f32 v46, s69, v46
    v_add_f32 v47, s69, v47
    v_add_f32 v48, s69, v48
    v_add_f32 v49, s69, v49
    v_add_f32 v50, s69, v50
    v_add_f32 v51, s69, v51
    v_cvt_pk_bf16_f32 v116, v36, v37
    v_cvt_pk_bf16_f32 v117, v38, v39
    v_cvt_pk_bf16_f32 v118, v40, v41
    v_cvt_pk_bf16_f32 v119, v42, v43
    v_cvt_pk_bf16_f32 v120, v44, v45
    v_cvt_pk_bf16_f32 v121, v46, v47
    v_cvt_pk_bf16_f32 v122, v48, v49
    v_cvt_pk_bf16_f32 v123, v50, v51
    v_cvt_pk_bf16_f32 v124, v52, v53
    v_cvt_pk_bf16_f32 v125, v54, v55
    v_cvt_pk_bf16_f32 v126, v56, v57
    v_cvt_pk_bf16_f32 v127, v58, v59
    v_cvt_pk_bf16_f32 v128, v60, v61
    v_cvt_pk_bf16_f32 v129, v62, v63
    v_cvt_pk_bf16_f32 v130, v64, v65
    v_cvt_pk_bf16_f32 v131, v66, v67
    v_mfma_f32_16x16x32_bf16 v[180:183], v[232:235], v[116:119], 0
    v_mov_b32 v52, v6
    v_mov_b32 v53, v6
    v_mov_b32 v54, v6
    v_mov_b32 v55, v6
    v_mfma_f32_16x16x32_bf16 v[184:187], v[232:235], v[120:123], 0
    v_mov_b32 v56, v6
    v_mov_b32 v57, v6
    v_mov_b32 v58, v6
    v_mov_b32 v59, v6
    v_mfma_f32_16x16x32_bf16 v[164:167], v[124:127], v[116:119], 0
    v_mov_b32 v60, v8
    v_mov_b32 v61, v8
    v_mov_b32 v62, v8
    v_mov_b32 v63, v8
    v_mfma_f32_16x16x32_bf16 v[168:171], v[128:131], v[120:123], 0
    v_mov_b32 v64, v8
    v_mov_b32 v65, v8
    v_mov_b32 v66, v8
    v_mov_b32 v67, v8
    v_cndmask_b32 v180, v180, v184, vcc
    s_cmp_eq_u32 s11, 0
    s_cbranch_scc1 c_pr0
    ds_write_b128 v7, v[164:167]
    ds_write_b128 v7, v[168:171] offset:1024
    ds_write_b32 v7, v180 offset:2048
c_pr0:
    s_waitcnt lgkmcnt(0)
    s_cmp_lt_u32 s5, 28
    s_cbranch_scc1 c_g
    s_barrier
    ds_read_b128 v[172:175], v7
    ds_read_b128 v[176:179], v7 offset:1024
    ds_read_b32 v181, v7 offset:2048
    s_waitcnt lgkmcnt(0)
    v_add_f32 v164, v164, v172
    v_add_f32 v165, v165, v173
    v_add_f32 v166, v166, v174
    v_add_f32 v167, v167, v175
    v_add_f32 v168, v168, v176
    v_add_f32 v169, v169, v177
    v_add_f32 v170, v170, v178
    v_add_f32 v171, v171, v179
    v_add_f32 v180, v180, v181
    s_cmp_lg_u32 s11, 0
    s_cbranch_scc1 c_at0
    buffer_atomic_add_f32 v164, v221, s[40:43], s71 offen offset:0
    buffer_atomic_add_f32 v165, v221, s[40:43], s71 offen offset:64
    buffer_atomic_add_f32 v166, v221, s[40:43], s71 offen offset:128
    buffer_atomic_add_f32 v167, v221, s[40:43], s71 offen offset:192
    buffer_atomic_add_f32 v168, v221, s[40:43], s71 offen offset:1088
    buffer_atomic_add_f32 v169, v221, s[40:43], s71 offen offset:1152
    buffer_atomic_add_f32 v170, v221, s[40:43], s71 offen offset:1216
    buffer_atomic_add_f32 v171, v221, s[40:43], s71 offen offset:1280
    s_mov_b32 exec_hi, 0
    buffer_atomic_add_f32 v180, v2, s[40:43], s71 offen offset:1024
    s_mov_b64 exec, -1
c_at0:
    v_mul_f32 v164, s68, v20
    v_mul_f32 v165, s68, v21
    v_mul_f32 v166, s68, v22
    v_mul_f32 v167, s68, v23
    v_mul_f32 v168, s68, v24
    v_mul_f32 v169, s68, v25
    v_mul_f32 v170, s68, v26
    v_mul_f32 v171, s68, v27
    v_mul_f32 v172, s68, v28
    v_mul_f32 v173, s68, v29
    v_mul_f32 v174, s68, v30
    v_mul_f32 v175, s68, v31
    v_mul_f32 v176, s68, v32
    v_mul_f32 v177, s68, v33
    v_mul_f32 v178, s68, v34
    v_mul_f32 v179, s68, v35
    v_exp_f32_e64 v164, v164 clamp
    v_max_f32 v20, 0, v20
    v_exp_f32_e64 v165, v165 clamp
    v_max_f32 v21, 0, v21
    v_exp_f32_e64 v166, v166 clamp
    v_max_f32 v22, 0, v22
    v_exp_f32_e64 v167, v167 clamp
    v_max_f32 v23, 0, v23
    v_exp_f32_e64 v168, v168 clamp
    v_max_f32 v24, 0, v24
    v_exp_f32_e64 v169, v169 clamp
    v_max_f32 v25, 0, v25
    v_exp_f32_e64 v170, v170 clamp
    v_max_f32 v26, 0, v26
    v_exp_f32_e64 v171, v171 clamp
    v_max_f32 v27, 0, v27
    v_exp_f32_e64 v172, v172 clamp
    v_max_f32 v28, 0, v28
    v_exp_f32_e64 v173, v173 clamp
    v_max_f32 v29, 0, v29
    v_exp_f32_e64 v174, v174 clamp
    v_max_f32 v30, 0, v30
    v_exp_f32_e64 v175, v175 clamp
    v_max_f32 v31, 0, v31
    v_exp_f32_e64 v176, v176 clamp
    v_max_f32 v32, 0, v32
    v_exp_f32_e64 v177, v177 clamp
    v_max_f32 v33, 0, v33
    v_exp_f32_e64 v178, v178 clamp
    v_max_f32 v34, 0, v34
    v_exp_f32_e64 v179, v179 clamp
    v_max_f32 v35, 0, v35
    v_add_f32 v20, v20, v164
    v_add_f32 v21, v21, v165
    v_add_f32 v22, v22, v166
    v_add_f32 v23, v23, v167
    v_add_f32 v24, v24, v168
    v_add_f32 v25, v25, v169
    v_add_f32 v26, v26, v170
    v_add_f32 v27, v27, v171
    v_add_f32 v28, v28, v172
    v_add_f32 v29, v29, v173
    v_add_f32 v30, v30, v174
    v_add_f32 v31, v31, v175
    v_add_f32 v32, v32, v176
    v_add_f32 v33, v33, v177
    v_add_f32 v34, v34, v178
    v_add_f32 v35, v35, v179
    v_add_f32 v20, s69, v20
    v_add_f32 v21, s69, v21
    v_add_f32 v22, s69, v22
    v_add_f32 v23, s69, v23
    v_add_f32 v24, s69, v24
    v_add_f32 v25, s69, v25
    v_add_f32 v26, s69, v26
    v_add_f32 v27, s69, v27
    v_add_f32 v28, s69, v28
    v_add_f32 v29, s69, v29
    v_add_f32 v30, s69, v30
    v_add_f32 v31, s69, v31
    v_add_f32 v32, s69, v32
    v_add_f32 v33, s69, v33
    v_add_f32 v34, s69, v34
    v_add_f32 v35, s69, v35
    v_cvt_pk_bf16_f32 v224, v20, v21
    v_cvt_pk_bf16_f32 v225, v22, v23
    v_cvt_pk_bf16_f32 v226, v24, v25
    v_cvt_pk_bf16_f32 v227, v26, v27
    v_cvt_pk_bf16_f32 v228, v28, v29
    v_cvt_pk_bf16_f32 v229, v30, v31
    v_cvt_pk_bf16_f32 v230, v32, v33
    v_cvt_pk_bf16_f32 v231, v34, v35
    s_lshl_b32 s68, s7, 8
    s_add_u32 s68, s68, 0x662000
    v_mov_b32 v2, 161792
    v_mov_b32 v3, 1
    s_waitcnt vmcnt(0)
    s_mov_b64 exec, 1
    ds_add_rtn_u32 v3, v2, v3
    s_mov_b64 exec, -1
    s_waitcnt lgkmcnt(0)
    v_readfirstlane_b32 s15, v3
    s_nop 0
    s_cmp_lg_u32 s15, 3
    s_cbranch_scc1 c_sp1
    s_mov_b32 s15, 1
    s_atomic_add s15, s[38:39], s68
c_sp1:
    s_mov_b32 s75, 200000
c_kv:
    s_mov_b32 s74, 0
    s_atomic_add s74, s[38:39], s68 glc
c_kv_chk:
    s_waitcnt lgkmcnt(0)
    s_cmp_eq_u32 s74, 32
    s_cbranch_scc1 c_kv_ok
    s_sleep 8
    s_sub_u32 s75, s75, 1
    s_cmp_lg_u32 s75, 0
    s_cbranch_scc1 c_kv
c_kv_ok:
    buffer_load_dwordx4 v[164:167], v222, s[40:43], s71 offen offset:0 sc1
    buffer_load_dwordx4 v[168:171], v9, s[40:43], s71 offen offset:1024 sc1
    buffer_load_dwordx4 v[172:175], v222, s[40:43], s71 offen offset:1088 sc1
    buffer_load_dwordx4 v[176:179], v9, s[40:43], s71 offen offset:2112 sc1
    s_waitcnt vmcnt(0)
    v_cvt_pk_bf16_f32 v212, v164, v165
    v_cvt_pk_bf16_f32 v213, v166, v167
    v_cvt_pk_bf16_f32 v214, v168, v169
    v_cvt_pk_bf16_f32 v215, v170, v171
    v_cvt_pk_bf16_f32 v216, v172, v173
    v_cvt_pk_bf16_f32 v217, v174, v175
    v_cvt_pk_bf16_f32 v218, v176, v177
    v_cvt_pk_bf16_f32 v219, v178, v179
    v_mfma_f32_16x16x16_bf16 v[20:23], v[212:213], v[224:225], 0
    v_mfma_f32_16x16x16_bf16 v[180:183], v[214:215], v[224:225], 0
    v_mfma_f32_16x16x16_bf16 v[24:27], v[212:213], v[226:227], 0
    v_mfma_f32_16x16x16_bf16 v[184:187], v[214:215], v[226:227], 0
    v_mfma_f32_16x16x16_bf16 v[28:31], v[216:217], v[228:229], 0
    v_mfma_f32_16x16x16_bf16 v[188:191], v[218:219], v[228:229], 0
    v_mfma_f32_16x16x16_bf16 v[32:35], v[216:217], v[230:231], 0
    v_mfma_f32_16x16x16_bf16 v[192:195], v[218:219], v[230:231], 0
    s_nop 1
    v_add_f32 v180, s69, v180
    s_nop 0
    v_add_f32 v184, s69, v184
    s_nop 0
    v_add_f32 v188, s69, v188
    s_nop 0
    v_add_f32 v192, s69, v192
    v_rcp_f32 v180, v180
    v_rcp_f32 v184, v184
    v_rcp_f32 v188, v188
    v_rcp_f32 v192, v192
    v_mul_f32 v20, v20, v180
    v_mul_f32 v21, v21, v180
    v_mul_f32 v22, v22, v180
    v_mul_f32 v23, v23, v180
    v_cvt_pk_bf16_f32 v164, v20, v21
    v_cvt_pk_bf16_f32 v165, v22, v23
    v_mul_f32 v28, v28, v188
    v_mul_f32 v29, v29, v188
    v_mul_f32 v30, v30, v188
    v_mul_f32 v31, v31, v188
    v_cvt_pk_bf16_f32 v166, v28, v29
    v_cvt_pk_bf16_f32 v167, v30, v31
    buffer_store_dwordx4 v[164:167], v4, s[40:43], s72 offen offset:0 sc1
    v_mul_f32 v24, v24, v184
    v_mul_f32 v25, v25, v184
    v_mul_f32 v26, v26, v184
    v_mul_f32 v27, v27, v184
    v_cvt_pk_bf16_f32 v168, v24, v25
    v_cvt_pk_bf16_f32 v169, v26, v27
    v_mul_f32 v32, v32, v192
    v_mul_f32 v33, v33, v192
    v_mul_f32 v34, v34, v192
    v_mul_f32 v35, v35, v192
    v_cvt_pk_bf16_f32 v170, v32, v33
    v_cvt_pk_bf16_f32 v171, v34, v35
    buffer_store_dwordx4 v[168:171], v4, s[40:43], s72 offen offset:1024 sc1
    s_lshl_b32 s68, s6, 8
    s_add_u32 s68, s68, 0x660000
    v_mov_b32 v2, 161796
    v_mov_b32 v3, 1
    s_waitcnt vmcnt(0)
    s_mov_b64 exec, 1
    ds_add_rtn_u32 v3, v2, v3
    s_mov_b64 exec, -1
    s_waitcnt lgkmcnt(0)
    v_readfirstlane_b32 s15, v3
    s_nop 0
    s_cmp_lg_u32 s15, 3
    s_cbranch_scc1 c_sp2
    s_mov_b32 s15, 1
    s_atomic_add s15, s[38:39], s68
c_sp2:
    s_barrier
    s_branch c_q
c_g:
    s_waitcnt lgkmcnt(0)
    s_barrier
    ds_read_b128 v[172:175], v7
    ds_read_b128 v[176:179], v7 offset:1024
    ds_read_b32 v181, v7 offset:2048
    ds_read_b64_tr_b16 v[68:69], v10 offset:32768
    ds_read_b64_tr_b16 v[70:71], v10 offset:34816
    ds_read_b64_tr_b16 v[76:77], v15 offset:49152
    ds_read_b64_tr_b16 v[78:79], v15 offset:51200
    ds_read_b64_tr_b16 v[72:73], v12 offset:32768
    ds_read_b64_tr_b16 v[74:75], v12 offset:34816
    ds_read_b64_tr_b16 v[80:81], v18 offset:49152
    ds_read_b64_tr_b16 v[82:83], v18 offset:51200
    ds_read_b64_tr_b16 v[84:85], v10 offset:36864
    ds_read_b64_tr_b16 v[86:87], v10 offset:38912
    ds_read_b64_tr_b16 v[92:93], v15 offset:53248
    ds_read_b64_tr_b16 v[94:95], v15 offset:55296
    ds_read_b64_tr_b16 v[88:89], v12 offset:36864
    ds_read_b64_tr_b16 v[90:91], v12 offset:38912
    ds_read_b64_tr_b16 v[96:97], v18 offset:53248
    ds_read_b64_tr_b16 v[98:99], v18 offset:55296
    s_waitcnt lgkmcnt(0)
    s_barrier
    v_mfma_f32_16x16x32_bf16 v[196:199], v[68:71], v[76:79], v[196:199]
    ds_read_b64_tr_b16 v[100:101], v10 offset:40960
    ds_read_b64_tr_b16 v[102:103], v10 offset:43008
    ds_read_b64_tr_b16 v[108:109], v15 offset:40960
    ds_read_b64_tr_b16 v[110:111], v15 offset:43008
    v_add_f32 v164, v164, v172
    v_mfma_f32_16x16x32_bf16 v[200:203], v[72:75], v[76:79], v[200:203]
    ds_read_b64_tr_b16 v[104:105], v12 offset:40960
    ds_read_b64_tr_b16 v[106:107], v12 offset:43008
    ds_read_b64_tr_b16 v[112:113], v18 offset:40960
    v_add_f32 v165, v165, v173
    ds_read_b64_tr_b16 v[114:115], v18 offset:43008
    v_mfma_f32_16x16x32_bf16 v[208:211], v[72:75], v[80:83], v[208:211]
    ds_read_b64_tr_b16 v[116:117], v10 offset:45056
    ds_read_b64_tr_b16 v[118:119], v10 offset:47104
    v_add_f32 v166, v166, v174
    ds_read_b64_tr_b16 v[124:125], v15 offset:45056
    ds_read_b64_tr_b16 v[126:127], v15 offset:47104
    v_mfma_f32_16x16x32_bf16 v[204:207], v[68:71], v[80:83], v[204:207]
    ds_read_b64_tr_b16 v[120:121], v12 offset:45056
    v_add_f32 v167, v167, v175
    ds_read_b64_tr_b16 v[122:123], v12 offset:47104
    ds_read_b64_tr_b16 v[128:129], v18 offset:45056
    ds_read_b64_tr_b16 v[130:131], v18 offset:47104
    v_add_f32 v168, v168, v176
    v_mfma_f32_16x16x32_bf16 v[196:199], v[84:87], v[92:95], v[196:199]
    v_add_f32 v169, v169, v177
    v_mfma_f32_16x16x32_bf16 v[200:203], v[88:91], v[92:95], v[200:203]
    v_add_f32 v170, v170, v178
    v_mfma_f32_16x16x32_bf16 v[208:211], v[88:91], v[96:99], v[208:211]
    v_add_f32 v171, v171, v179
    v_mfma_f32_16x16x32_bf16 v[204:207], v[84:87], v[96:99], v[204:207]
    v_add_f32 v180, v180, v181
    s_cmp_lg_u32 s11, 0
    s_cbranch_scc1 c_at1
    buffer_atomic_add_f32 v164, v221, s[40:43], s71 offen offset:0
    buffer_atomic_add_f32 v165, v221, s[40:43], s71 offen offset:64
    buffer_atomic_add_f32 v166, v221, s[40:43], s71 offen offset:128
    buffer_atomic_add_f32 v167, v221, s[40:43], s71 offen offset:192
    buffer_atomic_add_f32 v168, v221, s[40:43], s71 offen offset:1088
    buffer_atomic_add_f32 v169, v221, s[40:43], s71 offen offset:1152
    buffer_atomic_add_f32 v170, v221, s[40:43], s71 offen offset:1216
    buffer_atomic_add_f32 v171, v221, s[40:43], s71 offen offset:1280
    s_mov_b32 exec_hi, 0
    buffer_atomic_add_f32 v180, v2, s[40:43], s71 offen offset:1024
    s_mov_b64 exec, -1
c_at1:
    s_waitcnt lgkmcnt(0)
    s_barrier
    v_mfma_f32_16x16x32_bf16 v[196:199], v[100:103], v[108:111], v[196:199]
    ds_read_b64_tr_b16 v[68:69], v10 offset:49152
    ds_read_b64_tr_b16 v[70:71], v10 offset:51200
    v_mul_f32 v164, s68, v20
    ds_read_b64_tr_b16 v[76:77], v16 offset:16384
    ds_read_b64_tr_b16 v[78:79], v16 offset:18432
    v_mul_f32 v165, s68, v21
    v_mfma_f32_16x16x32_bf16 v[200:203], v[104:107], v[108:111], v[200:203]
    ds_read_b64_tr_b16 v[72:73], v12 offset:49152
    ds_read_b64_tr_b16 v[74:75], v12 offset:51200
    v_mul_f32 v166, s68, v22
    ds_read_b64_tr_b16 v[80:81], v19 offset:16384
    ds_read_b64_tr_b16 v[82:83], v19 offset:18432
    v_mul_f32 v167, s68, v23
    v_mfma_f32_16x16x32_bf16 v[208:211], v[104:107], v[112:115], v[208:211]
    ds_read_b64_tr_b16 v[84:85], v10 offset:53248
    ds_read_b64_tr_b16 v[86:87], v10 offset:55296
    v_mul_f32 v168, s68, v24
    ds_read_b64_tr_b16 v[92:93], v16 offset:20480
    ds_read_b64_tr_b16 v[94:95], v16 offset:22528
    v_mul_f32 v169, s68, v25
    v_mfma_f32_16x16x32_bf16 v[204:207], v[100:103], v[112:115], v[204:207]
    ds_read_b64_tr_b16 v[88:89], v12 offset:53248
    ds_read_b64_tr_b16 v[90:91], v12 offset:55296
    v_mul_f32 v170, s68, v26
    ds_read_b64_tr_b16 v[96:97], v19 offset:20480
    ds_read_b64_tr_b16 v[98:99], v19 offset:22528
    v_mul_f32 v171, s68, v27
    v_mfma_f32_16x16x32_bf16 v[196:199], v[116:119], v[124:127], v[196:199]
    v_mul_f32 v172, s68, v28
    v_mul_f32 v173, s68, v29
    v_mfma_f32_16x16x32_bf16 v[200:203], v[120:123], v[124:127], v[200:203]
    v_mul_f32 v174, s68, v30
    v_mul_f32 v175, s68, v31
    v_mfma_f32_16x16x32_bf16 v[208:211], v[120:123], v[128:131], v[208:211]
    v_mul_f32 v176, s68, v32
    v_mul_f32 v177, s68, v33
    v_mfma_f32_16x16x32_bf16 v[204:207], v[116:119], v[128:131], v[204:207]
    v_mul_f32 v178, s68, v34
    v_mul_f32 v179, s68, v35
    s_waitcnt lgkmcnt(0)
    s_barrier
    v_mfma_f32_16x16x32_bf16 v[196:199], v[68:71], v[76:79], v[196:199]
    ds_read_b64_tr_b16 v[100:101], v10 offset:57344
    ds_read_b64_tr_b16 v[102:103], v10 offset:59392
    v_exp_f32_e64 v164, v164 clamp
    ds_read_b64_tr_b16 v[108:109], v16 offset:8192
    ds_read_b64_tr_b16 v[110:111], v16 offset:10240
    v_max_f32 v20, 0, v20
    v_mfma_f32_16x16x32_bf16 v[200:203], v[72:75], v[76:79], v[200:203]
    ds_read_b64_tr_b16 v[104:105], v12 offset:57344
    ds_read_b64_tr_b16 v[106:107], v12 offset:59392
    v_exp_f32_e64 v165, v165 clamp
    ds_read_b64_tr_b16 v[112:113], v19 offset:8192
    ds_read_b64_tr_b16 v[114:115], v19 offset:10240
    v_max_f32 v21, 0, v21
    v_mfma_f32_16x16x32_bf16 v[208:211], v[72:75], v[80:83], v[208:211]
    ds_read_b64_tr_b16 v[116:117], v10 offset:61440
    ds_read_b64_tr_b16 v[118:119], v10 offset:63488
    v_exp_f32_e64 v166, v166 clamp
    ds_read_b64_tr_b16 v[124:125], v16 offset:12288
    ds_read_b64_tr_b16 v[126:127], v16 offset:14336
    v_max_f32 v22, 0, v22
    v_mfma_f32_16x16x32_bf16 v[204:207], v[68:71], v[80:83], v[204:207]
    ds_read_b64_tr_b16 v[120:121], v12 offset:61440
    ds_read_b64_tr_b16 v[122:123], v12 offset:63488
    v_exp_f32_e64 v167, v167 clamp
    ds_read_b64_tr_b16 v[128:129], v19 offset:12288
    ds_read_b64_tr_b16 v[130:131], v19 offset:14336
    v_max_f32 v23, 0, v23
    v_mfma_f32_16x16x32_bf16 v[196:199], v[84:87], v[92:95], v[196:199]
    v_exp_f32_e64 v168, v168 clamp
    v_max_f32 v24, 0, v24
    v_mfma_f32_16x16x32_bf16 v[200:203], v[88:91], v[92:95], v[200:203]
    v_exp_f32_e64 v169, v169 clamp
    v_max_f32 v25, 0, v25
    v_mfma_f32_16x16x32_bf16 v[208:211], v[88:91], v[96:99], v[208:211]
    v_exp_f32_e64 v170, v170 clamp
    v_max_f32 v26, 0, v26
    v_mfma_f32_16x16x32_bf16 v[204:207], v[84:87], v[96:99], v[204:207]
    v_exp_f32_e64 v171, v171 clamp
    v_max_f32 v27, 0, v27
    s_waitcnt lgkmcnt(0)
    s_barrier
    v_mfma_f32_16x16x32_bf16 v[196:199], v[100:103], v[108:111], v[196:199]
    ds_read_b64_tr_b16 v[68:69], v10 offset:0
    ds_read_b64_tr_b16 v[70:71], v10 offset:2048
    v_exp_f32_e64 v172, v172 clamp
    ds_read_b64_tr_b16 v[76:77], v16 offset:0
    ds_read_b64_tr_b16 v[78:79], v16 offset:2048
    v_max_f32 v28, 0, v28
    v_mfma_f32_16x16x32_bf16 v[200:203], v[104:107], v[108:111], v[200:203]
    ds_read_b64_tr_b16 v[72:73], v12 offset:0
    ds_read_b64_tr_b16 v[74:75], v12 offset:2048
    v_exp_f32_e64 v173, v173 clamp
    ds_read_b64_tr_b16 v[80:81], v19 offset:0
    ds_read_b64_tr_b16 v[82:83], v19 offset:2048
    v_max_f32 v29, 0, v29
    v_mfma_f32_16x16x32_bf16 v[208:211], v[104:107], v[112:115], v[208:211]
    ds_read_b64_tr_b16 v[84:85], v10 offset:4096
    ds_read_b64_tr_b16 v[86:87], v10 offset:6144
    v_exp_f32_e64 v174, v174 clamp
    ds_read_b64_tr_b16 v[92:93], v16 offset:4096
    ds_read_b64_tr_b16 v[94:95], v16 offset:6144
    v_max_f32 v30, 0, v30
    v_mfma_f32_16x16x32_bf16 v[204:207], v[100:103], v[112:115], v[204:207]
    ds_read_b64_tr_b16 v[88:89], v12 offset:4096
    ds_read_b64_tr_b16 v[90:91], v12 offset:6144
    v_exp_f32_e64 v175, v175 clamp
    ds_read_b64_tr_b16 v[96:97], v19 offset:4096
    ds_read_b64_tr_b16 v[98:99], v19 offset:6144
    v_max_f32 v31, 0, v31
    v_mfma_f32_16x16x32_bf16 v[196:199], v[116:119], v[124:127], v[196:199]
    v_exp_f32_e64 v176, v176 clamp
    v_max_f32 v32, 0, v32
    v_mfma_f32_16x16x32_bf16 v[200:203], v[120:123], v[124:127], v[200:203]
    v_exp_f32_e64 v177, v177 clamp
    v_max_f32 v33, 0, v33
    v_mfma_f32_16x16x32_bf16 v[208:211], v[120:123], v[128:131], v[208:211]
    v_exp_f32_e64 v178, v178 clamp
    v_max_f32 v34, 0, v34
    v_mfma_f32_16x16x32_bf16 v[204:207], v[116:119], v[128:131], v[204:207]
    v_exp_f32_e64 v179, v179 clamp
    v_max_f32 v35, 0, v35
    s_waitcnt vmcnt(0)
    s_waitcnt lgkmcnt(0)
    s_barrier
    v_mfma_f32_16x16x32_bf16 v[196:199], v[68:71], v[76:79], v[196:199]
    ds_read_b64_tr_b16 v[100:101], v10 offset:8192
    ds_read_b64_tr_b16 v[102:103], v10 offset:10240
    v_add_f32 v20, v20, v164
    ds_read_b64_tr_b16 v[108:109], v15 offset:57344
    ds_read_b64_tr_b16 v[110:111], v15 offset:59392
    v_add_f32 v21, v21, v165
    v_mfma_f32_16x16x32_bf16 v[200:203], v[72:75], v[76:79], v[200:203]
    ds_read_b64_tr_b16 v[104:105], v12 offset:8192
    ds_read_b64_tr_b16 v[106:107], v12 offset:10240
    v_add_f32 v22, v22, v166
    ds_read_b64_tr_b16 v[112:113], v18 offset:57344
    ds_read_b64_tr_b16 v[114:115], v18 offset:59392
    v_add_f32 v23, v23, v167
    v_mfma_f32_16x16x32_bf16 v[208:211], v[72:75], v[80:83], v[208:211]
    ds_read_b64_tr_b16 v[116:117], v10 offset:12288
    ds_read_b64_tr_b16 v[118:119], v10 offset:14336
    v_add_f32 v24, v24, v168
    ds_read_b64_tr_b16 v[124:125], v15 offset:61440
    ds_read_b64_tr_b16 v[126:127], v15 offset:63488
    v_add_f32 v25, v25, v169
    v_mfma_f32_16x16x32_bf16 v[204:207], v[68:71], v[80:83], v[204:207]
    ds_read_b64_tr_b16 v[120:121], v12 offset:12288
    ds_read_b64_tr_b16 v[122:123], v12 offset:14336
    v_add_f32 v26, v26, v170
    ds_read_b64_tr_b16 v[128:129], v18 offset:61440
    ds_read_b64_tr_b16 v[130:131], v18 offset:63488
    v_add_f32 v27, v27, v171
    v_mfma_f32_16x16x32_bf16 v[196:199], v[84:87], v[92:95], v[196:199]
    v_add_f32 v28, v28, v172
    v_add_f32 v29, v29, v173
    v_mfma_f32_16x16x32_bf16 v[200:203], v[88:91], v[92:95], v[200:203]
    v_add_f32 v30, v30, v174
    v_add_f32 v31, v31, v175
    v_mfma_f32_16x16x32_bf16 v[208:211], v[88:91], v[96:99], v[208:211]
    v_add_f32 v32, v32, v176
    v_add_f32 v33, v33, v177
    v_mfma_f32_16x16x32_bf16 v[204:207], v[84:87], v[96:99], v[204:207]
    v_add_f32 v34, v34, v178
    v_add_f32 v35, v35, v179
    s_waitcnt lgkmcnt(0)
    s_barrier
    v_mfma_f32_16x16x32_bf16 v[196:199], v[100:103], v[108:111], v[196:199]
    ds_read_b64_tr_b16 v[68:69], v11 offset:0
    ds_read_b64_tr_b16 v[70:71], v11 offset:2048
    v_add_f32 v20, s69, v20
    ds_read_b64_tr_b16 v[76:77], v15 offset:49152
    ds_read_b64_tr_b16 v[78:79], v15 offset:51200
    v_add_f32 v21, s69, v21
    v_mfma_f32_16x16x32_bf16 v[200:203], v[104:107], v[108:111], v[200:203]
    ds_read_b64_tr_b16 v[72:73], v13 offset:0
    ds_read_b64_tr_b16 v[74:75], v13 offset:2048
    v_add_f32 v22, s69, v22
    ds_read_b64_tr_b16 v[80:81], v18 offset:49152
    ds_read_b64_tr_b16 v[82:83], v18 offset:51200
    v_add_f32 v23, s69, v23
    v_mfma_f32_16x16x32_bf16 v[208:211], v[104:107], v[112:115], v[208:211]
    ds_read_b64_tr_b16 v[84:85], v11 offset:4096
    ds_read_b64_tr_b16 v[86:87], v11 offset:6144
    v_add_f32 v24, s69, v24
    ds_read_b64_tr_b16 v[92:93], v15 offset:53248
    ds_read_b64_tr_b16 v[94:95], v15 offset:55296
    v_add_f32 v25, s69, v25
    v_mfma_f32_16x16x32_bf16 v[204:207], v[100:103], v[112:115], v[204:207]
    ds_read_b64_tr_b16 v[88:89], v13 offset:4096
    ds_read_b64_tr_b16 v[90:91], v13 offset:6144
    v_add_f32 v26, s69, v26
    ds_read_b64_tr_b16 v[96:97], v18 offset:53248
    ds_read_b64_tr_b16 v[98:99], v18 offset:55296
    v_add_f32 v27, s69, v27
    v_mfma_f32_16x16x32_bf16 v[196:199], v[116:119], v[124:127], v[196:199]
    v_add_f32 v28, s69, v28
    v_add_f32 v29, s69, v29
    v_mfma_f32_16x16x32_bf16 v[200:203], v[120:123], v[124:127], v[200:203]
    v_add_f32 v30, s69, v30
    v_add_f32 v31, s69, v31
    v_mfma_f32_16x16x32_bf16 v[208:211], v[120:123], v[128:131], v[208:211]
    v_add_f32 v32, s69, v32
    v_add_f32 v33, s69, v33
    v_mfma_f32_16x16x32_bf16 v[204:207], v[116:119], v[128:131], v[204:207]
    v_add_f32 v34, s69, v34
    v_add_f32 v35, s69, v35
    s_waitcnt lgkmcnt(0)
    s_barrier
    v_mfma_f32_16x16x32_bf16 v[196:199], v[68:71], v[76:79], v[196:199]
    ds_read_b64_tr_b16 v[100:101], v10 offset:16384
    ds_read_b64_tr_b16 v[102:103], v10 offset:18432
    ds_read_b64_tr_b16 v[108:109], v16 offset:16384
    ds_read_b64_tr_b16 v[110:111], v16 offset:18432
    v_cvt_pk_bf16_f32 v224, v20, v21
    v_mfma_f32_16x16x32_bf16 v[200:203], v[72:75], v[76:79], v[200:203]
    ds_read_b64_tr_b16 v[104:105], v12 offset:16384
    ds_read_b64_tr_b16 v[106:107], v12 offset:18432
    ds_read_b64_tr_b16 v[112:113], v19 offset:16384
    ds_read_b64_tr_b16 v[114:115], v19 offset:18432
    v_cvt_pk_bf16_f32 v225, v22, v23
    v_mfma_f32_16x16x32_bf16 v[208:211], v[72:75], v[80:83], v[208:211]
    ds_read_b64_tr_b16 v[116:117], v10 offset:20480
    ds_read_b64_tr_b16 v[118:119], v10 offset:22528
    ds_read_b64_tr_b16 v[124:125], v16 offset:20480
    ds_read_b64_tr_b16 v[126:127], v16 offset:22528
    v_cvt_pk_bf16_f32 v226, v24, v25
    v_mfma_f32_16x16x32_bf16 v[204:207], v[68:71], v[80:83], v[204:207]
    ds_read_b64_tr_b16 v[120:121], v12 offset:20480
    ds_read_b64_tr_b16 v[122:123], v12 offset:22528
    ds_read_b64_tr_b16 v[128:129], v19 offset:20480
    ds_read_b64_tr_b16 v[130:131], v19 offset:22528
    v_cvt_pk_bf16_f32 v227, v26, v27
    v_mfma_f32_16x16x32_bf16 v[196:199], v[84:87], v[92:95], v[196:199]
    v_cvt_pk_bf16_f32 v228, v28, v29
    v_mfma_f32_16x16x32_bf16 v[200:203], v[88:91], v[92:95], v[200:203]
    v_cvt_pk_bf16_f32 v229, v30, v31
    v_mfma_f32_16x16x32_bf16 v[208:211], v[88:91], v[96:99], v[208:211]
    v_cvt_pk_bf16_f32 v230, v32, v33
    v_mfma_f32_16x16x32_bf16 v[204:207], v[84:87], v[96:99], v[204:207]
    v_cvt_pk_bf16_f32 v231, v34, v35
    s_waitcnt lgkmcnt(0)
    s_barrier
    v_mfma_f32_16x16x32_bf16 v[196:199], v[100:103], v[108:111], v[196:199]
    ds_read_b64_tr_b16 v[68:69], v10 offset:24576
    ds_read_b64_tr_b16 v[70:71], v10 offset:26624
    ds_read_b64_tr_b16 v[76:77], v16 offset:8192
    ds_read_b64_tr_b16 v[78:79], v16 offset:10240
    v_mfma_f32_16x16x32_bf16 v[200:203], v[104:107], v[108:111], v[200:203]
    ds_read_b64_tr_b16 v[72:73], v12 offset:24576
    ds_read_b64_tr_b16 v[74:75], v12 offset:26624
    ds_read_b64_tr_b16 v[80:81], v19 offset:8192
    ds_read_b64_tr_b16 v[82:83], v19 offset:10240
    v_mfma_f32_16x16x32_bf16 v[208:211], v[104:107], v[112:115], v[208:211]
    ds_read_b64_tr_b16 v[84:85], v10 offset:28672
    ds_read_b64_tr_b16 v[86:87], v10 offset:30720
    ds_read_b64_tr_b16 v[92:93], v16 offset:12288
    ds_read_b64_tr_b16 v[94:95], v16 offset:14336
    v_mfma_f32_16x16x32_bf16 v[204:207], v[100:103], v[112:115], v[204:207]
    ds_read_b64_tr_b16 v[88:89], v12 offset:28672
    ds_read_b64_tr_b16 v[90:91], v12 offset:30720
    ds_read_b64_tr_b16 v[96:97], v19 offset:12288
    ds_read_b64_tr_b16 v[98:99], v19 offset:14336
    v_mfma_f32_16x16x32_bf16 v[196:199], v[116:119], v[124:127], v[196:199]
    v_mfma_f32_16x16x32_bf16 v[200:203], v[120:123], v[124:127], v[200:203]
    v_mfma_f32_16x16x32_bf16 v[208:211], v[120:123], v[128:131], v[208:211]
    v_mfma_f32_16x16x32_bf16 v[204:207], v[116:119], v[128:131], v[204:207]
    s_waitcnt lgkmcnt(0)
    s_barrier
    v_mfma_f32_16x16x32_bf16 v[196:199], v[68:71], v[76:79], v[196:199]
    ds_read_b64_tr_b16 v[100:101], v10 offset:32768
    ds_read_b64_tr_b16 v[102:103], v10 offset:34816
    ds_read_b64_tr_b16 v[108:109], v16 offset:0
    ds_read_b64_tr_b16 v[110:111], v16 offset:2048
    v_mfma_f32_16x16x32_bf16 v[200:203], v[72:75], v[76:79], v[200:203]
    ds_read_b64_tr_b16 v[104:105], v12 offset:32768
    ds_read_b64_tr_b16 v[106:107], v12 offset:34816
    ds_read_b64_tr_b16 v[112:113], v19 offset:0
    ds_read_b64_tr_b16 v[114:115], v19 offset:2048
    v_mfma_f32_16x16x32_bf16 v[208:211], v[72:75], v[80:83], v[208:211]
    ds_read_b64_tr_b16 v[116:117], v10 offset:36864
    ds_read_b64_tr_b16 v[118:119], v10 offset:38912
    ds_read_b64_tr_b16 v[124:125], v16 offset:4096
    ds_read_b64_tr_b16 v[126:127], v16 offset:6144
    v_mfma_f32_16x16x32_bf16 v[204:207], v[68:71], v[80:83], v[204:207]
    ds_read_b64_tr_b16 v[120:121], v12 offset:36864
    ds_read_b64_tr_b16 v[122:123], v12 offset:38912
    ds_read_b64_tr_b16 v[128:129], v19 offset:4096
    ds_read_b64_tr_b16 v[130:131], v19 offset:6144
    v_mfma_f32_16x16x32_bf16 v[196:199], v[84:87], v[92:95], v[196:199]
    v_mfma_f32_16x16x32_bf16 v[200:203], v[88:91], v[92:95], v[200:203]
    v_mfma_f32_16x16x32_bf16 v[208:211], v[88:91], v[96:99], v[208:211]
    v_mfma_f32_16x16x32_bf16 v[204:207], v[84:87], v[96:99], v[204:207]
    s_waitcnt lgkmcnt(0)
    s_barrier
    v_mfma_f32_16x16x32_bf16 v[196:199], v[100:103], v[108:111], v[196:199]
    ds_read_b64_tr_b16 v[68:69], v10 offset:40960
    ds_read_b64_tr_b16 v[70:71], v10 offset:43008
    ds_read_b64_tr_b16 v[76:77], v15 offset:57344
    ds_read_b64_tr_b16 v[78:79], v15 offset:59392
    v_mfma_f32_16x16x32_bf16 v[200:203], v[104:107], v[108:111], v[200:203]
    ds_read_b64_tr_b16 v[72:73], v12 offset:40960
    ds_read_b64_tr_b16 v[74:75], v12 offset:43008
    ds_read_b64_tr_b16 v[80:81], v18 offset:57344
    ds_read_b64_tr_b16 v[82:83], v18 offset:59392
    v_mfma_f32_16x16x32_bf16 v[208:211], v[104:107], v[112:115], v[208:211]
    ds_read_b64_tr_b16 v[84:85], v10 offset:45056
    ds_read_b64_tr_b16 v[86:87], v10 offset:47104
    ds_read_b64_tr_b16 v[92:93], v15 offset:61440
    ds_read_b64_tr_b16 v[94:95], v15 offset:63488
    v_mfma_f32_16x16x32_bf16 v[204:207], v[100:103], v[112:115], v[204:207]
    ds_read_b64_tr_b16 v[88:89], v12 offset:45056
    ds_read_b64_tr_b16 v[90:91], v12 offset:47104
    ds_read_b64_tr_b16 v[96:97], v18 offset:61440
    ds_read_b64_tr_b16 v[98:99], v18 offset:63488
    v_mfma_f32_16x16x32_bf16 v[196:199], v[116:119], v[124:127], v[196:199]
    v_mfma_f32_16x16x32_bf16 v[200:203], v[120:123], v[124:127], v[200:203]
    v_mfma_f32_16x16x32_bf16 v[208:211], v[120:123], v[128:131], v[208:211]
    v_mfma_f32_16x16x32_bf16 v[204:207], v[116:119], v[128:131], v[204:207]
    s_waitcnt lgkmcnt(0)
    s_barrier
    v_mfma_f32_16x16x32_bf16 v[196:199], v[68:71], v[76:79], v[196:199]
    ds_read_b64_tr_b16 v[100:101], v10 offset:49152
    ds_read_b64_tr_b16 v[102:103], v10 offset:51200
    ds_read_b64_tr_b16 v[108:109], v15 offset:49152
    ds_read_b64_tr_b16 v[110:111], v15 offset:51200
    v_mfma_f32_16x16x32_bf16 v[200:203], v[72:75], v[76:79], v[200:203]
    ds_read_b64_tr_b16 v[104:105], v12 offset:49152
    ds_read_b64_tr_b16 v[106:107], v12 offset:51200
    ds_read_b64_tr_b16 v[112:113], v18 offset:49152
    ds_read_b64_tr_b16 v[114:115], v18 offset:51200
    v_mfma_f32_16x16x32_bf16 v[208:211], v[72:75], v[80:83], v[208:211]
    ds_read_b64_tr_b16 v[116:117], v10 offset:53248
    ds_read_b64_tr_b16 v[118:119], v10 offset:55296
    ds_read_b64_tr_b16 v[124:125], v15 offset:53248
    ds_read_b64_tr_b16 v[126:127], v15 offset:55296
    v_mfma_f32_16x16x32_bf16 v[204:207], v[68:71], v[80:83], v[204:207]
    ds_read_b64_tr_b16 v[120:121], v12 offset:53248
    ds_read_b64_tr_b16 v[122:123], v12 offset:55296
    ds_read_b64_tr_b16 v[128:129], v18 offset:53248
    ds_read_b64_tr_b16 v[130:131], v18 offset:55296
    v_mfma_f32_16x16x32_bf16 v[196:199], v[84:87], v[92:95], v[196:199]
    v_mfma_f32_16x16x32_bf16 v[200:203], v[88:91], v[92:95], v[200:203]
    v_mfma_f32_16x16x32_bf16 v[208:211], v[88:91], v[96:99], v[208:211]
    v_mfma_f32_16x16x32_bf16 v[204:207], v[84:87], v[96:99], v[204:207]
    s_waitcnt lgkmcnt(0)
    s_barrier
    v_mfma_f32_16x16x32_bf16 v[196:199], v[100:103], v[108:111], v[196:199]
    ds_read_b64_tr_b16 v[68:69], v10 offset:0
    ds_read_b64_tr_b16 v[70:71], v10 offset:2048
    ds_read_b64_tr_b16 v[76:77], v16 offset:16384
    ds_read_b64_tr_b16 v[78:79], v16 offset:18432
    v_mfma_f32_16x16x32_bf16 v[200:203], v[104:107], v[108:111], v[200:203]
    ds_read_b64_tr_b16 v[72:73], v12 offset:0
    ds_read_b64_tr_b16 v[74:75], v12 offset:2048
    ds_read_b64_tr_b16 v[80:81], v19 offset:16384
    ds_read_b64_tr_b16 v[82:83], v19 offset:18432
    v_mfma_f32_16x16x32_bf16 v[208:211], v[104:107], v[112:115], v[208:211]
    ds_read_b64_tr_b16 v[84:85], v10 offset:4096
    ds_read_b64_tr_b16 v[86:87], v10 offset:6144
    ds_read_b64_tr_b16 v[92:93], v16 offset:20480
    ds_read_b64_tr_b16 v[94:95], v16 offset:22528
    v_mfma_f32_16x16x32_bf16 v[204:207], v[100:103], v[112:115], v[204:207]
    ds_read_b64_tr_b16 v[88:89], v12 offset:4096
    ds_read_b64_tr_b16 v[90:91], v12 offset:6144
    ds_read_b64_tr_b16 v[96:97], v19 offset:20480
    ds_read_b64_tr_b16 v[98:99], v19 offset:22528
    v_mfma_f32_16x16x32_bf16 v[196:199], v[116:119], v[124:127], v[196:199]
    v_mfma_f32_16x16x32_bf16 v[200:203], v[120:123], v[124:127], v[200:203]
    v_mfma_f32_16x16x32_bf16 v[208:211], v[120:123], v[128:131], v[208:211]
    v_mfma_f32_16x16x32_bf16 v[204:207], v[116:119], v[128:131], v[204:207]
    s_waitcnt lgkmcnt(0)
    s_barrier
    v_mfma_f32_16x16x32_bf16 v[196:199], v[68:71], v[76:79], v[196:199]
    ds_read_b64_tr_b16 v[100:101], v10 offset:8192
    ds_read_b64_tr_b16 v[102:103], v10 offset:10240
    ds_read_b64_tr_b16 v[108:109], v16 offset:8192
    ds_read_b64_tr_b16 v[110:111], v16 offset:10240
    v_mfma_f32_16x16x32_bf16 v[200:203], v[72:75], v[76:79], v[200:203]
    ds_read_b64_tr_b16 v[104:105], v12 offset:8192
    ds_read_b64_tr_b16 v[106:107], v12 offset:10240
    ds_read_b64_tr_b16 v[112:113], v19 offset:8192
    ds_read_b64_tr_b16 v[114:115], v19 offset:10240
    v_mfma_f32_16x16x32_bf16 v[208:211], v[72:75], v[80:83], v[208:211]
    ds_read_b64_tr_b16 v[116:117], v10 offset:12288
    ds_read_b64_tr_b16 v[118:119], v10 offset:14336
    ds_read_b64_tr_b16 v[124:125], v16 offset:12288
    ds_read_b64_tr_b16 v[126:127], v16 offset:14336
    v_mfma_f32_16x16x32_bf16 v[204:207], v[68:71], v[80:83], v[204:207]
    ds_read_b64_tr_b16 v[120:121], v12 offset:12288
    ds_read_b64_tr_b16 v[122:123], v12 offset:14336
    ds_read_b64_tr_b16 v[128:129], v19 offset:12288
    ds_read_b64_tr_b16 v[130:131], v19 offset:14336
    v_mfma_f32_16x16x32_bf16 v[196:199], v[84:87], v[92:95], v[196:199]
    v_mfma_f32_16x16x32_bf16 v[200:203], v[88:91], v[92:95], v[200:203]
    v_mfma_f32_16x16x32_bf16 v[208:211], v[88:91], v[96:99], v[208:211]
    v_mfma_f32_16x16x32_bf16 v[204:207], v[84:87], v[96:99], v[204:207]
    s_waitcnt lgkmcnt(0)
    s_barrier
    v_mfma_f32_16x16x32_bf16 v[196:199], v[100:103], v[108:111], v[196:199]
    ds_read_b64_tr_b16 v[68:69], v10 offset:16384
    ds_read_b64_tr_b16 v[70:71], v10 offset:18432
    ds_read_b64_tr_b16 v[76:77], v16 offset:0
    ds_read_b64_tr_b16 v[78:79], v16 offset:2048
    v_mfma_f32_16x16x32_bf16 v[200:203], v[104:107], v[108:111], v[200:203]
    ds_read_b64_tr_b16 v[72:73], v12 offset:16384
    ds_read_b64_tr_b16 v[74:75], v12 offset:18432
    ds_read_b64_tr_b16 v[80:81], v19 offset:0
    ds_read_b64_tr_b16 v[82:83], v19 offset:2048
    v_mfma_f32_16x16x32_bf16 v[208:211], v[104:107], v[112:115], v[208:211]
    ds_read_b64_tr_b16 v[84:85], v10 offset:20480
    ds_read_b64_tr_b16 v[86:87], v10 offset:22528
    ds_read_b64_tr_b16 v[92:93], v16 offset:4096
    ds_read_b64_tr_b16 v[94:95], v16 offset:6144
    v_mfma_f32_16x16x32_bf16 v[204:207], v[100:103], v[112:115], v[204:207]
    ds_read_b64_tr_b16 v[88:89], v12 offset:20480
    ds_read_b64_tr_b16 v[90:91], v12 offset:22528
    ds_read_b64_tr_b16 v[96:97], v19 offset:4096
    ds_read_b64_tr_b16 v[98:99], v19 offset:6144
    v_mfma_f32_16x16x32_bf16 v[196:199], v[116:119], v[124:127], v[196:199]
    v_mfma_f32_16x16x32_bf16 v[200:203], v[120:123], v[124:127], v[200:203]
    v_mfma_f32_16x16x32_bf16 v[208:211], v[120:123], v[128:131], v[208:211]
    v_mfma_f32_16x16x32_bf16 v[204:207], v[116:119], v[128:131], v[204:207]
    s_waitcnt lgkmcnt(0)
    s_barrier
    v_mfma_f32_16x16x32_bf16 v[196:199], v[68:71], v[76:79], v[196:199]
    ds_read_b64_tr_b16 v[100:101], v10 offset:24576
    ds_read_b64_tr_b16 v[102:103], v10 offset:26624
    ds_read_b64_tr_b16 v[108:109], v15 offset:57344
    ds_read_b64_tr_b16 v[110:111], v15 offset:59392
    v_mfma_f32_16x16x32_bf16 v[200:203], v[72:75], v[76:79], v[200:203]
    ds_read_b64_tr_b16 v[104:105], v12 offset:24576
    ds_read_b64_tr_b16 v[106:107], v12 offset:26624
    ds_read_b64_tr_b16 v[112:113], v18 offset:57344
    ds_read_b64_tr_b16 v[114:115], v18 offset:59392
    v_mfma_f32_16x16x32_bf16 v[208:211], v[72:75], v[80:83], v[208:211]
    ds_read_b64_tr_b16 v[116:117], v10 offset:28672
    ds_read_b64_tr_b16 v[118:119], v10 offset:30720
    ds_read_b64_tr_b16 v[124:125], v15 offset:61440
    ds_read_b64_tr_b16 v[126:127], v15 offset:63488
    v_mfma_f32_16x16x32_bf16 v[204:207], v[68:71], v[80:83], v[204:207]
    ds_read_b64_tr_b16 v[120:121], v12 offset:28672
    ds_read_b64_tr_b16 v[122:123], v12 offset:30720
    ds_read_b64_tr_b16 v[128:129], v18 offset:61440
    ds_read_b64_tr_b16 v[130:131], v18 offset:63488
    v_mfma_f32_16x16x32_bf16 v[196:199], v[84:87], v[92:95], v[196:199]
    v_mfma_f32_16x16x32_bf16 v[200:203], v[88:91], v[92:95], v[200:203]
    v_mfma_f32_16x16x32_bf16 v[208:211], v[88:91], v[96:99], v[208:211]
    v_mfma_f32_16x16x32_bf16 v[204:207], v[84:87], v[96:99], v[204:207]
    s_waitcnt lgkmcnt(0)
    s_barrier
    v_mfma_f32_16x16x32_bf16 v[196:199], v[100:103], v[108:111], v[196:199]
    ds_read_b64_tr_b16 v[68:69], v10 offset:32768
    ds_read_b64_tr_b16 v[70:71], v10 offset:34816
    ds_read_b64_tr_b16 v[76:77], v15 offset:49152
    ds_read_b64_tr_b16 v[78:79], v15 offset:51200
    v_mfma_f32_16x16x32_bf16 v[200:203], v[104:107], v[108:111], v[200:203]
    ds_read_b64_tr_b16 v[72:73], v12 offset:32768
    ds_read_b64_tr_b16 v[74:75], v12 offset:34816
    ds_read_b64_tr_b16 v[80:81], v18 offset:49152
    ds_read_b64_tr_b16 v[82:83], v18 offset:51200
    v_mfma_f32_16x16x32_bf16 v[208:211], v[104:107], v[112:115], v[208:211]
    ds_read_b64_tr_b16 v[84:85], v10 offset:36864
    ds_read_b64_tr_b16 v[86:87], v10 offset:38912
    ds_read_b64_tr_b16 v[92:93], v15 offset:53248
    ds_read_b64_tr_b16 v[94:95], v15 offset:55296
    v_mfma_f32_16x16x32_bf16 v[204:207], v[100:103], v[112:115], v[204:207]
    ds_read_b64_tr_b16 v[88:89], v12 offset:36864
    ds_read_b64_tr_b16 v[90:91], v12 offset:38912
    ds_read_b64_tr_b16 v[96:97], v18 offset:53248
    ds_read_b64_tr_b16 v[98:99], v18 offset:55296
    v_mfma_f32_16x16x32_bf16 v[196:199], v[116:119], v[124:127], v[196:199]
    v_mfma_f32_16x16x32_bf16 v[200:203], v[120:123], v[124:127], v[200:203]
    v_mfma_f32_16x16x32_bf16 v[208:211], v[120:123], v[128:131], v[208:211]
    v_mfma_f32_16x16x32_bf16 v[204:207], v[116:119], v[128:131], v[204:207]
    s_waitcnt lgkmcnt(0)
    s_barrier
    v_mfma_f32_16x16x32_bf16 v[196:199], v[68:71], v[76:79], v[196:199]
    ds_read_b64_tr_b16 v[100:101], v10 offset:40960
    ds_read_b64_tr_b16 v[102:103], v10 offset:43008
    ds_read_b64_tr_b16 v[108:109], v16 offset:16384
    ds_read_b64_tr_b16 v[110:111], v16 offset:18432
    v_mfma_f32_16x16x32_bf16 v[200:203], v[72:75], v[76:79], v[200:203]
    ds_read_b64_tr_b16 v[104:105], v12 offset:40960
    ds_read_b64_tr_b16 v[106:107], v12 offset:43008
    ds_read_b64_tr_b16 v[112:113], v19 offset:16384
    ds_read_b64_tr_b16 v[114:115], v19 offset:18432
    v_mfma_f32_16x16x32_bf16 v[208:211], v[72:75], v[80:83], v[208:211]
    ds_read_b64_tr_b16 v[116:117], v10 offset:45056
    ds_read_b64_tr_b16 v[118:119], v10 offset:47104
    ds_read_b64_tr_b16 v[124:125], v16 offset:20480
    ds_read_b64_tr_b16 v[126:127], v16 offset:22528
    v_mfma_f32_16x16x32_bf16 v[204:207], v[68:71], v[80:83], v[204:207]
    ds_read_b64_tr_b16 v[120:121], v12 offset:45056
    ds_read_b64_tr_b16 v[122:123], v12 offset:47104
    ds_read_b64_tr_b16 v[128:129], v19 offset:20480
    ds_read_b64_tr_b16 v[130:131], v19 offset:22528
    v_mfma_f32_16x16x32_bf16 v[196:199], v[84:87], v[92:95], v[196:199]
    v_mfma_f32_16x16x32_bf16 v[200:203], v[88:91], v[92:95], v[200:203]
    v_mfma_f32_16x16x32_bf16 v[208:211], v[88:91], v[96:99], v[208:211]
    v_mfma_f32_16x16x32_bf16 v[204:207], v[84:87], v[96:99], v[204:207]
    s_waitcnt lgkmcnt(0)
    s_barrier
    ds_read_b128 v[164:167], v223 offset:0
    ds_read_b128 v[168:171], v250 offset:1024
    ds_read_b128 v[172:175], v223 offset:1088
    ds_read_b128 v[176:179], v250 offset:2112
    v_mfma_f32_16x16x32_bf16 v[196:199], v[100:103], v[108:111], v[196:199]
    ds_read_b64_tr_b16 v[68:69], v10 offset:49152
    ds_read_b64_tr_b16 v[70:71], v10 offset:51200
    ds_read_b64_tr_b16 v[76:77], v16 offset:8192
    ds_read_b64_tr_b16 v[78:79], v16 offset:10240
    v_mfma_f32_16x16x32_bf16 v[200:203], v[104:107], v[108:111], v[200:203]
    ds_read_b64_tr_b16 v[72:73], v12 offset:49152
    ds_read_b64_tr_b16 v[74:75], v12 offset:51200
    ds_read_b64_tr_b16 v[80:81], v19 offset:8192
    ds_read_b64_tr_b16 v[82:83], v19 offset:10240
    v_mfma_f32_16x16x32_bf16 v[208:211], v[104:107], v[112:115], v[208:211]
    ds_read_b64_tr_b16 v[84:85], v10 offset:53248
    ds_read_b64_tr_b16 v[86:87], v10 offset:55296
    ds_read_b64_tr_b16 v[92:93], v16 offset:12288
    ds_read_b64_tr_b16 v[94:95], v16 offset:14336
    v_mfma_f32_16x16x32_bf16 v[204:207], v[100:103], v[112:115], v[204:207]
    ds_read_b64_tr_b16 v[88:89], v12 offset:53248
    ds_read_b64_tr_b16 v[90:91], v12 offset:55296
    ds_read_b64_tr_b16 v[96:97], v19 offset:12288
    ds_read_b64_tr_b16 v[98:99], v19 offset:14336
    v_mfma_f32_16x16x32_bf16 v[196:199], v[116:119], v[124:127], v[196:199]
    v_mfma_f32_16x16x32_bf16 v[200:203], v[120:123], v[124:127], v[200:203]
    v_mfma_f32_16x16x32_bf16 v[208:211], v[120:123], v[128:131], v[208:211]
    v_mfma_f32_16x16x32_bf16 v[204:207], v[116:119], v[128:131], v[204:207]
    s_waitcnt lgkmcnt(0)
    s_barrier
    v_mfma_f32_16x16x32_bf16 v[196:199], v[68:71], v[76:79], v[196:199]
    ds_read_b64_tr_b16 v[100:101], v10 offset:0
    ds_read_b64_tr_b16 v[102:103], v10 offset:2048
    v_cvt_pk_bf16_f32 v212, v164, v165
    ds_read_b64_tr_b16 v[108:109], v16 offset:0
    ds_read_b64_tr_b16 v[110:111], v16 offset:2048
    v_cvt_pk_bf16_f32 v213, v166, v167
    v_mfma_f32_16x16x32_bf16 v[200:203], v[72:75], v[76:79], v[200:203]
    ds_read_b64_tr_b16 v[104:105], v12 offset:0
    ds_read_b64_tr_b16 v[106:107], v12 offset:2048
    v_cvt_pk_bf16_f32 v214, v168, v169
    ds_read_b64_tr_b16 v[112:113], v19 offset:0
    ds_read_b64_tr_b16 v[114:115], v19 offset:2048
    v_cvt_pk_bf16_f32 v215, v170, v171
    v_mfma_f32_16x16x32_bf16 v[208:211], v[72:75], v[80:83], v[208:211]
    ds_read_b64_tr_b16 v[116:117], v10 offset:4096
    ds_read_b64_tr_b16 v[118:119], v10 offset:6144
    v_cvt_pk_bf16_f32 v216, v172, v173
    ds_read_b64_tr_b16 v[124:125], v16 offset:4096
    ds_read_b64_tr_b16 v[126:127], v16 offset:6144
    v_cvt_pk_bf16_f32 v217, v174, v175
    v_mfma_f32_16x16x32_bf16 v[204:207], v[68:71], v[80:83], v[204:207]
    ds_read_b64_tr_b16 v[120:121], v12 offset:4096
    ds_read_b64_tr_b16 v[122:123], v12 offset:6144
    v_cvt_pk_bf16_f32 v218, v176, v177
    ds_read_b64_tr_b16 v[128:129], v19 offset:4096
    ds_read_b64_tr_b16 v[130:131], v19 offset:6144
    v_cvt_pk_bf16_f32 v219, v178, v179
    v_mfma_f32_16x16x32_bf16 v[196:199], v[84:87], v[92:95], v[196:199]
    v_mfma_f32_16x16x16_bf16 v[20:23], v[212:213], v[224:225], 0
    v_mfma_f32_16x16x16_bf16 v[180:183], v[214:215], v[224:225], 0
    v_mfma_f32_16x16x32_bf16 v[200:203], v[88:91], v[92:95], v[200:203]
    v_mfma_f32_16x16x16_bf16 v[24:27], v[212:213], v[226:227], 0
    v_mfma_f32_16x16x16_bf16 v[184:187], v[214:215], v[226:227], 0
    v_mfma_f32_16x16x32_bf16 v[208:211], v[88:91], v[96:99], v[208:211]
    v_mfma_f32_16x16x16_bf16 v[28:31], v[216:217], v[228:229], 0
    v_mfma_f32_16x16x16_bf16 v[188:191], v[218:219], v[228:229], 0
    v_mfma_f32_16x16x32_bf16 v[204:207], v[84:87], v[96:99], v[204:207]
    v_mfma_f32_16x16x16_bf16 v[32:35], v[216:217], v[230:231], 0
    v_mfma_f32_16x16x16_bf16 v[192:195], v[218:219], v[230:231], 0
    s_waitcnt lgkmcnt(0)
    s_barrier
    v_mfma_f32_16x16x32_bf16 v[196:199], v[100:103], v[108:111], v[196:199]
    ds_read_b64_tr_b16 v[68:69], v10 offset:8192
    ds_read_b64_tr_b16 v[70:71], v10 offset:10240
    ds_read_b64_tr_b16 v[76:77], v15 offset:57344
    ds_read_b64_tr_b16 v[78:79], v15 offset:59392
    v_mfma_f32_16x16x32_bf16 v[200:203], v[104:107], v[108:111], v[200:203]
    ds_read_b64_tr_b16 v[72:73], v12 offset:8192
    ds_read_b64_tr_b16 v[74:75], v12 offset:10240
    ds_read_b64_tr_b16 v[80:81], v18 offset:57344
    ds_read_b64_tr_b16 v[82:83], v18 offset:59392
    v_mfma_f32_16x16x32_bf16 v[208:211], v[104:107], v[112:115], v[208:211]
    ds_read_b64_tr_b16 v[84:85], v10 offset:12288
    ds_read_b64_tr_b16 v[86:87], v10 offset:14336
    ds_read_b64_tr_b16 v[92:93], v15 offset:61440
    ds_read_b64_tr_b16 v[94:95], v15 offset:63488
    v_mfma_f32_16x16x32_bf16 v[204:207], v[100:103], v[112:115], v[204:207]
    ds_read_b64_tr_b16 v[88:89], v12 offset:12288
    ds_read_b64_tr_b16 v[90:91], v12 offset:14336
    ds_read_b64_tr_b16 v[96:97], v18 offset:61440
    ds_read_b64_tr_b16 v[98:99], v18 offset:63488
    v_mfma_f32_16x16x32_bf16 v[196:199], v[116:119], v[124:127], v[196:199]
    v_mfma_f32_16x16x32_bf16 v[200:203], v[120:123], v[124:127], v[200:203]
    v_mfma_f32_16x16x32_bf16 v[208:211], v[120:123], v[128:131], v[208:211]
    v_mfma_f32_16x16x32_bf16 v[204:207], v[116:119], v[128:131], v[204:207]
    s_waitcnt lgkmcnt(0)
    s_barrier
    v_mfma_f32_16x16x32_bf16 v[196:199], v[68:71], v[76:79], v[196:199]
    ds_read_b64_tr_b16 v[100:101], v10 offset:16384
    ds_read_b64_tr_b16 v[102:103], v10 offset:18432
    v_add_f32 v180, s69, v180
    ds_read_b64_tr_b16 v[108:109], v15 offset:49152
    ds_read_b64_tr_b16 v[110:111], v15 offset:51200
    v_add_f32 v184, s69, v184
    v_mfma_f32_16x16x32_bf16 v[200:203], v[72:75], v[76:79], v[200:203]
    ds_read_b64_tr_b16 v[104:105], v12 offset:16384
    ds_read_b64_tr_b16 v[106:107], v12 offset:18432
    v_add_f32 v188, s69, v188
    ds_read_b64_tr_b16 v[112:113], v18 offset:49152
    ds_read_b64_tr_b16 v[114:115], v18 offset:51200
    v_add_f32 v192, s69, v192
    v_mfma_f32_16x16x32_bf16 v[208:211], v[72:75], v[80:83], v[208:211]
    ds_read_b64_tr_b16 v[116:117], v10 offset:20480
    ds_read_b64_tr_b16 v[118:119], v10 offset:22528
    v_rcp_f32 v180, v180
    ds_read_b64_tr_b16 v[124:125], v15 offset:53248
    ds_read_b64_tr_b16 v[126:127], v15 offset:55296
    v_rcp_f32 v184, v184
    v_mfma_f32_16x16x32_bf16 v[204:207], v[68:71], v[80:83], v[204:207]
    ds_read_b64_tr_b16 v[120:121], v12 offset:20480
    ds_read_b64_tr_b16 v[122:123], v12 offset:22528
    v_rcp_f32 v188, v188
    ds_read_b64_tr_b16 v[128:129], v18 offset:53248
    ds_read_b64_tr_b16 v[130:131], v18 offset:55296
    v_rcp_f32 v192, v192
    v_mfma_f32_16x16x32_bf16 v[196:199], v[84:87], v[92:95], v[196:199]
    v_mul_f32 v20, v20, v180
    v_mul_f32 v21, v21, v180
    v_mfma_f32_16x16x32_bf16 v[200:203], v[88:91], v[92:95], v[200:203]
    v_mul_f32 v22, v22, v180
    v_mul_f32 v23, v23, v180
    v_mfma_f32_16x16x32_bf16 v[208:211], v[88:91], v[96:99], v[208:211]
    v_cvt_pk_bf16_f32 v164, v20, v21
    v_cvt_pk_bf16_f32 v165, v22, v23
    v_mfma_f32_16x16x32_bf16 v[204:207], v[84:87], v[96:99], v[204:207]
    v_mul_f32 v28, v28, v188
    v_mul_f32 v29, v29, v188
    s_waitcnt lgkmcnt(0)
    s_barrier
    v_mfma_f32_16x16x32_bf16 v[196:199], v[100:103], v[108:111], v[196:199]
    ds_read_b64_tr_b16 v[68:69], v10 offset:24576
    ds_read_b64_tr_b16 v[70:71], v10 offset:26624
    v_mul_f32 v30, v30, v188
    ds_read_b64_tr_b16 v[76:77], v16 offset:16384
    ds_read_b64_tr_b16 v[78:79], v16 offset:18432
    v_mul_f32 v31, v31, v188
    v_mfma_f32_16x16x32_bf16 v[200:203], v[104:107], v[108:111], v[200:203]
    ds_read_b64_tr_b16 v[72:73], v12 offset:24576
    ds_read_b64_tr_b16 v[74:75], v12 offset:26624
    v_cvt_pk_bf16_f32 v166, v28, v29
    ds_read_b64_tr_b16 v[80:81], v19 offset:16384
    ds_read_b64_tr_b16 v[82:83], v19 offset:18432
    v_cvt_pk_bf16_f32 v167, v30, v31
    v_mfma_f32_16x16x32_bf16 v[208:211], v[104:107], v[112:115], v[208:211]
    ds_read_b64_tr_b16 v[84:85], v10 offset:28672
    ds_read_b64_tr_b16 v[86:87], v10 offset:30720
    buffer_store_dwordx4 v[164:167], v4, s[40:43], s72 offen offset:0 sc1
    ds_read_b64_tr_b16 v[92:93], v16 offset:20480
    ds_read_b64_tr_b16 v[94:95], v16 offset:22528
    v_mul_f32 v24, v24, v184
    v_mfma_f32_16x16x32_bf16 v[204:207], v[100:103], v[112:115], v[204:207]
    ds_read_b64_tr_b16 v[88:89], v12 offset:28672
    ds_read_b64_tr_b16 v[90:91], v12 offset:30720
    v_mul_f32 v25, v25, v184
    ds_read_b64_tr_b16 v[96:97], v19 offset:20480
    ds_read_b64_tr_b16 v[98:99], v19 offset:22528
    v_mul_f32 v26, v26, v184
    v_mfma_f32_16x16x32_bf16 v[196:199], v[116:119], v[124:127], v[196:199]
    v_mul_f32 v27, v27, v184
    v_cvt_pk_bf16_f32 v168, v24, v25
    v_mfma_f32_16x16x32_bf16 v[200:203], v[120:123], v[124:127], v[200:203]
    v_cvt_pk_bf16_f32 v169, v26, v27
    v_mul_f32 v32, v32, v192
    v_mfma_f32_16x16x32_bf16 v[208:211], v[120:123], v[128:131], v[208:211]
    v_mul_f32 v33, v33, v192
    v_mul_f32 v34, v34, v192
    v_mfma_f32_16x16x32_bf16 v[204:207], v[116:119], v[128:131], v[204:207]
    v_mul_f32 v35, v35, v192
    v_cvt_pk_bf16_f32 v170, v32, v33
    s_waitcnt lgkmcnt(0)
    s_barrier
    v_mfma_f32_16x16x32_bf16 v[196:199], v[68:71], v[76:79], v[196:199]
    ds_read_b64_tr_b16 v[100:101], v10 offset:32768
    ds_read_b64_tr_b16 v[102:103], v10 offset:34816
    ds_read_b64_tr_b16 v[108:109], v16 offset:8192
    ds_read_b64_tr_b16 v[110:111], v16 offset:10240
    v_mfma_f32_16x16x32_bf16 v[200:203], v[72:75], v[76:79], v[200:203]
    ds_read_b64_tr_b16 v[104:105], v12 offset:32768
    ds_read_b64_tr_b16 v[106:107], v12 offset:34816
    ds_read_b64_tr_b16 v[112:113], v19 offset:8192
    ds_read_b64_tr_b16 v[114:115], v19 offset:10240
    v_mfma_f32_16x16x32_bf16 v[208:211], v[72:75], v[80:83], v[208:211]
    ds_read_b64_tr_b16 v[116:117], v10 offset:36864
    ds_read_b64_tr_b16 v[118:119], v10 offset:38912
    ds_read_b64_tr_b16 v[124:125], v16 offset:12288
    ds_read_b64_tr_b16 v[126:127], v16 offset:14336
    v_mfma_f32_16x16x32_bf16 v[204:207], v[68:71], v[80:83], v[204:207]
    ds_read_b64_tr_b16 v[120:121], v12 offset:36864
    ds_read_b64_tr_b16 v[122:123], v12 offset:38912
    ds_read_b64_tr_b16 v[128:129], v19 offset:12288
    ds_read_b64_tr_b16 v[130:131], v19 offset:14336
    v_cvt_pk_bf16_f32 v171, v34, v35
    v_mfma_f32_16x16x32_bf16 v[196:199], v[84:87], v[92:95], v[196:199]
    v_mfma_f32_16x16x32_bf16 v[200:203], v[88:91], v[92:95], v[200:203]
    v_mfma_f32_16x16x32_bf16 v[208:211], v[88:91], v[96:99], v[208:211]
    v_mfma_f32_16x16x32_bf16 v[204:207], v[84:87], v[96:99], v[204:207]
    buffer_store_dwordx4 v[168:171], v4, s[40:43], s72 offen offset:1024 sc1
    s_waitcnt lgkmcnt(0)
    s_barrier
    v_mfma_f32_16x16x32_bf16 v[196:199], v[100:103], v[108:111], v[196:199]
    ds_read_b64_tr_b16 v[68:69], v10 offset:40960
    ds_read_b64_tr_b16 v[70:71], v10 offset:43008
    ds_read_b64_tr_b16 v[76:77], v16 offset:0
    ds_read_b64_tr_b16 v[78:79], v16 offset:2048
    v_mfma_f32_16x16x32_bf16 v[200:203], v[104:107], v[108:111], v[200:203]
    ds_read_b64_tr_b16 v[72:73], v12 offset:40960
    ds_read_b64_tr_b16 v[74:75], v12 offset:43008
    ds_read_b64_tr_b16 v[80:81], v19 offset:0
    ds_read_b64_tr_b16 v[82:83], v19 offset:2048
    v_mfma_f32_16x16x32_bf16 v[208:211], v[104:107], v[112:115], v[208:211]
    ds_read_b64_tr_b16 v[84:85], v10 offset:45056
    ds_read_b64_tr_b16 v[86:87], v10 offset:47104
    ds_read_b64_tr_b16 v[92:93], v16 offset:4096
    ds_read_b64_tr_b16 v[94:95], v16 offset:6144
    v_mfma_f32_16x16x32_bf16 v[204:207], v[100:103], v[112:115], v[204:207]
    ds_read_b64_tr_b16 v[88:89], v12 offset:45056
    ds_read_b64_tr_b16 v[90:91], v12 offset:47104
    ds_read_b64_tr_b16 v[96:97], v19 offset:4096
    ds_read_b64_tr_b16 v[98:99], v19 offset:6144
    v_mfma_f32_16x16x32_bf16 v[196:199], v[116:119], v[124:127], v[196:199]
    v_mfma_f32_16x16x32_bf16 v[200:203], v[120:123], v[124:127], v[200:203]
    v_mfma_f32_16x16x32_bf16 v[208:211], v[120:123], v[128:131], v[208:211]
    v_mfma_f32_16x16x32_bf16 v[204:207], v[116:119], v[128:131], v[204:207]
    s_waitcnt lgkmcnt(0)
    s_barrier
    v_mfma_f32_16x16x32_bf16 v[196:199], v[68:71], v[76:79], v[196:199]
    ds_read_b64_tr_b16 v[100:101], v10 offset:0
    ds_read_b64_tr_b16 v[102:103], v10 offset:2048
    ds_read_b64_tr_b16 v[108:109], v15 offset:57344
    ds_read_b64_tr_b16 v[110:111], v15 offset:59392
    v_mfma_f32_16x16x32_bf16 v[200:203], v[72:75], v[76:79], v[200:203]
    ds_read_b64_tr_b16 v[104:105], v12 offset:0
    ds_read_b64_tr_b16 v[106:107], v12 offset:2048
    ds_read_b64_tr_b16 v[112:113], v18 offset:57344
    ds_read_b64_tr_b16 v[114:115], v18 offset:59392
    v_mfma_f32_16x16x32_bf16 v[208:211], v[72:75], v[80:83], v[208:211]
    ds_read_b64_tr_b16 v[116:117], v10 offset:4096
    ds_read_b64_tr_b16 v[118:119], v10 offset:6144
    ds_read_b64_tr_b16 v[124:125], v15 offset:61440
    ds_read_b64_tr_b16 v[126:127], v15 offset:63488
    v_mfma_f32_16x16x32_bf16 v[204:207], v[68:71], v[80:83], v[204:207]
    ds_read_b64_tr_b16 v[120:121], v12 offset:4096
    ds_read_b64_tr_b16 v[122:123], v12 offset:6144
    ds_read_b64_tr_b16 v[128:129], v18 offset:61440
    ds_read_b64_tr_b16 v[130:131], v18 offset:63488
    v_mfma_f32_16x16x32_bf16 v[196:199], v[84:87], v[92:95], v[196:199]
    v_mfma_f32_16x16x32_bf16 v[200:203], v[88:91], v[92:95], v[200:203]
    v_mfma_f32_16x16x32_bf16 v[208:211], v[88:91], v[96:99], v[208:211]
    v_mfma_f32_16x16x32_bf16 v[204:207], v[84:87], v[96:99], v[204:207]
    s_waitcnt vmcnt(0)
    s_waitcnt lgkmcnt(0)
    s_barrier
    v_mfma_f32_16x16x32_bf16 v[196:199], v[100:103], v[108:111], v[196:199]
    ds_read_b64_tr_b16 v[68:69], v10 offset:8192
    ds_read_b64_tr_b16 v[70:71], v10 offset:10240
    ds_read_b64_tr_b16 v[76:77], v15 offset:49152
    ds_read_b64_tr_b16 v[78:79], v15 offset:51200
    v_mfma_f32_16x16x32_bf16 v[200:203], v[104:107], v[108:111], v[200:203]
    ds_read_b64_tr_b16 v[72:73], v12 offset:8192
    ds_read_b64_tr_b16 v[74:75], v12 offset:10240
    ds_read_b64_tr_b16 v[80:81], v18 offset:49152
    ds_read_b64_tr_b16 v[82:83], v18 offset:51200
    v_mfma_f32_16x16x32_bf16 v[208:211], v[104:107], v[112:115], v[208:211]
    ds_read_b64_tr_b16 v[84:85], v10 offset:12288
    ds_read_b64_tr_b16 v[86:87], v10 offset:14336
    ds_read_b64_tr_b16 v[92:93], v15 offset:53248
    ds_read_b64_tr_b16 v[94:95], v15 offset:55296
    v_mfma_f32_16x16x32_bf16 v[204:207], v[100:103], v[112:115], v[204:207]
    ds_read_b64_tr_b16 v[88:89], v12 offset:12288
    ds_read_b64_tr_b16 v[90:91], v12 offset:14336
    ds_read_b64_tr_b16 v[96:97], v18 offset:53248
    ds_read_b64_tr_b16 v[98:99], v18 offset:55296
    v_mfma_f32_16x16x32_bf16 v[196:199], v[116:119], v[124:127], v[196:199]
    v_mfma_f32_16x16x32_bf16 v[200:203], v[120:123], v[124:127], v[200:203]
    v_mfma_f32_16x16x32_bf16 v[208:211], v[120:123], v[128:131], v[208:211]
    v_mfma_f32_16x16x32_bf16 v[204:207], v[116:119], v[128:131], v[204:207]
    s_waitcnt lgkmcnt(0)
    s_barrier
    v_mfma_f32_16x16x32_bf16 v[196:199], v[68:71], v[76:79], v[196:199]
    ds_read_b64_tr_b16 v[100:101], v10 offset:16384
    ds_read_b64_tr_b16 v[102:103], v10 offset:18432
    ds_read_b64_tr_b16 v[108:109], v16 offset:16384
    ds_read_b64_tr_b16 v[110:111], v16 offset:18432
    v_mfma_f32_16x16x32_bf16 v[200:203], v[72:75], v[76:79], v[200:203]
    ds_read_b64_tr_b16 v[104:105], v12 offset:16384
    ds_read_b64_tr_b16 v[106:107], v12 offset:18432
    ds_read_b64_tr_b16 v[112:113], v19 offset:16384
    ds_read_b64_tr_b16 v[114:115], v19 offset:18432
    v_mfma_f32_16x16x32_bf16 v[208:211], v[72:75], v[80:83], v[208:211]
    ds_read_b64_tr_b16 v[116:117], v10 offset:20480
    ds_read_b64_tr_b16 v[118:119], v10 offset:22528
    ds_read_b64_tr_b16 v[124:125], v16 offset:20480
    ds_read_b64_tr_b16 v[126:127], v16 offset:22528
    v_mfma_f32_16x16x32_bf16 v[204:207], v[68:71], v[80:83], v[204:207]
    ds_read_b64_tr_b16 v[120:121], v12 offset:20480
    ds_read_b64_tr_b16 v[122:123], v12 offset:22528
    ds_read_b64_tr_b16 v[128:129], v19 offset:20480
    ds_read_b64_tr_b16 v[130:131], v19 offset:22528
    v_mfma_f32_16x16x32_bf16 v[196:199], v[84:87], v[92:95], v[196:199]
    v_mfma_f32_16x16x32_bf16 v[200:203], v[88:91], v[92:95], v[200:203]
    v_mfma_f32_16x16x32_bf16 v[208:211], v[88:91], v[96:99], v[208:211]
    v_mfma_f32_16x16x32_bf16 v[204:207], v[84:87], v[96:99], v[204:207]
    s_waitcnt lgkmcnt(0)
    s_barrier
    v_mfma_f32_16x16x32_bf16 v[196:199], v[100:103], v[108:111], v[196:199]
    ds_read_b64_tr_b16 v[68:69], v10 offset:24576
    ds_read_b64_tr_b16 v[70:71], v10 offset:26624
    ds_read_b64_tr_b16 v[76:77], v16 offset:8192
    ds_read_b64_tr_b16 v[78:79], v16 offset:10240
    v_mfma_f32_16x16x32_bf16 v[200:203], v[104:107], v[108:111], v[200:203]
    ds_read_b64_tr_b16 v[72:73], v12 offset:24576
    ds_read_b64_tr_b16 v[74:75], v12 offset:26624
    ds_read_b64_tr_b16 v[80:81], v19 offset:8192
    ds_read_b64_tr_b16 v[82:83], v19 offset:10240
    v_mfma_f32_16x16x32_bf16 v[208:211], v[104:107], v[112:115], v[208:211]
    ds_read_b64_tr_b16 v[84:85], v10 offset:28672
    ds_read_b64_tr_b16 v[86:87], v10 offset:30720
    ds_read_b64_tr_b16 v[92:93], v16 offset:12288
    ds_read_b64_tr_b16 v[94:95], v16 offset:14336
    v_mfma_f32_16x16x32_bf16 v[204:207], v[100:103], v[112:115], v[204:207]
    ds_read_b64_tr_b16 v[88:89], v12 offset:28672
    ds_read_b64_tr_b16 v[90:91], v12 offset:30720
    ds_read_b64_tr_b16 v[96:97], v19 offset:12288
    ds_read_b64_tr_b16 v[98:99], v19 offset:14336
    v_mfma_f32_16x16x32_bf16 v[196:199], v[116:119], v[124:127], v[196:199]
    v_mfma_f32_16x16x32_bf16 v[200:203], v[120:123], v[124:127], v[200:203]
    v_mfma_f32_16x16x32_bf16 v[208:211], v[120:123], v[128:131], v[208:211]
    v_mfma_f32_16x16x32_bf16 v[204:207], v[116:119], v[128:131], v[204:207]
    s_waitcnt lgkmcnt(0)
    s_barrier
    v_mfma_f32_16x16x32_bf16 v[196:199], v[68:71], v[76:79], v[196:199]
    ds_read_b64_tr_b16 v[100:101], v10 offset:32768
    ds_read_b64_tr_b16 v[102:103], v10 offset:34816
    ds_read_b64_tr_b16 v[108:109], v16 offset:0
    ds_read_b64_tr_b16 v[110:111], v16 offset:2048
    v_mfma_f32_16x16x32_bf16 v[200:203], v[72:75], v[76:79], v[200:203]
    ds_read_b64_tr_b16 v[104:105], v12 offset:32768
    ds_read_b64_tr_b16 v[106:107], v12 offset:34816
    ds_read_b64_tr_b16 v[112:113], v19 offset:0
    ds_read_b64_tr_b16 v[114:115], v19 offset:2048
    v_mfma_f32_16x16x32_bf16 v[208:211], v[72:75], v[80:83], v[208:211]
    ds_read_b64_tr_b16 v[116:117], v10 offset:36864
    ds_read_b64_tr_b16 v[118:119], v10 offset:38912
    ds_read_b64_tr_b16 v[124:125], v16 offset:4096
    ds_read_b64_tr_b16 v[126:127], v16 offset:6144
    v_mfma_f32_16x16x32_bf16 v[204:207], v[68:71], v[80:83], v[204:207]
    ds_read_b64_tr_b16 v[120:121], v12 offset:36864
    ds_read_b64_tr_b16 v[122:123], v12 offset:38912
    ds_read_b64_tr_b16 v[128:129], v19 offset:4096
    ds_read_b64_tr_b16 v[130:131], v19 offset:6144
    v_mfma_f32_16x16x32_bf16 v[196:199], v[84:87], v[92:95], v[196:199]
    v_mfma_f32_16x16x32_bf16 v[200:203], v[88:91], v[92:95], v[200:203]
    v_mfma_f32_16x16x32_bf16 v[208:211], v[88:91], v[96:99], v[208:211]
    v_mfma_f32_16x16x32_bf16 v[204:207], v[84:87], v[96:99], v[204:207]
    s_waitcnt lgkmcnt(0)
    s_barrier
    v_mfma_f32_16x16x32_bf16 v[196:199], v[100:103], v[108:111], v[196:199]
    ds_read_b64_tr_b16 v[68:69], v10 offset:0
    ds_read_b64_tr_b16 v[70:71], v10 offset:2048
    ds_read_b64_tr_b16 v[76:77], v15 offset:57344
    ds_read_b64_tr_b16 v[78:79], v15 offset:59392
    v_mfma_f32_16x16x32_bf16 v[200:203], v[104:107], v[108:111], v[200:203]
    ds_read_b64_tr_b16 v[72:73], v12 offset:0
    ds_read_b64_tr_b16 v[74:75], v12 offset:2048
    ds_read_b64_tr_b16 v[80:81], v18 offset:57344
    ds_read_b64_tr_b16 v[82:83], v18 offset:59392
    v_mfma_f32_16x16x32_bf16 v[208:211], v[104:107], v[112:115], v[208:211]
    ds_read_b64_tr_b16 v[84:85], v10 offset:4096
    ds_read_b64_tr_b16 v[86:87], v10 offset:6144
    ds_read_b64_tr_b16 v[92:93], v15 offset:61440
    ds_read_b64_tr_b16 v[94:95], v15 offset:63488
    v_mfma_f32_16x16x32_bf16 v[204:207], v[100:103], v[112:115], v[204:207]
    ds_read_b64_tr_b16 v[88:89], v12 offset:4096
    ds_read_b64_tr_b16 v[90:91], v12 offset:6144
    ds_read_b64_tr_b16 v[96:97], v18 offset:61440
    ds_read_b64_tr_b16 v[98:99], v18 offset:63488
    v_mfma_f32_16x16x32_bf16 v[196:199], v[116:119], v[124:127], v[196:199]
    v_mfma_f32_16x16x32_bf16 v[200:203], v[120:123], v[124:127], v[200:203]
    v_mfma_f32_16x16x32_bf16 v[208:211], v[120:123], v[128:131], v[208:211]
    v_mfma_f32_16x16x32_bf16 v[204:207], v[116:119], v[128:131], v[204:207]
    s_waitcnt lgkmcnt(0)
    s_barrier
    v_mfma_f32_16x16x32_bf16 v[196:199], v[68:71], v[76:79], v[196:199]
    ds_read_b64_tr_b16 v[100:101], v10 offset:8192
    ds_read_b64_tr_b16 v[102:103], v10 offset:10240
    ds_read_b64_tr_b16 v[108:109], v15 offset:49152
    ds_read_b64_tr_b16 v[110:111], v15 offset:51200
    v_mfma_f32_16x16x32_bf16 v[200:203], v[72:75], v[76:79], v[200:203]
    ds_read_b64_tr_b16 v[104:105], v12 offset:8192
    ds_read_b64_tr_b16 v[106:107], v12 offset:10240
    ds_read_b64_tr_b16 v[112:113], v18 offset:49152
    ds_read_b64_tr_b16 v[114:115], v18 offset:51200
    v_mfma_f32_16x16x32_bf16 v[208:211], v[72:75], v[80:83], v[208:211]
    ds_read_b64_tr_b16 v[116:117], v10 offset:12288
    ds_read_b64_tr_b16 v[118:119], v10 offset:14336
    ds_read_b64_tr_b16 v[124:125], v15 offset:53248
    ds_read_b64_tr_b16 v[126:127], v15 offset:55296
    v_mfma_f32_16x16x32_bf16 v[204:207], v[68:71], v[80:83], v[204:207]
    ds_read_b64_tr_b16 v[120:121], v12 offset:12288
    ds_read_b64_tr_b16 v[122:123], v12 offset:14336
    ds_read_b64_tr_b16 v[128:129], v18 offset:53248
    ds_read_b64_tr_b16 v[130:131], v18 offset:55296
    v_mfma_f32_16x16x32_bf16 v[196:199], v[84:87], v[92:95], v[196:199]
    v_mfma_f32_16x16x32_bf16 v[200:203], v[88:91], v[92:95], v[200:203]
    v_mfma_f32_16x16x32_bf16 v[208:211], v[88:91], v[96:99], v[208:211]
    v_mfma_f32_16x16x32_bf16 v[204:207], v[84:87], v[96:99], v[204:207]
    s_waitcnt lgkmcnt(0)
    v_mfma_f32_16x16x32_bf16 v[196:199], v[100:103], v[108:111], v[196:199]
    v_mfma_f32_16x16x32_bf16 v[200:203], v[104:107], v[108:111], v[200:203]
    v_mfma_f32_16x16x32_bf16 v[208:211], v[104:107], v[112:115], v[208:211]
    v_mfma_f32_16x16x32_bf16 v[204:207], v[100:103], v[112:115], v[204:207]
    v_mfma_f32_16x16x32_bf16 v[196:199], v[116:119], v[124:127], v[196:199]
    v_mfma_f32_16x16x32_bf16 v[200:203], v[120:123], v[124:127], v[200:203]
    v_mfma_f32_16x16x32_bf16 v[208:211], v[120:123], v[128:131], v[208:211]
    v_mfma_f32_16x16x32_bf16 v[204:207], v[116:119], v[128:131], v[204:207]
    s_mul_i32 s15, s7, 229376
    s_lshl_b32 s69, s8, 13
    s_add_u32 s15, s15, s69
    s_lshl_b32 s69, s11, 12
    s_add_u32 s15, s15, s69
    s_lshl_b32 s69, s12, 11
    s_add_u32 s15, s15, s69
    s_add_u32 s15, s15, 0x220000
    s_mov_b32 s76, 0xbdd2d3e8
    s_mov_b32 s77, 0xbdd2d3e8
    v_mov_b32 v2, 0xc0135761
    v_mov_b32 v3, 0xc0135761
    v_pk_mul_f32 v[164:165], v[196:197], v[196:197]
    v_pk_mul_f32 v[166:167], v[198:199], v[198:199]
    v_pk_mul_f32 v[168:169], v[200:201], v[200:201]
    v_pk_mul_f32 v[170:171], v[202:203], v[202:203]
    v_pk_mul_f32 v[172:173], v[204:205], v[204:205]
    v_pk_mul_f32 v[174:175], v[206:207], v[206:207]
    v_pk_mul_f32 v[176:177], v[208:209], v[208:209]
    v_pk_mul_f32 v[178:179], v[210:211], v[210:211]
    v_pk_fma_f32 v[164:165], v[164:165], s[76:77], v[2:3]
    v_pk_fma_f32 v[166:167], v[166:167], s[76:77], v[2:3]
    v_pk_fma_f32 v[168:169], v[168:169], s[76:77], v[2:3]
    v_pk_fma_f32 v[170:171], v[170:171], s[76:77], v[2:3]
    v_pk_fma_f32 v[172:173], v[172:173], s[76:77], v[2:3]
    v_pk_fma_f32 v[174:175], v[174:175], s[76:77], v[2:3]
    v_pk_fma_f32 v[176:177], v[176:177], s[76:77], v[2:3]
    v_pk_fma_f32 v[178:179], v[178:179], s[76:77], v[2:3]
    v_pk_mul_f32 v[164:165], v[164:165], v[196:197]
    v_pk_mul_f32 v[166:167], v[166:167], v[198:199]
    v_pk_mul_f32 v[168:169], v[168:169], v[200:201]
    v_pk_mul_f32 v[170:171], v[170:171], v[202:203]
    v_pk_mul_f32 v[172:173], v[172:173], v[204:205]
    v_pk_mul_f32 v[174:175], v[174:175], v[206:207]
    v_pk_mul_f32 v[176:177], v[176:177], v[208:209]
    v_pk_mul_f32 v[178:179], v[178:179], v[210:211]
    v_exp_f32 v164, v164
    v_exp_f32 v165, v165
    v_exp_f32 v166, v166
    v_exp_f32 v167, v167
    v_exp_f32 v168, v168
    v_exp_f32 v169, v169
    v_exp_f32 v170, v170
    v_exp_f32 v171, v171
    v_exp_f32 v172, v172
    v_exp_f32 v173, v173
    v_exp_f32 v174, v174
    v_exp_f32 v175, v175
    v_exp_f32 v176, v176
    v_exp_f32 v177, v177
    v_exp_f32 v178, v178
    v_exp_f32 v179, v179
    v_pk_add_f32 v[164:165], v[164:165], 1.0 op_sel_hi:[1,0]
    v_pk_add_f32 v[166:167], v[166:167], 1.0 op_sel_hi:[1,0]
    v_pk_add_f32 v[168:169], v[168:169], 1.0 op_sel_hi:[1,0]
    v_pk_add_f32 v[170:171], v[170:171], 1.0 op_sel_hi:[1,0]
    v_pk_add_f32 v[172:173], v[172:173], 1.0 op_sel_hi:[1,0]
    v_pk_add_f32 v[174:175], v[174:175], 1.0 op_sel_hi:[1,0]
    v_pk_add_f32 v[176:177], v[176:177], 1.0 op_sel_hi:[1,0]
    v_pk_add_f32 v[178:179], v[178:179], 1.0 op_sel_hi:[1,0]
    v_rcp_f32 v164, v164
    v_rcp_f32 v165, v165
    v_rcp_f32 v166, v166
    v_rcp_f32 v167, v167
    v_rcp_f32 v168, v168
    v_rcp_f32 v169, v169
    v_rcp_f32 v170, v170
    v_rcp_f32 v171, v171
    v_rcp_f32 v172, v172
    v_rcp_f32 v173, v173
    v_rcp_f32 v174, v174
    v_rcp_f32 v175, v175
    v_rcp_f32 v176, v176
    v_rcp_f32 v177, v177
    v_rcp_f32 v178, v178
    v_rcp_f32 v179, v179
    v_pk_mul_f32 v[164:165], v[164:165], v[196:197]
    v_pk_mul_f32 v[166:167], v[166:167], v[198:199]
    v_pk_mul_f32 v[168:169], v[168:169], v[200:201]
    v_pk_mul_f32 v[170:171], v[170:171], v[202:203]
    v_pk_mul_f32 v[172:173], v[172:173], v[204:205]
    v_pk_mul_f32 v[174:175], v[174:175], v[206:207]
    v_pk_mul_f32 v[176:177], v[176:177], v[208:209]
    v_pk_mul_f32 v[178:179], v[178:179], v[210:211]
    v_cvt_pk_bf16_f32 v212, v164, v165
    v_cvt_pk_bf16_f32 v213, v166, v167
    v_cvt_pk_bf16_f32 v214, v168, v169
    v_cvt_pk_bf16_f32 v215, v170, v171
    v_cvt_pk_bf16_f32 v216, v172, v173
    v_cvt_pk_bf16_f32 v217, v174, v175
    v_cvt_pk_bf16_f32 v218, v176, v177
    v_cvt_pk_bf16_f32 v219, v178, v179
    buffer_store_dwordx4 v[212:215], v4, s[40:43], s15 offen sc1
    buffer_store_dwordx4 v[216:219], v4, s[40:43], s15 offen offset:1024 sc1
    s_barrier
c_q:
    s_add_u32 s62, s62, 0x800000
    s_add_u32 s63, s63, 0x800000
    s_waitcnt vmcnt(0)
    s_waitcnt lgkmcnt(0)
    s_barrier
    ds_read_b64_tr_b16 v[68:69], v10 offset:16384
    ds_read_b64_tr_b16 v[70:71], v10 offset:18432
    ds_read_b128 v[76:79], v243 offset:16384
    ds_read_b64_tr_b16 v[72:73], v12 offset:16384
    ds_read_b64_tr_b16 v[74:75], v12 offset:18432
    ds_read_b128 v[80:83], v243 offset:17408
    ds_read_b64_tr_b16 v[84:85], v10 offset:20480
    ds_read_b64_tr_b16 v[86:87], v10 offset:22528
    ds_read_b128 v[92:95], v243 offset:20480
    ds_read_b64_tr_b16 v[88:89], v12 offset:20480
    ds_read_b64_tr_b16 v[90:91], v12 offset:22528
    ds_read_b128 v[96:99], v243 offset:21504
    s_waitcnt lgkmcnt(0)
    s_barrier
    v_mfma_f32_16x16x32_bf16 v[36:39], v[68:71], v[76:79], 0
    ds_read_b64_tr_b16 v[100:101], v10 offset:24576
    ds_read_b64_tr_b16 v[102:103], v10 offset:26624
    ds_read_b128 v[108:111], v243 offset:8192
    v_mfma_f32_16x16x32_bf16 v[40:43], v[72:75], v[76:79], 0
    ds_read_b64_tr_b16 v[104:105], v12 offset:24576
    ds_read_b64_tr_b16 v[106:107], v12 offset:26624
    ds_read_b128 v[112:115], v243 offset:9216
    v_mfma_f32_16x16x32_bf16 v[48:51], v[72:75], v[80:83], 0
    ds_read_b64_tr_b16 v[116:117], v10 offset:28672
    ds_read_b64_tr_b16 v[118:119], v10 offset:30720
    ds_read_b128 v[124:127], v243 offset:12288
    v_mfma_f32_16x16x32_bf16 v[44:47], v[68:71], v[80:83], 0
    ds_read_b64_tr_b16 v[120:121], v12 offset:28672
    ds_read_b64_tr_b16 v[122:123], v12 offset:30720
    ds_read_b128 v[128:131], v243 offset:13312
    v_mfma_f32_16x16x32_bf16 v[36:39], v[84:87], v[92:95], v[36:39]
    v_mfma_f32_16x16x32_bf16 v[40:43], v[88:91], v[92:95], v[40:43]
    v_mfma_f32_16x16x32_bf16 v[48:51], v[88:91], v[96:99], v[48:51]
    v_mfma_f32_16x16x32_bf16 v[44:47], v[84:87], v[96:99], v[44:47]
    s_waitcnt lgkmcnt(0)
    s_barrier
    v_mfma_f32_16x16x32_bf16 v[36:39], v[100:103], v[108:111], v[36:39]
    ds_read_b64_tr_b16 v[68:69], v10 offset:0
    ds_read_b64_tr_b16 v[70:71], v10 offset:2048
    ds_read_b128 v[76:79], v243 offset:0
    v_mfma_f32_16x16x32_bf16 v[40:43], v[104:107], v[108:111], v[40:43]
    ds_read_b64_tr_b16 v[72:73], v12 offset:0
    ds_read_b64_tr_b16 v[74:75], v12 offset:2048
    ds_read_b128 v[80:83], v243 offset:1024
    v_mfma_f32_16x16x32_bf16 v[48:51], v[104:107], v[112:115], v[48:51]
    ds_read_b64_tr_b16 v[84:85], v10 offset:4096
    ds_read_b64_tr_b16 v[86:87], v10 offset:6144
    ds_read_b128 v[92:95], v243 offset:4096
    v_mfma_f32_16x16x32_bf16 v[44:47], v[100:103], v[112:115], v[44:47]
    ds_read_b64_tr_b16 v[88:89], v12 offset:4096
    ds_read_b64_tr_b16 v[90:91], v12 offset:6144
    ds_read_b128 v[96:99], v243 offset:5120
    v_mfma_f32_16x16x32_bf16 v[36:39], v[116:119], v[124:127], v[36:39]
    v_mfma_f32_16x16x32_bf16 v[40:43], v[120:123], v[124:127], v[40:43]
    v_mfma_f32_16x16x32_bf16 v[48:51], v[120:123], v[128:131], v[48:51]
    v_mfma_f32_16x16x32_bf16 v[44:47], v[116:119], v[128:131], v[44:47]
    s_waitcnt lgkmcnt(0)
    s_barrier
    v_lshlrev_b32 v2, 3, v5
    s_mov_b32 s15, 0x650000
    buffer_load_dwordx2 v[222:223], v2, s[40:43], s15 offen sc1
    buffer_load_dwordx2 v[220:221], v2, s[40:43], s15 offen offset:128 sc1
    v_lshlrev_b32 v7, 10, v5
    v_lshrrev_b32 v3, 5, v1
    v_lshl_add_u32 v7, v3, 4, v7
    v_bfe_u32 v3, v1, 4, 1
    v_lshl_add_u32 v7, v3, 5, v7
    s_lshl_b32 s15, s7, 7
    s_lshl_b32 s68, s11, 6
    s_add_u32 s15, s15, s68
    s_add_u32 s68, s15, 16384
    v_mfma_f32_16x16x32_bf16 v[36:39], v[68:71], v[76:79], v[36:39]
    ds_read_b64_tr_b16 v[100:101], v10 offset:32768
    ds_read_b64_tr_b16 v[102:103], v10 offset:34816
    ds_read_b128 v[108:111], v242 offset:57344
    v_mfma_f32_16x16x32_bf16 v[40:43], v[72:75], v[76:79], v[40:43]
    ds_read_b64_tr_b16 v[104:105], v12 offset:32768
    ds_read_b64_tr_b16 v[106:107], v12 offset:34816
    ds_read_b128 v[112:115], v242 offset:58368
    v_mfma_f32_16x16x32_bf16 v[48:51], v[72:75], v[80:83], v[48:51]
    ds_read_b64_tr_b16 v[116:117], v10 offset:36864
    ds_read_b64_tr_b16 v[118:119], v10 offset:38912
    ds_read_b128 v[124:127], v242 offset:61440
    v_mfma_f32_16x16x32_bf16 v[44:47], v[68:71], v[80:83], v[44:47]
    ds_read_b64_tr_b16 v[120:121], v12 offset:36864
    ds_read_b64_tr_b16 v[122:123], v12 offset:38912
    ds_read_b128 v[128:131], v242 offset:62464
    v_mfma_f32_16x16x32_bf16 v[36:39], v[84:87], v[92:95], v[36:39]
    v_mfma_f32_16x16x32_bf16 v[40:43], v[88:91], v[92:95], v[40:43]
    v_mfma_f32_16x16x32_bf16 v[48:51], v[88:91], v[96:99], v[48:51]
    v_mfma_f32_16x16x32_bf16 v[44:47], v[84:87], v[96:99], v[44:47]
    s_waitcnt lgkmcnt(0)
    s_barrier
    v_mfma_f32_16x16x32_bf16 v[36:39], v[100:103], v[108:111], v[36:39]
    ds_read_b64_tr_b16 v[68:69], v10 offset:8192
    ds_read_b64_tr_b16 v[70:71], v10 offset:10240
    ds_read_b128 v[76:79], v242 offset:49152
    v_mfma_f32_16x16x32_bf16 v[40:43], v[104:107], v[108:111], v[40:43]
    ds_read_b64_tr_b16 v[72:73], v12 offset:8192
    ds_read_b64_tr_b16 v[74:75], v12 offset:10240
    ds_read_b128 v[80:83], v242 offset:50176
    v_mfma_f32_16x16x32_bf16 v[48:51], v[104:107], v[112:115], v[48:51]
    ds_read_b64_tr_b16 v[84:85], v10 offset:12288
    ds_read_b64_tr_b16 v[86:87], v10 offset:14336
    ds_read_b128 v[92:95], v242 offset:53248
    v_mfma_f32_16x16x32_bf16 v[44:47], v[100:103], v[112:115], v[44:47]
    ds_read_b64_tr_b16 v[88:89], v12 offset:12288
    ds_read_b64_tr_b16 v[90:91], v12 offset:14336
    ds_read_b128 v[96:99], v242 offset:54272
    v_mfma_f32_16x16x32_bf16 v[36:39], v[116:119], v[124:127], v[36:39]
    v_mfma_f32_16x16x32_bf16 v[40:43], v[120:123], v[124:127], v[40:43]
    v_mfma_f32_16x16x32_bf16 v[48:51], v[120:123], v[128:131], v[48:51]
    v_mfma_f32_16x16x32_bf16 v[44:47], v[116:119], v[128:131], v[44:47]
    s_waitcnt lgkmcnt(0)
    s_barrier
    v_mfma_f32_16x16x32_bf16 v[36:39], v[68:71], v[76:79], v[36:39]
    ds_read_b64_tr_b16 v[100:101], v10 offset:40960
    ds_read_b64_tr_b16 v[102:103], v10 offset:43008
    ds_read_b128 v[108:111], v243 offset:16384
    v_mfma_f32_16x16x32_bf16 v[40:43], v[72:75], v[76:79], v[40:43]
    ds_read_b64_tr_b16 v[104:105], v12 offset:40960
    ds_read_b64_tr_b16 v[106:107], v12 offset:43008
    ds_read_b128 v[112:115], v243 offset:17408
    v_mfma_f32_16x16x32_bf16 v[48:51], v[72:75], v[80:83], v[48:51]
    ds_read_b64_tr_b16 v[116:117], v10 offset:45056
    ds_read_b64_tr_b16 v[118:119], v10 offset:47104
    ds_read_b128 v[124:127], v243 offset:20480
    v_mfma_f32_16x16x32_bf16 v[44:47], v[68:71], v[80:83], v[44:47]
    ds_read_b64_tr_b16 v[120:121], v12 offset:45056
    ds_read_b64_tr_b16 v[122:123], v12 offset:47104
    ds_read_b128 v[128:131], v243 offset:21504
    v_mfma_f32_16x16x32_bf16 v[36:39], v[84:87], v[92:95], v[36:39]
    v_mfma_f32_16x16x32_bf16 v[40:43], v[88:91], v[92:95], v[40:43]
    v_mfma_f32_16x16x32_bf16 v[48:51], v[88:91], v[96:99], v[48:51]
    v_mfma_f32_16x16x32_bf16 v[44:47], v[84:87], v[96:99], v[44:47]
    s_waitcnt lgkmcnt(0)
    s_barrier
    v_mfma_f32_16x16x32_bf16 v[36:39], v[100:103], v[108:111], v[36:39]
    ds_read_b64_tr_b16 v[68:69], v10 offset:49152
    ds_read_b64_tr_b16 v[70:71], v10 offset:51200
    ds_read_b128 v[76:79], v243 offset:8192
    v_mfma_f32_16x16x32_bf16 v[40:43], v[104:107], v[108:111], v[40:43]
    ds_read_b64_tr_b16 v[72:73], v12 offset:49152
    ds_read_b64_tr_b16 v[74:75], v12 offset:51200
    ds_read_b128 v[80:83], v243 offset:9216
    v_mfma_f32_16x16x32_bf16 v[48:51], v[104:107], v[112:115], v[48:51]
    ds_read_b64_tr_b16 v[84:85], v10 offset:53248
    ds_read_b64_tr_b16 v[86:87], v10 offset:55296
    ds_read_b128 v[92:95], v243 offset:12288
    v_mfma_f32_16x16x32_bf16 v[44:47], v[100:103], v[112:115], v[44:47]
    ds_read_b64_tr_b16 v[88:89], v12 offset:53248
    ds_read_b64_tr_b16 v[90:91], v12 offset:55296
    ds_read_b128 v[96:99], v243 offset:13312
    v_mfma_f32_16x16x32_bf16 v[36:39], v[116:119], v[124:127], v[36:39]
    v_mfma_f32_16x16x32_bf16 v[40:43], v[120:123], v[124:127], v[40:43]
    v_mfma_f32_16x16x32_bf16 v[48:51], v[120:123], v[128:131], v[48:51]
    v_mfma_f32_16x16x32_bf16 v[44:47], v[116:119], v[128:131], v[44:47]
    s_waitcnt lgkmcnt(0)
    s_barrier
    v_mfma_f32_16x16x32_bf16 v[36:39], v[68:71], v[76:79], v[36:39]
    ds_read_b64_tr_b16 v[100:101], v10 offset:57344
    ds_read_b64_tr_b16 v[102:103], v10 offset:59392
    ds_read_b128 v[108:111], v243 offset:0
    v_mfma_f32_16x16x32_bf16 v[40:43], v[72:75], v[76:79], v[40:43]
    ds_read_b64_tr_b16 v[104:105], v12 offset:57344
    ds_read_b64_tr_b16 v[106:107], v12 offset:59392
    ds_read_b128 v[112:115], v243 offset:1024
    v_mfma_f32_16x16x32_bf16 v[48:51], v[72:75], v[80:83], v[48:51]
    ds_read_b64_tr_b16 v[116:117], v10 offset:61440
    ds_read_b64_tr_b16 v[118:119], v10 offset:63488
    ds_read_b128 v[124:127], v243 offset:4096
    v_mfma_f32_16x16x32_bf16 v[44:47], v[68:71], v[80:83], v[44:47]
    ds_read_b64_tr_b16 v[120:121], v12 offset:61440
    ds_read_b64_tr_b16 v[122:123], v12 offset:63488
    ds_read_b128 v[128:131], v243 offset:5120
    v_mfma_f32_16x16x32_bf16 v[36:39], v[84:87], v[92:95], v[36:39]
    v_mfma_f32_16x16x32_bf16 v[40:43], v[88:91], v[92:95], v[40:43]
    v_mfma_f32_16x16x32_bf16 v[48:51], v[88:91], v[96:99], v[48:51]
    v_mfma_f32_16x16x32_bf16 v[44:47], v[84:87], v[96:99], v[44:47]
    s_waitcnt lgkmcnt(0)
    s_barrier
    v_mfma_f32_16x16x32_bf16 v[36:39], v[100:103], v[108:111], v[36:39]
    ds_read_b64_tr_b16 v[132:133], v15 offset:0
    ds_read_b64_tr_b16 v[134:135], v15 offset:2048
    ds_read_b128 v[140:143], v245 offset:16384
    v_mfma_f32_16x16x32_bf16 v[40:43], v[104:107], v[108:111], v[40:43]
    ds_read_b64_tr_b16 v[136:137], v18 offset:0
    ds_read_b64_tr_b16 v[138:139], v18 offset:2048
    ds_read_b128 v[144:147], v245 offset:17408
    v_mfma_f32_16x16x32_bf16 v[48:51], v[104:107], v[112:115], v[48:51]
    ds_read_b64_tr_b16 v[148:149], v15 offset:4096
    ds_read_b64_tr_b16 v[150:151], v15 offset:6144
    ds_read_b128 v[156:159], v245 offset:20480
    v_mfma_f32_16x16x32_bf16 v[44:47], v[100:103], v[112:115], v[44:47]
    ds_read_b64_tr_b16 v[152:153], v18 offset:4096
    ds_read_b64_tr_b16 v[154:155], v18 offset:6144
    ds_read_b128 v[160:163], v245 offset:21504
    v_mfma_f32_16x16x32_bf16 v[36:39], v[116:119], v[124:127], v[36:39]
    v_mfma_f32_16x16x32_bf16 v[40:43], v[120:123], v[124:127], v[40:43]
    v_mfma_f32_16x16x32_bf16 v[48:51], v[120:123], v[128:131], v[48:51]
    v_mfma_f32_16x16x32_bf16 v[44:47], v[116:119], v[128:131], v[44:47]
    s_waitcnt lgkmcnt(0)
    s_barrier
    v_mfma_f32_16x16x32_bf16 v[52:55], v[140:143], v[132:135], v[52:55]
    ds_read_b64_tr_b16 v[68:69], v14 offset:16384
    ds_read_b64_tr_b16 v[70:71], v14 offset:18432
    ds_read_b128 v[76:79], v244 offset:57344
    v_mfma_f32_16x16x32_bf16 v[56:59], v[144:147], v[132:135], v[56:59]
    ds_read_b64_tr_b16 v[72:73], v17 offset:16384
    ds_read_b64_tr_b16 v[74:75], v17 offset:18432
    ds_read_b128 v[80:83], v244 offset:58368
    v_mfma_f32_16x16x32_bf16 v[64:67], v[144:147], v[136:139], v[64:67]
    ds_read_b64_tr_b16 v[84:85], v14 offset:20480
    ds_read_b64_tr_b16 v[86:87], v14 offset:22528
    ds_read_b128 v[92:95], v244 offset:61440
    v_mfma_f32_16x16x32_bf16 v[60:63], v[140:143], v[136:139], v[60:63]
    ds_read_b64_tr_b16 v[88:89], v17 offset:20480
    ds_read_b64_tr_b16 v[90:91], v17 offset:22528
    ds_read_b128 v[96:99], v244 offset:62464
    v_mfma_f32_16x16x32_bf16 v[52:55], v[156:159], v[148:151], v[52:55]
    v_mfma_f32_16x16x32_bf16 v[56:59], v[160:163], v[148:151], v[56:59]
    v_mfma_f32_16x16x32_bf16 v[64:67], v[160:163], v[152:155], v[64:67]
    v_mfma_f32_16x16x32_bf16 v[60:63], v[156:159], v[152:155], v[60:63]
    s_waitcnt lgkmcnt(0)
    s_barrier
    v_mfma_f32_16x16x32_bf16 v[52:55], v[76:79], v[68:71], v[52:55]
    ds_read_b64_tr_b16 v[132:133], v15 offset:8192
    ds_read_b64_tr_b16 v[134:135], v15 offset:10240
    ds_read_b128 v[140:143], v244 offset:49152
    v_mfma_f32_16x16x32_bf16 v[56:59], v[80:83], v[68:71], v[56:59]
    ds_read_b64_tr_b16 v[136:137], v18 offset:8192
    ds_read_b64_tr_b16 v[138:139], v18 offset:10240
    ds_read_b128 v[144:147], v244 offset:50176
    v_mfma_f32_16x16x32_bf16 v[64:67], v[80:83], v[72:75], v[64:67]
    ds_read_b64_tr_b16 v[148:149], v15 offset:12288
    ds_read_b64_tr_b16 v[150:151], v15 offset:14336
    ds_read_b128 v[156:159], v244 offset:53248
    v_mfma_f32_16x16x32_bf16 v[60:63], v[76:79], v[72:75], v[60:63]
    ds_read_b64_tr_b16 v[152:153], v18 offset:12288
    ds_read_b64_tr_b16 v[154:155], v18 offset:14336
    ds_read_b128 v[160:163], v244 offset:54272
    v_mfma_f32_16x16x32_bf16 v[52:55], v[92:95], v[84:87], v[52:55]
    v_mfma_f32_16x16x32_bf16 v[56:59], v[96:99], v[84:87], v[56:59]
    v_mfma_f32_16x16x32_bf16 v[64:67], v[96:99], v[88:91], v[64:67]
    v_mfma_f32_16x16x32_bf16 v[60:63], v[92:95], v[88:91], v[60:63]
    s_waitcnt lgkmcnt(0)
    s_barrier
    s_waitcnt vmcnt(0)
    v_mfma_f32_16x16x32_bf16 v[52:55], v[140:143], v[132:135], v[52:55]
    ds_read_b64_tr_b16 v[68:69], v14 offset:24576
    ds_read_b64_tr_b16 v[70:71], v14 offset:26624
    v_mul_f32 v36, v222, v36
    ds_read_b128 v[76:79], v244 offset:40960
    v_mul_f32 v37, v222, v37
    v_mfma_f32_16x16x32_bf16 v[56:59], v[144:147], v[132:135], v[56:59]
    ds_read_b64_tr_b16 v[72:73], v17 offset:24576
    ds_read_b64_tr_b16 v[74:75], v17 offset:26624
    v_mul_f32 v38, v222, v38
    ds_read_b128 v[80:83], v244 offset:41984
    v_mul_f32 v39, v222, v39
    v_mfma_f32_16x16x32_bf16 v[64:67], v[144:147], v[136:139], v[64:67]
    ds_read_b64_tr_b16 v[84:85], v14 offset:28672
    ds_read_b64_tr_b16 v[86:87], v14 offset:30720
    v_mul_f32 v40, v222, v40
    ds_read_b128 v[92:95], v244 offset:45056
    v_mul_f32 v41, v222, v41
    v_mfma_f32_16x16x32_bf16 v[60:63], v[140:143], v[136:139], v[60:63]
    ds_read_b64_tr_b16 v[88:89], v17 offset:28672
    ds_read_b64_tr_b16 v[90:91], v17 offset:30720
    v_mul_f32 v42, v222, v42
    ds_read_b128 v[96:99], v244 offset:46080
    v_mul_f32 v43, v222, v43
    v_mfma_f32_16x16x32_bf16 v[52:55], v[156:159], v[148:151], v[52:55]
    v_mul_f32 v44, v220, v44
    v_mul_f32 v45, v220, v45
    v_mfma_f32_16x16x32_bf16 v[56:59], v[160:163], v[148:151], v[56:59]
    v_mul_f32 v46, v220, v46
    v_mul_f32 v47, v220, v47
    v_mfma_f32_16x16x32_bf16 v[64:67], v[160:163], v[152:155], v[64:67]
    v_mul_f32 v48, v220, v48
    v_mul_f32 v49, v220, v49
    v_mfma_f32_16x16x32_bf16 v[60:63], v[156:159], v[152:155], v[60:63]
    v_mul_f32 v50, v220, v50
    v_mul_f32 v51, v220, v51
    s_waitcnt lgkmcnt(0)
    s_barrier
    v_mfma_f32_16x16x32_bf16 v[52:55], v[76:79], v[68:71], v[52:55]
    ds_read_b64_tr_b16 v[132:133], v15 offset:16384
    ds_read_b64_tr_b16 v[134:135], v15 offset:18432
    ds_read_b128 v[140:143], v245 offset:8192
    v_mfma_f32_16x16x32_bf16 v[56:59], v[80:83], v[68:71], v[56:59]
    ds_read_b64_tr_b16 v[136:137], v18 offset:16384
    ds_read_b64_tr_b16 v[138:139], v18 offset:18432
    ds_read_b128 v[144:147], v245 offset:9216
    v_mfma_f32_16x16x32_bf16 v[64:67], v[80:83], v[72:75], v[64:67]
    ds_read_b64_tr_b16 v[148:149], v15 offset:20480
    ds_read_b64_tr_b16 v[150:151], v15 offset:22528
    ds_read_b128 v[156:159], v245 offset:12288
    v_mfma_f32_16x16x32_bf16 v[60:63], v[76:79], v[72:75], v[60:63]
    ds_read_b64_tr_b16 v[152:153], v18 offset:20480
    ds_read_b64_tr_b16 v[154:155], v18 offset:22528
    ds_read_b128 v[160:163], v245 offset:13312
    v_mfma_f32_16x16x32_bf16 v[52:55], v[92:95], v[84:87], v[52:55]
    v_mfma_f32_16x16x32_bf16 v[56:59], v[96:99], v[84:87], v[56:59]
    v_mfma_f32_16x16x32_bf16 v[64:67], v[96:99], v[88:91], v[64:67]
    v_mfma_f32_16x16x32_bf16 v[60:63], v[92:95], v[88:91], v[60:63]
    s_waitcnt lgkmcnt(0)
    s_barrier
    v_mfma_f32_16x16x32_bf16 v[52:55], v[140:143], v[132:135], v[52:55]
    ds_read_b64_tr_b16 v[68:69], v14 offset:0
    ds_read_b64_tr_b16 v[70:71], v14 offset:2048
    ds_read_b128 v[76:79], v245 offset:16384
    v_mfma_f32_16x16x32_bf16 v[56:59], v[144:147], v[132:135], v[56:59]
    ds_read_b64_tr_b16 v[72:73], v17 offset:0
    ds_read_b64_tr_b16 v[74:75], v17 offset:2048
    ds_read_b128 v[80:83], v245 offset:17408
    v_mfma_f32_16x16x32_bf16 v[64:67], v[144:147], v[136:139], v[64:67]
    ds_read_b64_tr_b16 v[84:85], v14 offset:4096
    ds_read_b64_tr_b16 v[86:87], v14 offset:6144
    ds_read_b128 v[92:95], v245 offset:20480
    v_mfma_f32_16x16x32_bf16 v[60:63], v[140:143], v[136:139], v[60:63]
    ds_read_b64_tr_b16 v[88:89], v17 offset:4096
    ds_read_b64_tr_b16 v[90:91], v17 offset:6144
    ds_read_b128 v[96:99], v245 offset:21504
    v_mfma_f32_16x16x32_bf16 v[52:55], v[156:159], v[148:151], v[52:55]
    v_mfma_f32_16x16x32_bf16 v[56:59], v[160:163], v[148:151], v[56:59]
    v_mfma_f32_16x16x32_bf16 v[64:67], v[160:163], v[152:155], v[64:67]
    v_mfma_f32_16x16x32_bf16 v[60:63], v[156:159], v[152:155], v[60:63]
    s_waitcnt lgkmcnt(0)
    s_barrier
    v_mfma_f32_16x16x32_bf16 v[52:55], v[76:79], v[68:71], v[52:55]
    ds_read_b64_tr_b16 v[132:133], v15 offset:24576
    ds_read_b64_tr_b16 v[134:135], v15 offset:26624
    ds_read_b128 v[140:143], v245 offset:0
    v_mfma_f32_16x16x32_bf16 v[56:59], v[80:83], v[68:71], v[56:59]
    ds_read_b64_tr_b16 v[136:137], v18 offset:24576
    ds_read_b64_tr_b16 v[138:139], v18 offset:26624
    ds_read_b128 v[144:147], v245 offset:1024
    v_mfma_f32_16x16x32_bf16 v[64:67], v[80:83], v[72:75], v[64:67]
    ds_read_b64_tr_b16 v[148:149], v15 offset:28672
    ds_read_b64_tr_b16 v[150:151], v15 offset:30720
    ds_read_b128 v[156:159], v245 offset:4096
    v_mfma_f32_16x16x32_bf16 v[60:63], v[76:79], v[72:75], v[60:63]
    ds_read_b64_tr_b16 v[152:153], v18 offset:28672
    ds_read_b64_tr_b16 v[154:155], v18 offset:30720
    ds_read_b128 v[160:163], v245 offset:5120
    v_mfma_f32_16x16x32_bf16 v[52:55], v[92:95], v[84:87], v[52:55]
    v_mfma_f32_16x16x32_bf16 v[56:59], v[96:99], v[84:87], v[56:59]
    v_mfma_f32_16x16x32_bf16 v[64:67], v[96:99], v[88:91], v[64:67]
    v_mfma_f32_16x16x32_bf16 v[60:63], v[92:95], v[88:91], v[60:63]
    s_waitcnt lgkmcnt(0)
    s_barrier
    v_mfma_f32_16x16x32_bf16 v[52:55], v[140:143], v[132:135], v[52:55]
    ds_read_b64_tr_b16 v[68:69], v14 offset:32768
    ds_read_b64_tr_b16 v[70:71], v14 offset:34816
    ds_read_b128 v[76:79], v244 offset:57344
    v_mfma_f32_16x16x32_bf16 v[56:59], v[144:147], v[132:135], v[56:59]
    ds_read_b64_tr_b16 v[72:73], v17 offset:32768
    ds_read_b64_tr_b16 v[74:75], v17 offset:34816
    ds_read_b128 v[80:83], v244 offset:58368
    v_mfma_f32_16x16x32_bf16 v[64:67], v[144:147], v[136:139], v[64:67]
    ds_read_b64_tr_b16 v[84:85], v14 offset:36864
    ds_read_b64_tr_b16 v[86:87], v14 offset:38912
    ds_read_b128 v[92:95], v244 offset:61440
    v_mfma_f32_16x16x32_bf16 v[60:63], v[140:143], v[136:139], v[60:63]
    ds_read_b64_tr_b16 v[88:89], v17 offset:36864
    ds_read_b64_tr_b16 v[90:91], v17 offset:38912
    ds_read_b128 v[96:99], v244 offset:62464
    v_mfma_f32_16x16x32_bf16 v[52:55], v[156:159], v[148:151], v[52:55]
    v_mfma_f32_16x16x32_bf16 v[56:59], v[160:163], v[148:151], v[56:59]
    v_mfma_f32_16x16x32_bf16 v[64:67], v[160:163], v[152:155], v[64:67]
    v_mfma_f32_16x16x32_bf16 v[60:63], v[156:159], v[152:155], v[60:63]
    s_waitcnt lgkmcnt(0)
    s_barrier
    v_mfma_f32_16x16x32_bf16 v[52:55], v[76:79], v[68:71], v[52:55]
    ds_read_b64_tr_b16 v[132:133], v15 offset:32768
    ds_read_b64_tr_b16 v[134:135], v15 offset:34816
    ds_read_b128 v[140:143], v244 offset:49152
    v_mfma_f32_16x16x32_bf16 v[56:59], v[80:83], v[68:71], v[56:59]
    ds_read_b64_tr_b16 v[136:137], v18 offset:32768
    ds_read_b64_tr_b16 v[138:139], v18 offset:34816
    ds_read_b128 v[144:147], v244 offset:50176
    v_mfma_f32_16x16x32_bf16 v[64:67], v[80:83], v[72:75], v[64:67]
    ds_read_b64_tr_b16 v[148:149], v15 offset:36864
    ds_read_b64_tr_b16 v[150:151], v15 offset:38912
    ds_read_b128 v[156:159], v244 offset:53248
    v_mfma_f32_16x16x32_bf16 v[60:63], v[76:79], v[72:75], v[60:63]
    ds_read_b64_tr_b16 v[152:153], v18 offset:36864
    ds_read_b64_tr_b16 v[154:155], v18 offset:38912
    ds_read_b128 v[160:163], v244 offset:54272
    v_mfma_f32_16x16x32_bf16 v[52:55], v[92:95], v[84:87], v[52:55]
    v_mfma_f32_16x16x32_bf16 v[56:59], v[96:99], v[84:87], v[56:59]
    v_mfma_f32_16x16x32_bf16 v[64:67], v[96:99], v[88:91], v[64:67]
    v_mfma_f32_16x16x32_bf16 v[60:63], v[92:95], v[88:91], v[60:63]
    s_waitcnt lgkmcnt(0)
    s_barrier
    v_mfma_f32_16x16x32_bf16 v[52:55], v[140:143], v[132:135], v[52:55]
    ds_read_b64_tr_b16 v[68:69], v14 offset:8192
    ds_read_b64_tr_b16 v[70:71], v14 offset:10240
    ds_read_b128 v[76:79], v245 offset:8192
    v_mfma_f32_16x16x32_bf16 v[56:59], v[144:147], v[132:135], v[56:59]
    ds_read_b64_tr_b16 v[72:73], v17 offset:8192
    ds_read_b64_tr_b16 v[74:75], v17 offset:10240
    ds_read_b128 v[80:83], v245 offset:9216
    v_mfma_f32_16x16x32_bf16 v[64:67], v[144:147], v[136:139], v[64:67]
    ds_read_b64_tr_b16 v[84:85], v14 offset:12288
    ds_read_b64_tr_b16 v[86:87], v14 offset:14336
    ds_read_b128 v[92:95], v245 offset:12288
    v_mfma_f32_16x16x32_bf16 v[60:63], v[140:143], v[136:139], v[60:63]
    ds_read_b64_tr_b16 v[88:89], v17 offset:12288
    ds_read_b64_tr_b16 v[90:91], v17 offset:14336
    ds_read_b128 v[96:99], v245 offset:13312
    v_mfma_f32_16x16x32_bf16 v[52:55], v[156:159], v[148:151], v[52:55]
    v_mfma_f32_16x16x32_bf16 v[56:59], v[160:163], v[148:151], v[56:59]
    v_mfma_f32_16x16x32_bf16 v[64:67], v[160:163], v[152:155], v[64:67]
    v_mfma_f32_16x16x32_bf16 v[60:63], v[156:159], v[152:155], v[60:63]
    s_waitcnt lgkmcnt(0)
    s_barrier
    v_mfma_f32_16x16x32_bf16 v[52:55], v[76:79], v[68:71], v[52:55]
    ds_read_b64_tr_b16 v[132:133], v14 offset:40960
    ds_read_b64_tr_b16 v[134:135], v14 offset:43008
    ds_read_b128 v[140:143], v245 offset:16384
    v_mfma_f32_16x16x32_bf16 v[56:59], v[80:83], v[68:71], v[56:59]
    ds_read_b64_tr_b16 v[136:137], v17 offset:40960
    ds_read_b64_tr_b16 v[138:139], v17 offset:43008
    ds_read_b128 v[144:147], v245 offset:17408
    v_mfma_f32_16x16x32_bf16 v[64:67], v[80:83], v[72:75], v[64:67]
    ds_read_b64_tr_b16 v[148:149], v14 offset:45056
    ds_read_b64_tr_b16 v[150:151], v14 offset:47104
    ds_read_b128 v[156:159], v245 offset:20480
    v_mfma_f32_16x16x32_bf16 v[60:63], v[76:79], v[72:75], v[60:63]
    ds_read_b64_tr_b16 v[152:153], v17 offset:45056
    ds_read_b64_tr_b16 v[154:155], v17 offset:47104
    ds_read_b128 v[160:163], v245 offset:21504
    v_mfma_f32_16x16x32_bf16 v[52:55], v[92:95], v[84:87], v[52:55]
    v_mfma_f32_16x16x32_bf16 v[56:59], v[96:99], v[84:87], v[56:59]
    v_mfma_f32_16x16x32_bf16 v[64:67], v[96:99], v[88:91], v[64:67]
    v_mfma_f32_16x16x32_bf16 v[60:63], v[92:95], v[88:91], v[60:63]
    s_waitcnt lgkmcnt(0)
    s_barrier
    v_mfma_f32_16x16x32_bf16 v[52:55], v[140:143], v[132:135], v[52:55]
    ds_read_b64_tr_b16 v[68:69], v14 offset:49152
    ds_read_b64_tr_b16 v[70:71], v14 offset:51200
    ds_read_b128 v[76:79], v245 offset:0
    v_mfma_f32_16x16x32_bf16 v[56:59], v[144:147], v[132:135], v[56:59]
    ds_read_b64_tr_b16 v[72:73], v17 offset:49152
    ds_read_b64_tr_b16 v[74:75], v17 offset:51200
    ds_read_b128 v[80:83], v245 offset:1024
    v_mfma_f32_16x16x32_bf16 v[64:67], v[144:147], v[136:139], v[64:67]
    ds_read_b64_tr_b16 v[84:85], v14 offset:53248
    ds_read_b64_tr_b16 v[86:87], v14 offset:55296
    ds_read_b128 v[92:95], v245 offset:4096
    v_mfma_f32_16x16x32_bf16 v[60:63], v[140:143], v[136:139], v[60:63]
    ds_read_b64_tr_b16 v[88:89], v17 offset:53248
    ds_read_b64_tr_b16 v[90:91], v17 offset:55296
    ds_read_b128 v[96:99], v245 offset:5120
    v_mfma_f32_16x16x32_bf16 v[52:55], v[156:159], v[148:151], v[52:55]
    v_mfma_f32_16x16x32_bf16 v[56:59], v[160:163], v[148:151], v[56:59]
    v_mfma_f32_16x16x32_bf16 v[64:67], v[160:163], v[152:155], v[64:67]
    v_mfma_f32_16x16x32_bf16 v[60:63], v[156:159], v[152:155], v[60:63]
    s_waitcnt lgkmcnt(0)
    s_barrier
    v_mfma_f32_16x16x32_bf16 v[52:55], v[76:79], v[68:71], v[52:55]
    ds_read_b64_tr_b16 v[132:133], v14 offset:57344
    ds_read_b64_tr_b16 v[134:135], v14 offset:59392
    ds_read_b128 v[140:143], v244 offset:57344
    v_mfma_f32_16x16x32_bf16 v[56:59], v[80:83], v[68:71], v[56:59]
    ds_read_b64_tr_b16 v[136:137], v17 offset:57344
    ds_read_b64_tr_b16 v[138:139], v17 offset:59392
    ds_read_b128 v[144:147], v244 offset:58368
    v_mfma_f32_16x16x32_bf16 v[64:67], v[80:83], v[72:75], v[64:67]
    ds_read_b64_tr_b16 v[148:149], v14 offset:61440
    ds_read_b64_tr_b16 v[150:151], v14 offset:63488
    ds_read_b128 v[156:159], v244 offset:61440
    v_mfma_f32_16x16x32_bf16 v[60:63], v[76:79], v[72:75], v[60:63]
    ds_read_b64_tr_b16 v[152:153], v17 offset:61440
    ds_read_b64_tr_b16 v[154:155], v17 offset:63488
    ds_read_b128 v[160:163], v244 offset:62464
    v_mfma_f32_16x16x32_bf16 v[52:55], v[92:95], v[84:87], v[52:55]
    v_mfma_f32_16x16x32_bf16 v[56:59], v[96:99], v[84:87], v[56:59]
    v_mfma_f32_16x16x32_bf16 v[64:67], v[96:99], v[88:91], v[64:67]
    v_mfma_f32_16x16x32_bf16 v[60:63], v[92:95], v[88:91], v[60:63]
    s_waitcnt lgkmcnt(0)
    s_barrier
    v_mfma_f32_16x16x32_bf16 v[52:55], v[140:143], v[132:135], v[52:55]
    ds_read_b64_tr_b16 v[68:69], v15 offset:0
    ds_read_b64_tr_b16 v[70:71], v15 offset:2048
    ds_read_b128 v[76:79], v244 offset:49152
    v_mfma_f32_16x16x32_bf16 v[56:59], v[144:147], v[132:135], v[56:59]
    ds_read_b64_tr_b16 v[72:73], v18 offset:0
    ds_read_b64_tr_b16 v[74:75], v18 offset:2048
    ds_read_b128 v[80:83], v244 offset:50176
    v_mfma_f32_16x16x32_bf16 v[64:67], v[144:147], v[136:139], v[64:67]
    ds_read_b64_tr_b16 v[84:85], v15 offset:4096
    ds_read_b64_tr_b16 v[86:87], v15 offset:6144
    ds_read_b128 v[92:95], v244 offset:53248
    v_mfma_f32_16x16x32_bf16 v[60:63], v[140:143], v[136:139], v[60:63]
    ds_read_b64_tr_b16 v[88:89], v18 offset:4096
    ds_read_b64_tr_b16 v[90:91], v18 offset:6144
    ds_read_b128 v[96:99], v244 offset:54272
    v_mfma_f32_16x16x32_bf16 v[52:55], v[156:159], v[148:151], v[52:55]
    v_mfma_f32_16x16x32_bf16 v[56:59], v[160:163], v[148:151], v[56:59]
    v_mfma_f32_16x16x32_bf16 v[64:67], v[160:163], v[152:155], v[64:67]
    v_mfma_f32_16x16x32_bf16 v[60:63], v[156:159], v[152:155], v[60:63]
    s_waitcnt lgkmcnt(0)
    s_barrier
    v_mfma_f32_16x16x32_bf16 v[52:55], v[76:79], v[68:71], v[52:55]
    ds_read_b64_tr_b16 v[132:133], v14 offset:16384
    ds_read_b64_tr_b16 v[134:135], v14 offset:18432
    ds_read_b128 v[140:143], v245 offset:8192
    v_mfma_f32_16x16x32_bf16 v[56:59], v[80:83], v[68:71], v[56:59]
    ds_read_b64_tr_b16 v[136:137], v17 offset:16384
    ds_read_b64_tr_b16 v[138:139], v17 offset:18432
    ds_read_b128 v[144:147], v245 offset:9216
    v_mfma_f32_16x16x32_bf16 v[64:67], v[80:83], v[72:75], v[64:67]
    ds_read_b64_tr_b16 v[148:149], v14 offset:20480
    ds_read_b64_tr_b16 v[150:151], v14 offset:22528
    ds_read_b128 v[156:159], v245 offset:12288
    v_mfma_f32_16x16x32_bf16 v[60:63], v[76:79], v[72:75], v[60:63]
    ds_read_b64_tr_b16 v[152:153], v17 offset:20480
    ds_read_b64_tr_b16 v[154:155], v17 offset:22528
    ds_read_b128 v[160:163], v245 offset:13312
    v_mfma_f32_16x16x32_bf16 v[52:55], v[92:95], v[84:87], v[52:55]
    v_mfma_f32_16x16x32_bf16 v[56:59], v[96:99], v[84:87], v[56:59]
    v_mfma_f32_16x16x32_bf16 v[64:67], v[96:99], v[88:91], v[64:67]
    v_mfma_f32_16x16x32_bf16 v[60:63], v[92:95], v[88:91], v[60:63]
    s_waitcnt lgkmcnt(0)
    s_barrier
    v_mfma_f32_16x16x32_bf16 v[52:55], v[140:143], v[132:135], v[52:55]
    ds_read_b64_tr_b16 v[68:69], v14 offset:24576
    ds_read_b64_tr_b16 v[70:71], v14 offset:26624
    ds_read_b128 v[76:79], v245 offset:16384
    v_mfma_f32_16x16x32_bf16 v[56:59], v[144:147], v[132:135], v[56:59]
    ds_read_b64_tr_b16 v[72:73], v17 offset:24576
    ds_read_b64_tr_b16 v[74:75], v17 offset:26624
    ds_read_b128 v[80:83], v245 offset:17408
    v_mfma_f32_16x16x32_bf16 v[64:67], v[144:147], v[136:139], v[64:67]
    ds_read_b64_tr_b16 v[84:85], v14 offset:28672
    ds_read_b64_tr_b16 v[86:87], v14 offset:30720
    ds_read_b128 v[92:95], v245 offset:20480
    v_mfma_f32_16x16x32_bf16 v[60:63], v[140:143], v[136:139], v[60:63]
    ds_read_b64_tr_b16 v[88:89], v17 offset:28672
    ds_read_b64_tr_b16 v[90:91], v17 offset:30720
    ds_read_b128 v[96:99], v245 offset:21504
    v_mfma_f32_16x16x32_bf16 v[52:55], v[156:159], v[148:151], v[52:55]
    v_mfma_f32_16x16x32_bf16 v[56:59], v[160:163], v[148:151], v[56:59]
    v_mfma_f32_16x16x32_bf16 v[64:67], v[160:163], v[152:155], v[64:67]
    v_mfma_f32_16x16x32_bf16 v[60:63], v[156:159], v[152:155], v[60:63]
    s_waitcnt lgkmcnt(0)
    s_barrier
    v_mfma_f32_16x16x32_bf16 v[52:55], v[76:79], v[68:71], v[52:55]
    ds_read_b64_tr_b16 v[132:133], v14 offset:0
    ds_read_b64_tr_b16 v[134:135], v14 offset:2048
    ds_read_b128 v[140:143], v245 offset:0
    v_mfma_f32_16x16x32_bf16 v[56:59], v[80:83], v[68:71], v[56:59]
    ds_read_b64_tr_b16 v[136:137], v17 offset:0
    ds_read_b64_tr_b16 v[138:139], v17 offset:2048
    ds_read_b128 v[144:147], v245 offset:1024
    v_mfma_f32_16x16x32_bf16 v[64:67], v[80:83], v[72:75], v[64:67]
    ds_read_b64_tr_b16 v[148:149], v14 offset:4096
    ds_read_b64_tr_b16 v[150:151], v14 offset:6144
    ds_read_b128 v[156:159], v245 offset:4096
    v_mfma_f32_16x16x32_bf16 v[60:63], v[76:79], v[72:75], v[60:63]
    ds_read_b64_tr_b16 v[152:153], v17 offset:4096
    ds_read_b64_tr_b16 v[154:155], v17 offset:6144
    ds_read_b128 v[160:163], v245 offset:5120
    v_mfma_f32_16x16x32_bf16 v[52:55], v[92:95], v[84:87], v[52:55]
    v_mfma_f32_16x16x32_bf16 v[56:59], v[96:99], v[84:87], v[56:59]
    v_mfma_f32_16x16x32_bf16 v[64:67], v[96:99], v[88:91], v[64:67]
    v_mfma_f32_16x16x32_bf16 v[60:63], v[92:95], v[88:91], v[60:63]
    s_waitcnt lgkmcnt(0)
    s_barrier
    v_mfma_f32_16x16x32_bf16 v[52:55], v[140:143], v[132:135], v[52:55]
    ds_read_b64_tr_b16 v[68:69], v15 offset:8192
    ds_read_b64_tr_b16 v[70:71], v15 offset:10240
    ds_read_b128 v[76:79], v244 offset:57344
    v_mfma_f32_16x16x32_bf16 v[56:59], v[144:147], v[132:135], v[56:59]
    ds_read_b64_tr_b16 v[72:73], v18 offset:8192
    ds_read_b64_tr_b16 v[74:75], v18 offset:10240
    ds_read_b128 v[80:83], v244 offset:58368
    v_mfma_f32_16x16x32_bf16 v[64:67], v[144:147], v[136:139], v[64:67]
    ds_read_b64_tr_b16 v[84:85], v15 offset:12288
    ds_read_b64_tr_b16 v[86:87], v15 offset:14336
    ds_read_b128 v[92:95], v244 offset:61440
    v_mfma_f32_16x16x32_bf16 v[60:63], v[140:143], v[136:139], v[60:63]
    ds_read_b64_tr_b16 v[88:89], v18 offset:12288
    ds_read_b64_tr_b16 v[90:91], v18 offset:14336
    ds_read_b128 v[96:99], v244 offset:62464
    v_mfma_f32_16x16x32_bf16 v[52:55], v[156:159], v[148:151], v[52:55]
    v_mfma_f32_16x16x32_bf16 v[56:59], v[160:163], v[148:151], v[56:59]
    v_mfma_f32_16x16x32_bf16 v[64:67], v[160:163], v[152:155], v[64:67]
    v_mfma_f32_16x16x32_bf16 v[60:63], v[156:159], v[152:155], v[60:63]
    s_waitcnt lgkmcnt(0)
    s_barrier
    v_mfma_f32_16x16x32_bf16 v[52:55], v[76:79], v[68:71], v[52:55]
    ds_read_b64_tr_b16 v[132:133], v14 offset:32768
    ds_read_b64_tr_b16 v[134:135], v14 offset:34816
    ds_read_b128 v[140:143], v244 offset:49152
    v_mfma_f32_16x16x32_bf16 v[56:59], v[80:83], v[68:71], v[56:59]
    ds_read_b64_tr_b16 v[136:137], v17 offset:32768
    ds_read_b64_tr_b16 v[138:139], v17 offset:34816
    ds_read_b128 v[144:147], v244 offset:50176
    v_mfma_f32_16x16x32_bf16 v[64:67], v[80:83], v[72:75], v[64:67]
    ds_read_b64_tr_b16 v[148:149], v14 offset:36864
    ds_read_b64_tr_b16 v[150:151], v14 offset:38912
    ds_read_b128 v[156:159], v244 offset:53248
    v_mfma_f32_16x16x32_bf16 v[60:63], v[76:79], v[72:75], v[60:63]
    ds_read_b64_tr_b16 v[152:153], v17 offset:36864
    ds_read_b64_tr_b16 v[154:155], v17 offset:38912
    ds_read_b128 v[160:163], v244 offset:54272
    v_mfma_f32_16x16x32_bf16 v[52:55], v[92:95], v[84:87], v[52:55]
    v_mfma_f32_16x16x32_bf16 v[56:59], v[96:99], v[84:87], v[56:59]
    v_mfma_f32_16x16x32_bf16 v[64:67], v[96:99], v[88:91], v[64:67]
    v_mfma_f32_16x16x32_bf16 v[60:63], v[92:95], v[88:91], v[60:63]
    s_waitcnt lgkmcnt(0)
    s_barrier
    v_mfma_f32_16x16x32_bf16 v[52:55], v[140:143], v[132:135], v[52:55]
    ds_read_b64_tr_b16 v[68:69], v14 offset:8192
    ds_read_b64_tr_b16 v[70:71], v14 offset:10240
    ds_read_b128 v[76:79], v245 offset:8192
    v_mfma_f32_16x16x32_bf16 v[56:59], v[144:147], v[132:135], v[56:59]
    ds_read_b64_tr_b16 v[72:73], v17 offset:8192
    ds_read_b64_tr_b16 v[74:75], v17 offset:10240
    ds_read_b128 v[80:83], v245 offset:9216
    v_mfma_f32_16x16x32_bf16 v[64:67], v[144:147], v[136:139], v[64:67]
    ds_read_b64_tr_b16 v[84:85], v14 offset:12288
    ds_read_b64_tr_b16 v[86:87], v14 offset:14336
    ds_read_b128 v[92:95], v245 offset:12288
    v_mfma_f32_16x16x32_bf16 v[60:63], v[140:143], v[136:139], v[60:63]
    ds_read_b64_tr_b16 v[88:89], v17 offset:12288
    ds_read_b64_tr_b16 v[90:91], v17 offset:14336
    ds_read_b128 v[96:99], v245 offset:13312
    v_mfma_f32_16x16x32_bf16 v[52:55], v[156:159], v[148:151], v[52:55]
    v_mfma_f32_16x16x32_bf16 v[56:59], v[160:163], v[148:151], v[56:59]
    v_mfma_f32_16x16x32_bf16 v[64:67], v[160:163], v[152:155], v[64:67]
    v_mfma_f32_16x16x32_bf16 v[60:63], v[156:159], v[152:155], v[60:63]
    s_waitcnt lgkmcnt(0)
    s_barrier
    v_mfma_f32_16x16x32_bf16 v[52:55], v[76:79], v[68:71], v[52:55]
    ds_read_b64_tr_b16 v[132:133], v14 offset:40960
    ds_read_b64_tr_b16 v[134:135], v14 offset:43008
    ds_read_b128 v[140:143], v245 offset:16384
    v_mfma_f32_16x16x32_bf16 v[56:59], v[80:83], v[68:71], v[56:59]
    ds_read_b64_tr_b16 v[136:137], v17 offset:40960
    ds_read_b64_tr_b16 v[138:139], v17 offset:43008
    ds_read_b128 v[144:147], v245 offset:17408
    v_mfma_f32_16x16x32_bf16 v[64:67], v[80:83], v[72:75], v[64:67]
    ds_read_b64_tr_b16 v[148:149], v14 offset:45056
    ds_read_b64_tr_b16 v[150:151], v14 offset:47104
    ds_read_b128 v[156:159], v245 offset:20480
    v_mfma_f32_16x16x32_bf16 v[60:63], v[76:79], v[72:75], v[60:63]
    ds_read_b64_tr_b16 v[152:153], v17 offset:45056
    ds_read_b64_tr_b16 v[154:155], v17 offset:47104
    ds_read_b128 v[160:163], v245 offset:21504
    v_mfma_f32_16x16x32_bf16 v[52:55], v[92:95], v[84:87], v[52:55]
    v_mfma_f32_16x16x32_bf16 v[56:59], v[96:99], v[84:87], v[56:59]
    v_mfma_f32_16x16x32_bf16 v[64:67], v[96:99], v[88:91], v[64:67]
    v_mfma_f32_16x16x32_bf16 v[60:63], v[92:95], v[88:91], v[60:63]
    s_waitcnt lgkmcnt(0)
    s_barrier
    v_mfma_f32_16x16x32_bf16 v[52:55], v[140:143], v[132:135], v[52:55]
    ds_read_b64_tr_b16 v[68:69], v14 offset:49152
    ds_read_b64_tr_b16 v[70:71], v14 offset:51200
    ds_read_b128 v[76:79], v245 offset:0
    v_mfma_f32_16x16x32_bf16 v[56:59], v[144:147], v[132:135], v[56:59]
    ds_read_b64_tr_b16 v[72:73], v17 offset:49152
    ds_read_b64_tr_b16 v[74:75], v17 offset:51200
    ds_read_b128 v[80:83], v245 offset:1024
    v_mfma_f32_16x16x32_bf16 v[64:67], v[144:147], v[136:139], v[64:67]
    ds_read_b64_tr_b16 v[84:85], v14 offset:53248
    ds_read_b64_tr_b16 v[86:87], v14 offset:55296
    ds_read_b128 v[92:95], v245 offset:4096
    v_mfma_f32_16x16x32_bf16 v[60:63], v[140:143], v[136:139], v[60:63]
    ds_read_b64_tr_b16 v[88:89], v17 offset:53248
    ds_read_b64_tr_b16 v[90:91], v17 offset:55296
    ds_read_b128 v[96:99], v245 offset:5120
    v_mfma_f32_16x16x32_bf16 v[52:55], v[156:159], v[148:151], v[52:55]
    v_mfma_f32_16x16x32_bf16 v[56:59], v[160:163], v[148:151], v[56:59]
    v_mfma_f32_16x16x32_bf16 v[64:67], v[160:163], v[152:155], v[64:67]
    v_mfma_f32_16x16x32_bf16 v[60:63], v[156:159], v[152:155], v[60:63]
    s_waitcnt lgkmcnt(0)
    s_barrier
    v_mfma_f32_16x16x32_bf16 v[52:55], v[76:79], v[68:71], v[52:55]
    ds_read_b64_tr_b16 v[132:133], v14 offset:16384
    ds_read_b64_tr_b16 v[134:135], v14 offset:18432
    ds_read_b128 v[140:143], v244 offset:57344
    v_mfma_f32_16x16x32_bf16 v[56:59], v[80:83], v[68:71], v[56:59]
    ds_read_b64_tr_b16 v[136:137], v17 offset:16384
    ds_read_b64_tr_b16 v[138:139], v17 offset:18432
    ds_read_b128 v[144:147], v244 offset:58368
    v_mfma_f32_16x16x32_bf16 v[64:67], v[80:83], v[72:75], v[64:67]
    ds_read_b64_tr_b16 v[148:149], v14 offset:20480
    ds_read_b64_tr_b16 v[150:151], v14 offset:22528
    ds_read_b128 v[156:159], v244 offset:61440
    v_mfma_f32_16x16x32_bf16 v[60:63], v[76:79], v[72:75], v[60:63]
    ds_read_b64_tr_b16 v[152:153], v17 offset:20480
    ds_read_b64_tr_b16 v[154:155], v17 offset:22528
    ds_read_b128 v[160:163], v244 offset:62464
    v_mfma_f32_16x16x32_bf16 v[52:55], v[92:95], v[84:87], v[52:55]
    v_mfma_f32_16x16x32_bf16 v[56:59], v[96:99], v[84:87], v[56:59]
    v_mfma_f32_16x16x32_bf16 v[64:67], v[96:99], v[88:91], v[64:67]
    v_mfma_f32_16x16x32_bf16 v[60:63], v[92:95], v[88:91], v[60:63]
    s_waitcnt lgkmcnt(0)
    s_barrier
    v_mfma_f32_16x16x32_bf16 v[52:55], v[140:143], v[132:135], v[52:55]
    ds_read_b64_tr_b16 v[68:69], v14 offset:0
    ds_read_b64_tr_b16 v[70:71], v14 offset:2048
    ds_read_b128 v[76:79], v244 offset:49152
    v_mfma_f32_16x16x32_bf16 v[56:59], v[144:147], v[132:135], v[56:59]
    ds_read_b64_tr_b16 v[72:73], v17 offset:0
    ds_read_b64_tr_b16 v[74:75], v17 offset:2048
    ds_read_b128 v[80:83], v244 offset:50176
    v_mfma_f32_16x16x32_bf16 v[64:67], v[144:147], v[136:139], v[64:67]
    ds_read_b64_tr_b16 v[84:85], v14 offset:4096
    ds_read_b64_tr_b16 v[86:87], v14 offset:6144
    ds_read_b128 v[92:95], v244 offset:53248
    v_mfma_f32_16x16x32_bf16 v[60:63], v[140:143], v[136:139], v[60:63]
    ds_read_b64_tr_b16 v[88:89], v17 offset:4096
    ds_read_b64_tr_b16 v[90:91], v17 offset:6144
    ds_read_b128 v[96:99], v244 offset:54272
    v_mfma_f32_16x16x32_bf16 v[52:55], v[156:159], v[148:151], v[52:55]
    v_mfma_f32_16x16x32_bf16 v[56:59], v[160:163], v[148:151], v[56:59]
    v_mfma_f32_16x16x32_bf16 v[64:67], v[160:163], v[152:155], v[64:67]
    v_mfma_f32_16x16x32_bf16 v[60:63], v[156:159], v[152:155], v[60:63]
    s_waitcnt lgkmcnt(0)
    s_barrier
    v_mfma_f32_16x16x32_bf16 v[52:55], v[76:79], v[68:71], v[52:55]
    ds_read_b64_tr_b16 v[132:133], v14 offset:24576
    ds_read_b64_tr_b16 v[134:135], v14 offset:26624
    ds_read_b128 v[140:143], v245 offset:8192
    v_mfma_f32_16x16x32_bf16 v[56:59], v[80:83], v[68:71], v[56:59]
    ds_read_b64_tr_b16 v[136:137], v17 offset:24576
    ds_read_b64_tr_b16 v[138:139], v17 offset:26624
    ds_read_b128 v[144:147], v245 offset:9216
    v_mfma_f32_16x16x32_bf16 v[64:67], v[80:83], v[72:75], v[64:67]
    ds_read_b64_tr_b16 v[148:149], v14 offset:28672
    ds_read_b64_tr_b16 v[150:151], v14 offset:30720
    ds_read_b128 v[156:159], v245 offset:12288
    v_mfma_f32_16x16x32_bf16 v[60:63], v[76:79], v[72:75], v[60:63]
    ds_read_b64_tr_b16 v[152:153], v17 offset:28672
    ds_read_b64_tr_b16 v[154:155], v17 offset:30720
    ds_read_b128 v[160:163], v245 offset:13312
    v_mfma_f32_16x16x32_bf16 v[52:55], v[92:95], v[84:87], v[52:55]
    v_mfma_f32_16x16x32_bf16 v[56:59], v[96:99], v[84:87], v[56:59]
    v_mfma_f32_16x16x32_bf16 v[64:67], v[96:99], v[88:91], v[64:67]
    v_mfma_f32_16x16x32_bf16 v[60:63], v[92:95], v[88:91], v[60:63]
    s_waitcnt lgkmcnt(0)
    s_barrier
    v_mfma_f32_16x16x32_bf16 v[52:55], v[140:143], v[132:135], v[52:55]
    ds_read_b64_tr_b16 v[68:69], v14 offset:8192
    ds_read_b64_tr_b16 v[70:71], v14 offset:10240
    ds_read_b128 v[76:79], v245 offset:16384
    v_mfma_f32_16x16x32_bf16 v[56:59], v[144:147], v[132:135], v[56:59]
    ds_read_b64_tr_b16 v[72:73], v17 offset:8192
    ds_read_b64_tr_b16 v[74:75], v17 offset:10240
    ds_read_b128 v[80:83], v245 offset:17408
    v_mfma_f32_16x16x32_bf16 v[64:67], v[144:147], v[136:139], v[64:67]
    ds_read_b64_tr_b16 v[84:85], v14 offset:12288
    ds_read_b64_tr_b16 v[86:87], v14 offset:14336
    ds_read_b128 v[92:95], v245 offset:20480
    v_mfma_f32_16x16x32_bf16 v[60:63], v[140:143], v[136:139], v[60:63]
    ds_read_b64_tr_b16 v[88:89], v17 offset:12288
    ds_read_b64_tr_b16 v[90:91], v17 offset:14336
    ds_read_b128 v[96:99], v245 offset:21504
    v_mfma_f32_16x16x32_bf16 v[52:55], v[156:159], v[148:151], v[52:55]
    v_mfma_f32_16x16x32_bf16 v[56:59], v[160:163], v[148:151], v[56:59]
    v_mfma_f32_16x16x32_bf16 v[64:67], v[160:163], v[152:155], v[64:67]
    v_mfma_f32_16x16x32_bf16 v[60:63], v[156:159], v[152:155], v[60:63]
    s_waitcnt lgkmcnt(0)
    s_barrier
    v_mfma_f32_16x16x32_bf16 v[52:55], v[76:79], v[68:71], v[52:55]
    ds_read_b64_tr_b16 v[132:133], v14 offset:32768
    ds_read_b64_tr_b16 v[134:135], v14 offset:34816
    ds_read_b128 v[140:143], v245 offset:0
    v_mfma_f32_16x16x32_bf16 v[56:59], v[80:83], v[68:71], v[56:59]
    ds_read_b64_tr_b16 v[136:137], v17 offset:32768
    ds_read_b64_tr_b16 v[138:139], v17 offset:34816
    ds_read_b128 v[144:147], v245 offset:1024
    v_mfma_f32_16x16x32_bf16 v[64:67], v[80:83], v[72:75], v[64:67]
    ds_read_b64_tr_b16 v[148:149], v14 offset:36864
    ds_read_b64_tr_b16 v[150:151], v14 offset:38912
    ds_read_b128 v[156:159], v245 offset:4096
    v_mfma_f32_16x16x32_bf16 v[60:63], v[76:79], v[72:75], v[60:63]
    ds_read_b64_tr_b16 v[152:153], v17 offset:36864
    ds_read_b64_tr_b16 v[154:155], v17 offset:38912
    ds_read_b128 v[160:163], v245 offset:5120
    v_mfma_f32_16x16x32_bf16 v[52:55], v[92:95], v[84:87], v[52:55]
    v_mfma_f32_16x16x32_bf16 v[56:59], v[96:99], v[84:87], v[56:59]
    v_mfma_f32_16x16x32_bf16 v[64:67], v[96:99], v[88:91], v[64:67]
    v_mfma_f32_16x16x32_bf16 v[60:63], v[92:95], v[88:91], v[60:63]
    s_waitcnt lgkmcnt(0)
    s_barrier
    v_mfma_f32_16x16x32_bf16 v[52:55], v[140:143], v[132:135], v[52:55]
    ds_read_b64_tr_b16 v[68:69], v14 offset:16384
    ds_read_b64_tr_b16 v[70:71], v14 offset:18432
    ds_read_b128 v[76:79], v244 offset:57344
    v_mfma_f32_16x16x32_bf16 v[56:59], v[144:147], v[132:135], v[56:59]
    ds_read_b64_tr_b16 v[72:73], v17 offset:16384
    ds_read_b64_tr_b16 v[74:75], v17 offset:18432
    ds_read_b128 v[80:83], v244 offset:58368
    v_mfma_f32_16x16x32_bf16 v[64:67], v[144:147], v[136:139], v[64:67]
    ds_read_b64_tr_b16 v[84:85], v14 offset:20480
    ds_read_b64_tr_b16 v[86:87], v14 offset:22528
    ds_read_b128 v[92:95], v244 offset:61440
    v_mfma_f32_16x16x32_bf16 v[60:63], v[140:143], v[136:139], v[60:63]
    ds_read_b64_tr_b16 v[88:89], v17 offset:20480
    ds_read_b64_tr_b16 v[90:91], v17 offset:22528
    ds_read_b128 v[96:99], v244 offset:62464
    v_mfma_f32_16x16x32_bf16 v[52:55], v[156:159], v[148:151], v[52:55]
    v_mfma_f32_16x16x32_bf16 v[56:59], v[160:163], v[148:151], v[56:59]
    v_mfma_f32_16x16x32_bf16 v[64:67], v[160:163], v[152:155], v[64:67]
    v_mfma_f32_16x16x32_bf16 v[60:63], v[156:159], v[152:155], v[60:63]
    s_waitcnt lgkmcnt(0)
    v_mfma_f32_16x16x32_bf16 v[52:55], v[76:79], v[68:71], v[52:55]
    v_mfma_f32_16x16x32_bf16 v[56:59], v[80:83], v[68:71], v[56:59]
    v_mfma_f32_16x16x32_bf16 v[64:67], v[80:83], v[72:75], v[64:67]
    v_mfma_f32_16x16x32_bf16 v[60:63], v[76:79], v[72:75], v[60:63]
    v_mfma_f32_16x16x32_bf16 v[52:55], v[92:95], v[84:87], v[52:55]
    v_mfma_f32_16x16x32_bf16 v[56:59], v[96:99], v[84:87], v[56:59]
    v_mfma_f32_16x16x32_bf16 v[64:67], v[96:99], v[88:91], v[64:67]
    v_mfma_f32_16x16x32_bf16 v[60:63], v[92:95], v[88:91], v[60:63]
    s_nop 4
    v_fmac_f32 v36, v223, v52
    v_fmac_f32 v37, v223, v53
    v_fmac_f32 v38, v223, v54
    v_fmac_f32 v39, v223, v55
    v_fmac_f32 v40, v223, v56
    v_fmac_f32 v41, v223, v57
    v_fmac_f32 v42, v223, v58
    v_fmac_f32 v43, v223, v59
    v_fmac_f32 v44, v221, v60
    v_fmac_f32 v45, v221, v61
    v_fmac_f32 v46, v221, v62
    v_fmac_f32 v47, v221, v63
    v_fmac_f32 v48, v221, v64
    v_fmac_f32 v49, v221, v65
    v_fmac_f32 v50, v221, v66
    v_fmac_f32 v51, v221, v67
    v_cvt_pk_bf16_f32 v180, v36, v37
    v_cvt_pk_bf16_f32 v181, v38, v39
    v_cvt_pk_bf16_f32 v182, v40, v41
    v_cvt_pk_bf16_f32 v183, v42, v43
    v_cvt_pk_bf16_f32 v184, v44, v45
    v_cvt_pk_bf16_f32 v185, v46, v47
    v_cvt_pk_bf16_f32 v186, v48, v49
    v_cvt_pk_bf16_f32 v187, v50, v51
    v_permlane16_swap_b32 v180, v182
    v_permlane16_swap_b32 v181, v183
    v_permlane16_swap_b32 v184, v186
    v_permlane16_swap_b32 v185, v187
    buffer_store_dwordx4 v[180:183], v7, s[64:67], s15 offen
    buffer_store_dwordx4 v[184:187], v7, s[64:67], s68 offen
    s_endpgm
tl_main:
    s_add_u32 s68, s60, 1
    s_and_b32 s68, s68, 3
    s_or_b32 s68, s68, s62
    s_mul_i32 s68, s68, 196608
    s_add_u32 s68, s68, s65
    s_mov_b32 m0, 16384
    s_add_u32 s69, s68, 98304
    buffer_load_dwordx4 v4, s[44:47], s68 offen offset:0 lds
    buffer_load_dwordx4 v5, s[44:47], s68 offen offset:1024 lds
    buffer_load_dwordx4 v6, s[44:47], s68 offen offset:2048 lds
    buffer_load_dwordx4 v7, s[44:47], s68 offen offset:3072 lds
    s_mov_b32 m0, 20480
    s_nop 0
    buffer_load_dwordx4 v4, s[44:47], s69 offen offset:0 lds
    buffer_load_dwordx4 v5, s[44:47], s69 offen offset:1024 lds
    buffer_load_dwordx4 v6, s[44:47], s69 offen offset:2048 lds
    buffer_load_dwordx4 v7, s[44:47], s69 offen offset:3072 lds
    s_add_u32 s68, s68, 1024
    s_mov_b32 m0, 24576
    s_add_u32 s69, s68, 98304
    buffer_load_dwordx4 v4, s[44:47], s68 offen offset:0 lds
    buffer_load_dwordx4 v5, s[44:47], s68 offen offset:1024 lds
    buffer_load_dwordx4 v6, s[44:47], s68 offen offset:2048 lds
    buffer_load_dwordx4 v7, s[44:47], s68 offen offset:3072 lds
    s_mov_b32 m0, 28672
    s_nop 0
    buffer_load_dwordx4 v4, s[44:47], s69 offen offset:0 lds
    buffer_load_dwordx4 v5, s[44:47], s69 offen offset:1024 lds
    buffer_load_dwordx4 v6, s[44:47], s69 offen offset:2048 lds
    buffer_load_dwordx4 v7, s[44:47], s69 offen offset:3072 lds
    v_lshrrev_b32 v2, 5, v1
    v_lshlrev_b32 v2, 5, v2
    v_xor_b32 v22, v22, v2
    v_mul_u32_u24 v8, 3584, v23
    v_add_u32 v8, v8, v22
    v_add_u32 v9, 27648, v8
    v_add_u32 v10, 55296, v8
    v_add_u32 v11, 82944, v8
    s_lshl_b32 s66, s8, 7
    s_mov_b32 s48, s24
    s_mov_b32 s49, s25
    s_mov_b32 s50, 0x700000
    s_mov_b32 s51, 0x20000
    s_mov_b32 s52, s20
    s_mov_b32 s53, s21
    s_mov_b32 s54, 0x80000
    s_mov_b32 s55, 0x20000
    s_mov_b32 s56, s28
    s_mov_b32 s57, s29
    s_mov_b32 s58, 0x700000
    s_mov_b32 s59, 0x20000
    s_mov_b32 s40, s38
    s_mov_b32 s41, s39
    s_mov_b32 s42, 0x2000000
    s_mov_b32 s43, 0x20000
    s_mul_i32 s23, s10, 147
    s_mul_i32 s64, s9, 256
    s_add_u32 s23, s23, s64
    s_lshr_b32 s23, s23, 6
    s_sub_u32 s64, s23, 16
    s_cmp_ge_u32 s23, 16
    s_cselect_b32 s23, s64, s23
    s_mul_i32 s26, s10, 147
    s_lshr_b32 s26, s26, 6
    s_sub_u32 s64, s26, 16
    s_cmp_ge_u32 s26, 16
    s_cselect_b32 s26, s64, s26
    s_and_b32 s27, s4, 1
    s_mul_i32 s27, s27, 16
    s_sub_u32 s30, 16, s27
    s_cmp_ge_u32 s5, 28
    s_cbranch_scc1 tl_spare
    s_add_u32 s68, s23, 0
    s_add_u32 s68, s68, s27
    s_mul_i32 s68, s68, 229376
    s_add_u32 s68, s68, s66
    s_mov_b32 m0, 32768
    s_add_u32 s69, s68, 114688
    buffer_load_dwordx4 v8, s[48:51], s68 offen offset:0 lds
    buffer_load_dwordx4 v9, s[48:51], s68 offen offset:1024 lds
    buffer_load_dwordx4 v10, s[48:51], s68 offen offset:2048 lds
    buffer_load_dwordx4 v11, s[48:51], s68 offen offset:3072 lds
    s_mov_b32 m0, 36864
    s_nop 0
    buffer_load_dwordx4 v8, s[48:51], s69 offen offset:0 lds
    buffer_load_dwordx4 v9, s[48:51], s69 offen offset:1024 lds
    buffer_load_dwordx4 v10, s[48:51], s69 offen offset:2048 lds
    buffer_load_dwordx4 v11, s[48:51], s69 offen offset:3072 lds
    s_cmp_ge_u32 s23, 15
    s_cselect_b32 s68, -15, 1
    s_add_u32 s68, s68, s23
    s_add_u32 s68, s68, s27
    s_mul_i32 s68, s68, 229376
    s_add_u32 s68, s68, s66
    s_mov_b32 m0, 40960
    s_add_u32 s69, s68, 114688
    buffer_load_dwordx4 v8, s[48:51], s68 offen offset:0 lds
    buffer_load_dwordx4 v9, s[48:51], s68 offen offset:1024 lds
    buffer_load_dwordx4 v10, s[48:51], s68 offen offset:2048 lds
    buffer_load_dwordx4 v11, s[48:51], s68 offen offset:3072 lds
    s_mov_b32 m0, 45056
    s_nop 0
    buffer_load_dwordx4 v8, s[48:51], s69 offen offset:0 lds
    buffer_load_dwordx4 v9, s[48:51], s69 offen offset:1024 lds
    buffer_load_dwordx4 v10, s[48:51], s69 offen offset:2048 lds
    buffer_load_dwordx4 v11, s[48:51], s69 offen offset:3072 lds
    v_mul_u32_u24 v12, 1024, v23
    v_add_u32 v12, v12, v22
    v_add_u32 v13, 7168, v12
    v_add_u32 v14, 14336, v12
    v_add_u32 v15, 21504, v12
    v_mul_u32_u24 v16, 4096, v23
    v_add_u32 v16, v16, v22
    v_add_u32 v17, 31744, v16
    v_add_u32 v18, 63488, v16
    v_add_u32 v19, 95232, v16
    v_lshlrev_b32 v25, 4, v1
    s_mul_i32 s32, s10, 112
    s_mul_i32 s64, s9, 224
    s_add_u32 s32, s32, s64
    s_lshr_b32 s32, s32, 6
    s_sub_u32 s64, s32, 14
    s_cmp_ge_u32 s32, 14
    s_cselect_b32 s32, s64, s32
    s_mul_i32 s33, s10, 112
    s_lshr_b32 s33, s33, 6
    s_sub_u32 s64, s33, 14
    s_cmp_ge_u32 s33, 14
    s_cselect_b32 s33, s64, s33
    s_and_b32 s34, s4, 1
    s_mul_i32 s34, s34, 14
    s_sub_u32 s35, 14, s34
    s_lshl_b32 s61, s9, 1
    s_add_u32 s61, s61, s10
    s_lshl_b32 s67, s6, 7
    s_xor_b32 s64, s7, 4
    s_lshl_b32 s76, s64, 18
    s_add_u32 s76, s76, 0x10000
    s_mul_i32 s77, s64, 229376
    s_add_u32 s77, s77, 0x220000
    s_waitcnt vmcnt(32)
    s_barrier
    s_add_u32 s68, s60, 2
    s_and_b32 s68, s68, 3
    s_or_b32 s68, s68, s62
    s_mul_i32 s68, s68, 196608
    s_add_u32 s68, s68, s65
    s_mov_b32 m0, 49152
    s_add_u32 s69, s68, 98304
    buffer_load_dwordx4 v4, s[44:47], s68 offen offset:0 lds
    buffer_load_dwordx4 v5, s[44:47], s68 offen offset:1024 lds
    buffer_load_dwordx4 v6, s[44:47], s68 offen offset:2048 lds
    buffer_load_dwordx4 v7, s[44:47], s68 offen offset:3072 lds
    s_mov_b32 m0, 53248
    s_nop 0
    buffer_load_dwordx4 v4, s[44:47], s69 offen offset:0 lds
    buffer_load_dwordx4 v5, s[44:47], s69 offen offset:1024 lds
    buffer_load_dwordx4 v6, s[44:47], s69 offen offset:2048 lds
    buffer_load_dwordx4 v7, s[44:47], s69 offen offset:3072 lds
    s_add_u32 s68, s68, 1024
    s_mov_b32 m0, 57344
    s_add_u32 s69, s68, 98304
    buffer_load_dwordx4 v4, s[44:47], s68 offen offset:0 lds
    buffer_load_dwordx4 v5, s[44:47], s68 offen offset:1024 lds
    buffer_load_dwordx4 v6, s[44:47], s68 offen offset:2048 lds
    buffer_load_dwordx4 v7, s[44:47], s68 offen offset:3072 lds
    s_mov_b32 m0, 61440
    s_nop 0
    buffer_load_dwordx4 v4, s[44:47], s69 offen offset:0 lds
    buffer_load_dwordx4 v5, s[44:47], s69 offen offset:1024 lds
    buffer_load_dwordx4 v6, s[44:47], s69 offen offset:2048 lds
    buffer_load_dwordx4 v7, s[44:47], s69 offen offset:3072 lds
    s_waitcnt vmcnt(32)
    s_barrier
    s_add_u32 s68, s60, 3
    s_and_b32 s68, s68, 3
    s_or_b32 s68, s68, s62
    s_mul_i32 s68, s68, 196608
    s_add_u32 s68, s68, s65
    s_mov_b32 m0, 0
    s_add_u32 s69, s68, 98304
    buffer_load_dwordx4 v4, s[44:47], s68 offen offset:0 lds
    buffer_load_dwordx4 v5, s[44:47], s68 offen offset:1024 lds
    buffer_load_dwordx4 v6, s[44:47], s68 offen offset:2048 lds
    buffer_load_dwordx4 v7, s[44:47], s68 offen offset:3072 lds
    s_mov_b32 m0, 4096
    s_nop 0
    buffer_load_dwordx4 v4, s[44:47], s69 offen offset:0 lds
    buffer_load_dwordx4 v5, s[44:47], s69 offen offset:1024 lds
    buffer_load_dwordx4 v6, s[44:47], s69 offen offset:2048 lds
    buffer_load_dwordx4 v7, s[44:47], s69 offen offset:3072 lds
    s_add_u32 s68, s68, 1024
    s_mov_b32 m0, 8192
    s_add_u32 s69, s68, 98304
    buffer_load_dwordx4 v4, s[44:47], s68 offen offset:0 lds
    buffer_load_dwordx4 v5, s[44:47], s68 offen offset:1024 lds
    buffer_load_dwordx4 v6, s[44:47], s68 offen offset:2048 lds
    buffer_load_dwordx4 v7, s[44:47], s68 offen offset:3072 lds
    s_mov_b32 m0, 12288
    s_nop 0
    buffer_load_dwordx4 v4, s[44:47], s69 offen offset:0 lds
    buffer_load_dwordx4 v5, s[44:47], s69 offen offset:1024 lds
    buffer_load_dwordx4 v6, s[44:47], s69 offen offset:2048 lds
    buffer_load_dwordx4 v7, s[44:47], s69 offen offset:3072 lds
    s_waitcnt vmcnt(16)
    s_barrier
    s_add_u32 s68, s60, 0
    s_and_b32 s68, s68, 3
    s_or_b32 s68, s68, s62
    s_xor_b32 s68, s68, 4
    s_mul_i32 s68, s68, 196608
    s_add_u32 s68, s68, s65
    s_mov_b32 m0, 16384
    s_add_u32 s69, s68, 98304
    buffer_load_dwordx4 v4, s[44:47], s68 offen offset:0 lds
    buffer_load_dwordx4 v5, s[44:47], s68 offen offset:1024 lds
    buffer_load_dwordx4 v6, s[44:47], s68 offen offset:2048 lds
    buffer_load_dwordx4 v7, s[44:47], s68 offen offset:3072 lds
    s_mov_b32 m0, 20480
    s_nop 0
    buffer_load_dwordx4 v4, s[44:47], s69 offen offset:0 lds
    buffer_load_dwordx4 v5, s[44:47], s69 offen offset:1024 lds
    buffer_load_dwordx4 v6, s[44:47], s69 offen offset:2048 lds
    buffer_load_dwordx4 v7, s[44:47], s69 offen offset:3072 lds
    s_add_u32 s68, s68, 1024
    s_mov_b32 m0, 24576
    s_add_u32 s69, s68, 98304
    buffer_load_dwordx4 v4, s[44:47], s68 offen offset:0 lds
    buffer_load_dwordx4 v5, s[44:47], s68 offen offset:1024 lds
    buffer_load_dwordx4 v6, s[44:47], s68 offen offset:2048 lds
    buffer_load_dwordx4 v7, s[44:47], s68 offen offset:3072 lds
    s_mov_b32 m0, 28672
    s_nop 0
    buffer_load_dwordx4 v4, s[44:47], s69 offen offset:0 lds
    buffer_load_dwordx4 v5, s[44:47], s69 offen offset:1024 lds
    buffer_load_dwordx4 v6, s[44:47], s69 offen offset:2048 lds
    buffer_load_dwordx4 v7, s[44:47], s69 offen offset:3072 lds
    s_waitcnt vmcnt(16)
    s_barrier
    s_add_u32 s68, s60, 1
    s_and_b32 s68, s68, 3
    s_or_b32 s68, s68, s62
    s_xor_b32 s68, s68, 4
    s_mul_i32 s68, s68, 196608
    s_add_u32 s68, s68, s65
    s_mov_b32 m0, 49152
    s_add_u32 s69, s68, 98304
    buffer_load_dwordx4 v4, s[44:47], s68 offen offset:0 lds
    buffer_load_dwordx4 v5, s[44:47], s68 offen offset:1024 lds
    buffer_load_dwordx4 v6, s[44:47], s68 offen offset:2048 lds
    buffer_load_dwordx4 v7, s[44:47], s68 offen offset:3072 lds
    s_mov_b32 m0, 53248
    s_nop 0
    buffer_load_dwordx4 v4, s[44:47], s69 offen offset:0 lds
    buffer_load_dwordx4 v5, s[44:47], s69 offen offset:1024 lds
    buffer_load_dwordx4 v6, s[44:47], s69 offen offset:2048 lds
    buffer_load_dwordx4 v7, s[44:47], s69 offen offset:3072 lds
    s_add_u32 s68, s68, 1024
    s_mov_b32 m0, 57344
    s_add_u32 s69, s68, 98304
    buffer_load_dwordx4 v4, s[44:47], s68 offen offset:0 lds
    buffer_load_dwordx4 v5, s[44:47], s68 offen offset:1024 lds
    buffer_load_dwordx4 v6, s[44:47], s68 offen offset:2048 lds
    buffer_load_dwordx4 v7, s[44:47], s68 offen offset:3072 lds
    s_mov_b32 m0, 61440
    s_nop 0
    buffer_load_dwordx4 v4, s[44:47], s69 offen offset:0 lds
    buffer_load_dwordx4 v5, s[44:47], s69 offen offset:1024 lds
    buffer_load_dwordx4 v6, s[44:47], s69 offen offset:2048 lds
    buffer_load_dwordx4 v7, s[44:47], s69 offen offset:3072 lds
    s_waitcnt vmcnt(16)
    s_barrier
    s_add_u32 s68, s60, 2
    s_and_b32 s68, s68, 3
    s_or_b32 s68, s68, s62
    s_xor_b32 s68, s68, 4
    s_mul_i32 s68, s68, 196608
    s_add_u32 s68, s68, s65
    s_mov_b32 m0, 0
    s_add_u32 s69, s68, 98304
    buffer_load_dwordx4 v4, s[44:47], s68 offen offset:0 lds
    buffer_load_dwordx4 v5, s[44:47], s68 offen offset:1024 lds
    buffer_load_dwordx4 v6, s[44:47], s68 offen offset:2048 lds
    buffer_load_dwordx4 v7, s[44:47], s68 offen offset:3072 lds
    s_mov_b32 m0, 4096
    s_nop 0
    buffer_load_dwordx4 v4, s[44:47], s69 offen offset:0 lds
    buffer_load_dwordx4 v5, s[44:47], s69 offen offset:1024 lds
    buffer_load_dwordx4 v6, s[44:47], s69 offen offset:2048 lds
    buffer_load_dwordx4 v7, s[44:47], s69 offen offset:3072 lds
    s_add_u32 s68, s68, 1024
    s_mov_b32 m0, 8192
    s_add_u32 s69, s68, 98304
    buffer_load_dwordx4 v4, s[44:47], s68 offen offset:0 lds
    buffer_load_dwordx4 v5, s[44:47], s68 offen offset:1024 lds
    buffer_load_dwordx4 v6, s[44:47], s68 offen offset:2048 lds
    buffer_load_dwordx4 v7, s[44:47], s68 offen offset:3072 lds
    s_mov_b32 m0, 12288
    s_nop 0
    buffer_load_dwordx4 v4, s[44:47], s69 offen offset:0 lds
    buffer_load_dwordx4 v5, s[44:47], s69 offen offset:1024 lds
    buffer_load_dwordx4 v6, s[44:47], s69 offen offset:2048 lds
    buffer_load_dwordx4 v7, s[44:47], s69 offen offset:3072 lds
    s_waitcnt vmcnt(16)
    s_barrier
    s_add_u32 s68, s60, 3
    s_and_b32 s68, s68, 3
    s_or_b32 s68, s68, s62
    s_xor_b32 s68, s68, 4
    s_mul_i32 s68, s68, 196608
    s_add_u32 s68, s68, s65
    s_mov_b32 m0, 16384
    s_add_u32 s69, s68, 98304
    buffer_load_dwordx4 v4, s[44:47], s68 offen offset:0 lds
    buffer_load_dwordx4 v5, s[44:47], s68 offen offset:1024 lds
    buffer_load_dwordx4 v6, s[44:47], s68 offen offset:2048 lds
    buffer_load_dwordx4 v7, s[44:47], s68 offen offset:3072 lds
    s_mov_b32 m0, 20480
    s_nop 0
    buffer_load_dwordx4 v4, s[44:47], s69 offen offset:0 lds
    buffer_load_dwordx4 v5, s[44:47], s69 offen offset:1024 lds
    buffer_load_dwordx4 v6, s[44:47], s69 offen offset:2048 lds
    buffer_load_dwordx4 v7, s[44:47], s69 offen offset:3072 lds
    s_add_u32 s68, s68, 1024
    s_mov_b32 m0, 24576
    s_add_u32 s69, s68, 98304
    buffer_load_dwordx4 v4, s[44:47], s68 offen offset:0 lds
    buffer_load_dwordx4 v5, s[44:47], s68 offen offset:1024 lds
    buffer_load_dwordx4 v6, s[44:47], s68 offen offset:2048 lds
    buffer_load_dwordx4 v7, s[44:47], s68 offen offset:3072 lds
    s_mov_b32 m0, 28672
    s_nop 0
    buffer_load_dwordx4 v4, s[44:47], s69 offen offset:0 lds
    buffer_load_dwordx4 v5, s[44:47], s69 offen offset:1024 lds
    buffer_load_dwordx4 v6, s[44:47], s69 offen offset:2048 lds
    buffer_load_dwordx4 v7, s[44:47], s69 offen offset:3072 lds
    s_waitcnt vmcnt(16)
    s_barrier
    s_cmp_ge_u32 s23, 14
    s_cselect_b32 s68, -14, 2
    s_add_u32 s68, s68, s23
    s_add_u32 s68, s68, s27
    s_mul_i32 s68, s68, 229376
    s_add_u32 s68, s68, s66
    s_mov_b32 m0, 49152
    s_add_u32 s69, s68, 114688
    buffer_load_dwordx4 v8, s[48:51], s68 offen offset:0 lds
    buffer_load_dwordx4 v9, s[48:51], s68 offen offset:1024 lds
    buffer_load_dwordx4 v10, s[48:51], s68 offen offset:2048 lds
    buffer_load_dwordx4 v11, s[48:51], s68 offen offset:3072 lds
    s_mov_b32 m0, 53248
    s_nop 0
    buffer_load_dwordx4 v8, s[48:51], s69 offen offset:0 lds
    buffer_load_dwordx4 v9, s[48:51], s69 offen offset:1024 lds
    buffer_load_dwordx4 v10, s[48:51], s69 offen offset:2048 lds
    buffer_load_dwordx4 v11, s[48:51], s69 offen offset:3072 lds
    s_cmp_ge_u32 s23, 13
    s_cselect_b32 s68, -13, 3
    s_add_u32 s68, s68, s23
    s_add_u32 s68, s68, s27
    s_mul_i32 s68, s68, 229376
    s_add_u32 s68, s68, s66
    s_mov_b32 m0, 57344
    s_add_u32 s69, s68, 114688
    buffer_load_dwordx4 v8, s[48:51], s68 offen offset:0 lds
    buffer_load_dwordx4 v9, s[48:51], s68 offen offset:1024 lds
    buffer_load_dwordx4 v10, s[48:51], s68 offen offset:2048 lds
    buffer_load_dwordx4 v11, s[48:51], s68 offen offset:3072 lds
    s_mov_b32 m0, 61440
    s_nop 0
    buffer_load_dwordx4 v8, s[48:51], s69 offen offset:0 lds
    buffer_load_dwordx4 v9, s[48:51], s69 offen offset:1024 lds
    buffer_load_dwordx4 v10, s[48:51], s69 offen offset:2048 lds
    buffer_load_dwordx4 v11, s[48:51], s69 offen offset:3072 lds
    s_waitcnt vmcnt(16)
    s_barrier
    s_cmp_ge_u32 s23, 12
    s_cselect_b32 s68, -12, 4
    s_add_u32 s68, s68, s23
    s_add_u32 s68, s68, s27
    s_mul_i32 s68, s68, 229376
    s_add_u32 s68, s68, s66
    s_mov_b32 m0, 0
    s_add_u32 s69, s68, 114688
    buffer_load_dwordx4 v8, s[48:51], s68 offen offset:0 lds
    buffer_load_dwordx4 v9, s[48:51], s68 offen offset:1024 lds
    buffer_load_dwordx4 v10, s[48:51], s68 offen offset:2048 lds
    buffer_load_dwordx4 v11, s[48:51], s68 offen offset:3072 lds
    s_mov_b32 m0, 4096
    s_nop 0
    buffer_load_dwordx4 v8, s[48:51], s69 offen offset:0 lds
    buffer_load_dwordx4 v9, s[48:51], s69 offen offset:1024 lds
    buffer_load_dwordx4 v10, s[48:51], s69 offen offset:2048 lds
    buffer_load_dwordx4 v11, s[48:51], s69 offen offset:3072 lds
    s_cmp_ge_u32 s23, 11
    s_cselect_b32 s68, -11, 5
    s_add_u32 s68, s68, s23
    s_add_u32 s68, s68, s27
    s_mul_i32 s68, s68, 229376
    s_add_u32 s68, s68, s66
    s_mov_b32 m0, 8192
    s_add_u32 s69, s68, 114688
    buffer_load_dwordx4 v8, s[48:51], s68 offen offset:0 lds
    buffer_load_dwordx4 v9, s[48:51], s68 offen offset:1024 lds
    buffer_load_dwordx4 v10, s[48:51], s68 offen offset:2048 lds
    buffer_load_dwordx4 v11, s[48:51], s68 offen offset:3072 lds
    s_mov_b32 m0, 12288
    s_nop 0
    buffer_load_dwordx4 v8, s[48:51], s69 offen offset:0 lds
    buffer_load_dwordx4 v9, s[48:51], s69 offen offset:1024 lds
    buffer_load_dwordx4 v10, s[48:51], s69 offen offset:2048 lds
    buffer_load_dwordx4 v11, s[48:51], s69 offen offset:3072 lds
    s_cmp_ge_u32 s23, 10
    s_cselect_b32 s68, -10, 6
    s_add_u32 s68, s68, s23
    s_add_u32 s68, s68, s27
    s_mul_i32 s68, s68, 229376
    s_add_u32 s68, s68, s66
    s_mov_b32 m0, 65536
    s_add_u32 s69, s68, 114688
    buffer_load_dwordx4 v8, s[48:51], s68 offen offset:0 lds
    buffer_load_dwordx4 v9, s[48:51], s68 offen offset:1024 lds
    buffer_load_dwordx4 v10, s[48:51], s68 offen offset:2048 lds
    buffer_load_dwordx4 v11, s[48:51], s68 offen offset:3072 lds
    s_mov_b32 m0, 69632
    s_nop 0
    buffer_load_dwordx4 v8, s[48:51], s69 offen offset:0 lds
    buffer_load_dwordx4 v9, s[48:51], s69 offen offset:1024 lds
    buffer_load_dwordx4 v10, s[48:51], s69 offen offset:2048 lds
    buffer_load_dwordx4 v11, s[48:51], s69 offen offset:3072 lds
    s_barrier
    s_cmp_ge_u32 s23, 9
    s_cselect_b32 s68, -9, 7
    s_add_u32 s68, s68, s23
    s_add_u32 s68, s68, s27
    s_mul_i32 s68, s68, 229376
    s_add_u32 s68, s68, s66
    s_mov_b32 m0, 16384
    s_add_u32 s69, s68, 114688
    buffer_load_dwordx4 v8, s[48:51], s68 offen offset:0 lds
    buffer_load_dwordx4 v9, s[48:51], s68 offen offset:1024 lds
    buffer_load_dwordx4 v10, s[48:51], s68 offen offset:2048 lds
    buffer_load_dwordx4 v11, s[48:51], s68 offen offset:3072 lds
    s_mov_b32 m0, 20480
    s_nop 0
    buffer_load_dwordx4 v8, s[48:51], s69 offen offset:0 lds
    buffer_load_dwordx4 v9, s[48:51], s69 offen offset:1024 lds
    buffer_load_dwordx4 v10, s[48:51], s69 offen offset:2048 lds
    buffer_load_dwordx4 v11, s[48:51], s69 offen offset:3072 lds
    s_barrier
    s_cmp_ge_u32 s23, 8
    s_cselect_b32 s68, -8, 8
    s_add_u32 s68, s68, s23
    s_add_u32 s68, s68, s27
    s_mul_i32 s68, s68, 229376
    s_add_u32 s68, s68, s66
    s_mov_b32 m0, 24576
    s_add_u32 s69, s68, 114688
    buffer_load_dwordx4 v8, s[48:51], s68 offen offset:0 lds
    buffer_load_dwordx4 v9, s[48:51], s68 offen offset:1024 lds
    buffer_load_dwordx4 v10, s[48:51], s68 offen offset:2048 lds
    buffer_load_dwordx4 v11, s[48:51], s68 offen offset:3072 lds
    s_mov_b32 m0, 28672
    s_nop 0
    buffer_load_dwordx4 v8, s[48:51], s69 offen offset:0 lds
    buffer_load_dwordx4 v9, s[48:51], s69 offen offset:1024 lds
    buffer_load_dwordx4 v10, s[48:51], s69 offen offset:2048 lds
    buffer_load_dwordx4 v11, s[48:51], s69 offen offset:3072 lds
    s_waitcnt vmcnt(48)
    s_barrier
    s_cmp_ge_u32 s23, 7
    s_cselect_b32 s68, -7, 9
    s_add_u32 s68, s68, s23
    s_add_u32 s68, s68, s27
    s_mul_i32 s68, s68, 229376
    s_add_u32 s68, s68, s66
    s_mov_b32 m0, 32768
    s_add_u32 s69, s68, 114688
    buffer_load_dwordx4 v8, s[48:51], s68 offen offset:0 lds
    buffer_load_dwordx4 v9, s[48:51], s68 offen offset:1024 lds
    buffer_load_dwordx4 v10, s[48:51], s68 offen offset:2048 lds
    buffer_load_dwordx4 v11, s[48:51], s68 offen offset:3072 lds
    s_mov_b32 m0, 36864
    s_nop 0
    buffer_load_dwordx4 v8, s[48:51], s69 offen offset:0 lds
    buffer_load_dwordx4 v9, s[48:51], s69 offen offset:1024 lds
    buffer_load_dwordx4 v10, s[48:51], s69 offen offset:2048 lds
    buffer_load_dwordx4 v11, s[48:51], s69 offen offset:3072 lds
    s_waitcnt vmcnt(48)
    s_barrier
    s_cmp_ge_u32 s23, 6
    s_cselect_b32 s68, -6, 10
    s_add_u32 s68, s68, s23
    s_add_u32 s68, s68, s27
    s_mul_i32 s68, s68, 229376
    s_add_u32 s68, s68, s66
    s_mov_b32 m0, 40960
    s_add_u32 s69, s68, 114688
    buffer_load_dwordx4 v8, s[48:51], s68 offen offset:0 lds
    buffer_load_dwordx4 v9, s[48:51], s68 offen offset:1024 lds
    buffer_load_dwordx4 v10, s[48:51], s68 offen offset:2048 lds
    buffer_load_dwordx4 v11, s[48:51], s68 offen offset:3072 lds
    s_mov_b32 m0, 45056
    s_nop 0
    buffer_load_dwordx4 v8, s[48:51], s69 offen offset:0 lds
    buffer_load_dwordx4 v9, s[48:51], s69 offen offset:1024 lds
    buffer_load_dwordx4 v10, s[48:51], s69 offen offset:2048 lds
    buffer_load_dwordx4 v11, s[48:51], s69 offen offset:3072 lds
    s_waitcnt vmcnt(48)
    s_barrier
    s_cmp_ge_u32 s23, 5
    s_cselect_b32 s68, -5, 11
    s_add_u32 s68, s68, s23
    s_add_u32 s68, s68, s27
    s_mul_i32 s68, s68, 229376
    s_add_u32 s68, s68, s66
    s_mov_b32 m0, 49152
    s_add_u32 s69, s68, 114688
    buffer_load_dwordx4 v8, s[48:51], s68 offen offset:0 lds
    buffer_load_dwordx4 v9, s[48:51], s68 offen offset:1024 lds
    buffer_load_dwordx4 v10, s[48:51], s68 offen offset:2048 lds
    buffer_load_dwordx4 v11, s[48:51], s68 offen offset:3072 lds
    s_mov_b32 m0, 53248
    s_nop 0
    buffer_load_dwordx4 v8, s[48:51], s69 offen offset:0 lds
    buffer_load_dwordx4 v9, s[48:51], s69 offen offset:1024 lds
    buffer_load_dwordx4 v10, s[48:51], s69 offen offset:2048 lds
    buffer_load_dwordx4 v11, s[48:51], s69 offen offset:3072 lds
    s_waitcnt vmcnt(48)
    s_barrier
    s_cmp_ge_u32 s23, 4
    s_cselect_b32 s68, -4, 12
    s_add_u32 s68, s68, s23
    s_add_u32 s68, s68, s27
    s_mul_i32 s68, s68, 229376
    s_add_u32 s68, s68, s66
    s_mov_b32 m0, 0
    s_add_u32 s69, s68, 114688
    buffer_load_dwordx4 v8, s[48:51], s68 offen offset:0 lds
    buffer_load_dwordx4 v9, s[48:51], s68 offen offset:1024 lds
    buffer_load_dwordx4 v10, s[48:51], s68 offen offset:2048 lds
    buffer_load_dwordx4 v11, s[48:51], s68 offen offset:3072 lds
    s_mov_b32 m0, 4096
    s_nop 0
    buffer_load_dwordx4 v8, s[48:51], s69 offen offset:0 lds
    buffer_load_dwordx4 v9, s[48:51], s69 offen offset:1024 lds
    buffer_load_dwordx4 v10, s[48:51], s69 offen offset:2048 lds
    buffer_load_dwordx4 v11, s[48:51], s69 offen offset:3072 lds
    s_waitcnt vmcnt(48)
    s_barrier
    s_cmp_ge_u32 s23, 3
    s_cselect_b32 s68, -3, 13
    s_add_u32 s68, s68, s23
    s_add_u32 s68, s68, s27
    s_mul_i32 s68, s68, 229376
    s_add_u32 s68, s68, s66
    s_mov_b32 m0, 8192
    s_add_u32 s69, s68, 114688
    buffer_load_dwordx4 v8, s[48:51], s68 offen offset:0 lds
    buffer_load_dwordx4 v9, s[48:51], s68 offen offset:1024 lds
    buffer_load_dwordx4 v10, s[48:51], s68 offen offset:2048 lds
    buffer_load_dwordx4 v11, s[48:51], s68 offen offset:3072 lds
    s_mov_b32 m0, 12288
    s_nop 0
    buffer_load_dwordx4 v8, s[48:51], s69 offen offset:0 lds
    buffer_load_dwordx4 v9, s[48:51], s69 offen offset:1024 lds
    buffer_load_dwordx4 v10, s[48:51], s69 offen offset:2048 lds
    buffer_load_dwordx4 v11, s[48:51], s69 offen offset:3072 lds
    s_waitcnt vmcnt(48)
    s_barrier
    s_waitcnt vmcnt(40)
    s_barrier
    s_cmp_ge_u32 s23, 2
    s_cselect_b32 s68, -2, 14
    s_add_u32 s68, s68, s23
    s_add_u32 s68, s68, s27
    s_mul_i32 s68, s68, 229376
    s_add_u32 s68, s68, s66
    s_mov_b32 m0, 16384
    s_add_u32 s69, s68, 114688
    buffer_load_dwordx4 v8, s[48:51], s68 offen offset:0 lds
    buffer_load_dwordx4 v9, s[48:51], s68 offen offset:1024 lds
    buffer_load_dwordx4 v10, s[48:51], s68 offen offset:2048 lds
    buffer_load_dwordx4 v11, s[48:51], s68 offen offset:3072 lds
    s_mov_b32 m0, 20480
    s_nop 0
    buffer_load_dwordx4 v8, s[48:51], s69 offen offset:0 lds
    buffer_load_dwordx4 v9, s[48:51], s69 offen offset:1024 lds
    buffer_load_dwordx4 v10, s[48:51], s69 offen offset:2048 lds
    buffer_load_dwordx4 v11, s[48:51], s69 offen offset:3072 lds
    s_waitcnt vmcnt(40)
    s_barrier
    s_cmp_ge_u32 s23, 1
    s_cselect_b32 s68, -1, 15
    s_add_u32 s68, s68, s23
    s_add_u32 s68, s68, s27
    s_mul_i32 s68, s68, 229376
    s_add_u32 s68, s68, s66
    s_mov_b32 m0, 24576
    s_add_u32 s69, s68, 114688
    buffer_load_dwordx4 v8, s[48:51], s68 offen offset:0 lds
    buffer_load_dwordx4 v9, s[48:51], s68 offen offset:1024 lds
    buffer_load_dwordx4 v10, s[48:51], s68 offen offset:2048 lds
    buffer_load_dwordx4 v11, s[48:51], s68 offen offset:3072 lds
    s_mov_b32 m0, 28672
    s_nop 0
    buffer_load_dwordx4 v8, s[48:51], s69 offen offset:0 lds
    buffer_load_dwordx4 v9, s[48:51], s69 offen offset:1024 lds
    buffer_load_dwordx4 v10, s[48:51], s69 offen offset:2048 lds
    buffer_load_dwordx4 v11, s[48:51], s69 offen offset:3072 lds
    s_waitcnt vmcnt(40)
    s_barrier
    s_add_u32 s68, s26, 0
    s_add_u32 s68, s68, s30
    s_mul_i32 s68, s68, 229376
    s_add_u32 s68, s68, s66
    s_mov_b32 m0, 32768
    s_add_u32 s69, s68, 114688
    buffer_load_dwordx4 v8, s[48:51], s68 offen offset:0 lds
    buffer_load_dwordx4 v9, s[48:51], s68 offen offset:1024 lds
    buffer_load_dwordx4 v10, s[48:51], s68 offen offset:2048 lds
    buffer_load_dwordx4 v11, s[48:51], s68 offen offset:3072 lds
    s_mov_b32 m0, 36864
    s_nop 0
    buffer_load_dwordx4 v8, s[48:51], s69 offen offset:0 lds
    buffer_load_dwordx4 v9, s[48:51], s69 offen offset:1024 lds
    buffer_load_dwordx4 v10, s[48:51], s69 offen offset:2048 lds
    buffer_load_dwordx4 v11, s[48:51], s69 offen offset:3072 lds
    s_waitcnt vmcnt(40)
    s_barrier
    s_cmp_ge_u32 s26, 15
    s_cselect_b32 s68, -15, 1
    s_add_u32 s68, s68, s26
    s_add_u32 s68, s68, s30
    s_mul_i32 s68, s68, 229376
    s_add_u32 s68, s68, s66
    s_mov_b32 m0, 40960
    s_add_u32 s69, s68, 114688
    buffer_load_dwordx4 v8, s[48:51], s68 offen offset:0 lds
    buffer_load_dwordx4 v9, s[48:51], s68 offen offset:1024 lds
    buffer_load_dwordx4 v10, s[48:51], s68 offen offset:2048 lds
    buffer_load_dwordx4 v11, s[48:51], s68 offen offset:3072 lds
    s_mov_b32 m0, 45056
    s_nop 0
    buffer_load_dwordx4 v8, s[48:51], s69 offen offset:0 lds
    buffer_load_dwordx4 v9, s[48:51], s69 offen offset:1024 lds
    buffer_load_dwordx4 v10, s[48:51], s69 offen offset:2048 lds
    buffer_load_dwordx4 v11, s[48:51], s69 offen offset:3072 lds
    s_waitcnt vmcnt(40)
    s_barrier
    s_cmp_ge_u32 s26, 14
    s_cselect_b32 s68, -14, 2
    s_add_u32 s68, s68, s26
    s_add_u32 s68, s68, s30
    s_mul_i32 s68, s68, 229376
    s_add_u32 s68, s68, s66
    s_mov_b32 m0, 49152
    s_add_u32 s69, s68, 114688
    buffer_load_dwordx4 v8, s[48:51], s68 offen offset:0 lds
    buffer_load_dwordx4 v9, s[48:51], s68 offen offset:1024 lds
    buffer_load_dwordx4 v10, s[48:51], s68 offen offset:2048 lds
    buffer_load_dwordx4 v11, s[48:51], s68 offen offset:3072 lds
    s_mov_b32 m0, 53248
    s_nop 0
    buffer_load_dwordx4 v8, s[48:51], s69 offen offset:0 lds
    buffer_load_dwordx4 v9, s[48:51], s69 offen offset:1024 lds
    buffer_load_dwordx4 v10, s[48:51], s69 offen offset:2048 lds
    buffer_load_dwordx4 v11, s[48:51], s69 offen offset:3072 lds
    s_waitcnt vmcnt(40)
    s_barrier
    s_cmp_ge_u32 s26, 13
    s_cselect_b32 s68, -13, 3
    s_add_u32 s68, s68, s26
    s_add_u32 s68, s68, s30
    s_mul_i32 s68, s68, 229376
    s_add_u32 s68, s68, s66
    s_mov_b32 m0, 0
    s_add_u32 s69, s68, 114688
    buffer_load_dwordx4 v8, s[48:51], s68 offen offset:0 lds
    buffer_load_dwordx4 v9, s[48:51], s68 offen offset:1024 lds
    buffer_load_dwordx4 v10, s[48:51], s68 offen offset:2048 lds
    buffer_load_dwordx4 v11, s[48:51], s68 offen offset:3072 lds
    s_mov_b32 m0, 4096
    s_nop 0
    buffer_load_dwordx4 v8, s[48:51], s69 offen offset:0 lds
    buffer_load_dwordx4 v9, s[48:51], s69 offen offset:1024 lds
    buffer_load_dwordx4 v10, s[48:51], s69 offen offset:2048 lds
    buffer_load_dwordx4 v11, s[48:51], s69 offen offset:3072 lds
    s_waitcnt vmcnt(40)
    s_barrier
    s_waitcnt vmcnt(32)
    s_barrier
    s_cmp_ge_u32 s26, 12
    s_cselect_b32 s68, -12, 4
    s_add_u32 s68, s68, s26
    s_add_u32 s68, s68, s30
    s_mul_i32 s68, s68, 229376
    s_add_u32 s68, s68, s66
    s_mov_b32 m0, 8192
    s_add_u32 s69, s68, 114688
    buffer_load_dwordx4 v8, s[48:51], s68 offen offset:0 lds
    buffer_load_dwordx4 v9, s[48:51], s68 offen offset:1024 lds
    buffer_load_dwordx4 v10, s[48:51], s68 offen offset:2048 lds
    buffer_load_dwordx4 v11, s[48:51], s68 offen offset:3072 lds
    s_mov_b32 m0, 12288
    s_nop 0
    buffer_load_dwordx4 v8, s[48:51], s69 offen offset:0 lds
    buffer_load_dwordx4 v9, s[48:51], s69 offen offset:1024 lds
    buffer_load_dwordx4 v10, s[48:51], s69 offen offset:2048 lds
    buffer_load_dwordx4 v11, s[48:51], s69 offen offset:3072 lds
    s_waitcnt vmcnt(32)
    s_barrier
    s_cmp_ge_u32 s26, 11
    s_cselect_b32 s68, -11, 5
    s_add_u32 s68, s68, s26
    s_add_u32 s68, s68, s30
    s_mul_i32 s68, s68, 229376
    s_add_u32 s68, s68, s66
    s_mov_b32 m0, 16384
    s_add_u32 s69, s68, 114688
    buffer_load_dwordx4 v8, s[48:51], s68 offen offset:0 lds
    buffer_load_dwordx4 v9, s[48:51], s68 offen offset:1024 lds
    buffer_load_dwordx4 v10, s[48:51], s68 offen offset:2048 lds
    buffer_load_dwordx4 v11, s[48:51], s68 offen offset:3072 lds
    s_mov_b32 m0, 20480
    s_nop 0
    buffer_load_dwordx4 v8, s[48:51], s69 offen offset:0 lds
    buffer_load_dwordx4 v9, s[48:51], s69 offen offset:1024 lds
    buffer_load_dwordx4 v10, s[48:51], s69 offen offset:2048 lds
    buffer_load_dwordx4 v11, s[48:51], s69 offen offset:3072 lds
    s_waitcnt vmcnt(32)
    s_barrier
    s_cmp_ge_u32 s26, 10
    s_cselect_b32 s68, -10, 6
    s_add_u32 s68, s68, s26
    s_add_u32 s68, s68, s30
    s_mul_i32 s68, s68, 229376
    s_add_u32 s68, s68, s66
    s_mov_b32 m0, 24576
    s_add_u32 s69, s68, 114688
    buffer_load_dwordx4 v8, s[48:51], s68 offen offset:0 lds
    buffer_load_dwordx4 v9, s[48:51], s68 offen offset:1024 lds
    buffer_load_dwordx4 v10, s[48:51], s68 offen offset:2048 lds
    buffer_load_dwordx4 v11, s[48:51], s68 offen offset:3072 lds
    s_mov_b32 m0, 28672
    s_nop 0
    buffer_load_dwordx4 v8, s[48:51], s69 offen offset:0 lds
    buffer_load_dwordx4 v9, s[48:51], s69 offen offset:1024 lds
    buffer_load_dwordx4 v10, s[48:51], s69 offen offset:2048 lds
    buffer_load_dwordx4 v11, s[48:51], s69 offen offset:3072 lds
    s_waitcnt vmcnt(32)
    s_barrier
    s_cmp_ge_u32 s26, 9
    s_cselect_b32 s68, -9, 7
    s_add_u32 s68, s68, s26
    s_add_u32 s68, s68, s30
    s_mul_i32 s68, s68, 229376
    s_add_u32 s68, s68, s66
    s_mov_b32 m0, 32768
    s_add_u32 s69, s68, 114688
    buffer_load_dwordx4 v8, s[48:51], s68 offen offset:0 lds
    buffer_load_dwordx4 v9, s[48:51], s68 offen offset:1024 lds
    buffer_load_dwordx4 v10, s[48:51], s68 offen offset:2048 lds
    buffer_load_dwordx4 v11, s[48:51], s68 offen offset:3072 lds
    s_mov_b32 m0, 36864
    s_nop 0
    buffer_load_dwordx4 v8, s[48:51], s69 offen offset:0 lds
    buffer_load_dwordx4 v9, s[48:51], s69 offen offset:1024 lds
    buffer_load_dwordx4 v10, s[48:51], s69 offen offset:2048 lds
    buffer_load_dwordx4 v11, s[48:51], s69 offen offset:3072 lds
    s_waitcnt vmcnt(32)
    s_barrier
    s_cmp_ge_u32 s26, 8
    s_cselect_b32 s68, -8, 8
    s_add_u32 s68, s68, s26
    s_add_u32 s68, s68, s30
    s_mul_i32 s68, s68, 229376
    s_add_u32 s68, s68, s66
    s_mov_b32 m0, 40960
    s_add_u32 s69, s68, 114688
    buffer_load_dwordx4 v8, s[48:51], s68 offen offset:0 lds
    buffer_load_dwordx4 v9, s[48:51], s68 offen offset:1024 lds
    buffer_load_dwordx4 v10, s[48:51], s68 offen offset:2048 lds
    buffer_load_dwordx4 v11, s[48:51], s68 offen offset:3072 lds
    s_mov_b32 m0, 45056
    s_nop 0
    buffer_load_dwordx4 v8, s[48:51], s69 offen offset:0 lds
    buffer_load_dwordx4 v9, s[48:51], s69 offen offset:1024 lds
    buffer_load_dwordx4 v10, s[48:51], s69 offen offset:2048 lds
    buffer_load_dwordx4 v11, s[48:51], s69 offen offset:3072 lds
    s_waitcnt vmcnt(32)
    s_barrier
    s_cmp_ge_u32 s26, 7
    s_cselect_b32 s68, -7, 9
    s_add_u32 s68, s68, s26
    s_add_u32 s68, s68, s30
    s_mul_i32 s68, s68, 229376
    s_add_u32 s68, s68, s66
    s_mov_b32 m0, 0
    s_add_u32 s69, s68, 114688
    buffer_load_dwordx4 v8, s[48:51], s68 offen offset:0 lds
    buffer_load_dwordx4 v9, s[48:51], s68 offen offset:1024 lds
    buffer_load_dwordx4 v10, s[48:51], s68 offen offset:2048 lds
    buffer_load_dwordx4 v11, s[48:51], s68 offen offset:3072 lds
    s_mov_b32 m0, 4096
    s_nop 0
    buffer_load_dwordx4 v8, s[48:51], s69 offen offset:0 lds
    buffer_load_dwordx4 v9, s[48:51], s69 offen offset:1024 lds
    buffer_load_dwordx4 v10, s[48:51], s69 offen offset:2048 lds
    buffer_load_dwordx4 v11, s[48:51], s69 offen offset:3072 lds
    s_waitcnt vmcnt(32)
    s_barrier
    s_waitcnt vmcnt(24)
    s_barrier
    s_cmp_ge_u32 s26, 6
    s_cselect_b32 s68, -6, 10
    s_add_u32 s68, s68, s26
    s_add_u32 s68, s68, s30
    s_mul_i32 s68, s68, 229376
    s_add_u32 s68, s68, s66
    s_mov_b32 m0, 8192
    s_add_u32 s69, s68, 114688
    buffer_load_dwordx4 v8, s[48:51], s68 offen offset:0 lds
    buffer_load_dwordx4 v9, s[48:51], s68 offen offset:1024 lds
    buffer_load_dwordx4 v10, s[48:51], s68 offen offset:2048 lds
    buffer_load_dwordx4 v11, s[48:51], s68 offen offset:3072 lds
    s_mov_b32 m0, 12288
    s_nop 0
    buffer_load_dwordx4 v8, s[48:51], s69 offen offset:0 lds
    buffer_load_dwordx4 v9, s[48:51], s69 offen offset:1024 lds
    buffer_load_dwordx4 v10, s[48:51], s69 offen offset:2048 lds
    buffer_load_dwordx4 v11, s[48:51], s69 offen offset:3072 lds
    s_waitcnt vmcnt(24)
    s_barrier
    s_cmp_ge_u32 s26, 5
    s_cselect_b32 s68, -5, 11
    s_add_u32 s68, s68, s26
    s_add_u32 s68, s68, s30
    s_mul_i32 s68, s68, 229376
    s_add_u32 s68, s68, s66
    s_mov_b32 m0, 16384
    s_add_u32 s69, s68, 114688
    buffer_load_dwordx4 v8, s[48:51], s68 offen offset:0 lds
    buffer_load_dwordx4 v9, s[48:51], s68 offen offset:1024 lds
    buffer_load_dwordx4 v10, s[48:51], s68 offen offset:2048 lds
    buffer_load_dwordx4 v11, s[48:51], s68 offen offset:3072 lds
    s_mov_b32 m0, 20480
    s_nop 0
    buffer_load_dwordx4 v8, s[48:51], s69 offen offset:0 lds
    buffer_load_dwordx4 v9, s[48:51], s69 offen offset:1024 lds
    buffer_load_dwordx4 v10, s[48:51], s69 offen offset:2048 lds
    buffer_load_dwordx4 v11, s[48:51], s69 offen offset:3072 lds
    s_waitcnt vmcnt(24)
    s_barrier
    s_cmp_ge_u32 s26, 4
    s_cselect_b32 s68, -4, 12
    s_add_u32 s68, s68, s26
    s_add_u32 s68, s68, s30
    s_mul_i32 s68, s68, 229376
    s_add_u32 s68, s68, s66
    s_mov_b32 m0, 24576
    s_add_u32 s69, s68, 114688
    buffer_load_dwordx4 v8, s[48:51], s68 offen offset:0 lds
    buffer_load_dwordx4 v9, s[48:51], s68 offen offset:1024 lds
    buffer_load_dwordx4 v10, s[48:51], s68 offen offset:2048 lds
    buffer_load_dwordx4 v11, s[48:51], s68 offen offset:3072 lds
    s_mov_b32 m0, 28672
    s_nop 0
    buffer_load_dwordx4 v8, s[48:51], s69 offen offset:0 lds
    buffer_load_dwordx4 v9, s[48:51], s69 offen offset:1024 lds
    buffer_load_dwordx4 v10, s[48:51], s69 offen offset:2048 lds
    buffer_load_dwordx4 v11, s[48:51], s69 offen offset:3072 lds
    s_waitcnt vmcnt(24)
    s_barrier
    s_cmp_ge_u32 s26, 3
    s_cselect_b32 s68, -3, 13
    s_add_u32 s68, s68, s26
    s_add_u32 s68, s68, s30
    s_mul_i32 s68, s68, 229376
    s_add_u32 s68, s68, s66
    s_mov_b32 m0, 32768
    s_add_u32 s69, s68, 114688
    buffer_load_dwordx4 v8, s[48:51], s68 offen offset:0 lds
    buffer_load_dwordx4 v9, s[48:51], s68 offen offset:1024 lds
    buffer_load_dwordx4 v10, s[48:51], s68 offen offset:2048 lds
    buffer_load_dwordx4 v11, s[48:51], s68 offen offset:3072 lds
    s_mov_b32 m0, 36864
    s_nop 0
    buffer_load_dwordx4 v8, s[48:51], s69 offen offset:0 lds
    buffer_load_dwordx4 v9, s[48:51], s69 offen offset:1024 lds
    buffer_load_dwordx4 v10, s[48:51], s69 offen offset:2048 lds
    buffer_load_dwordx4 v11, s[48:51], s69 offen offset:3072 lds
    s_waitcnt vmcnt(24)
    s_barrier
    s_cmp_ge_u32 s26, 2
    s_cselect_b32 s68, -2, 14
    s_add_u32 s68, s68, s26
    s_add_u32 s68, s68, s30
    s_mul_i32 s68, s68, 229376
    s_add_u32 s68, s68, s66
    s_mov_b32 m0, 0
    s_add_u32 s69, s68, 114688
    buffer_load_dwordx4 v8, s[48:51], s68 offen offset:0 lds
    buffer_load_dwordx4 v9, s[48:51], s68 offen offset:1024 lds
    buffer_load_dwordx4 v10, s[48:51], s68 offen offset:2048 lds
    buffer_load_dwordx4 v11, s[48:51], s68 offen offset:3072 lds
    s_mov_b32 m0, 4096
    s_nop 0
    buffer_load_dwordx4 v8, s[48:51], s69 offen offset:0 lds
    buffer_load_dwordx4 v9, s[48:51], s69 offen offset:1024 lds
    buffer_load_dwordx4 v10, s[48:51], s69 offen offset:2048 lds
    buffer_load_dwordx4 v11, s[48:51], s69 offen offset:3072 lds
    s_waitcnt vmcnt(24)
    s_barrier
    s_cmp_ge_u32 s26, 1
    s_cselect_b32 s68, -1, 15
    s_add_u32 s68, s68, s26
    s_add_u32 s68, s68, s30
    s_mul_i32 s68, s68, 229376
    s_add_u32 s68, s68, s66
    s_mov_b32 m0, 8192
    s_add_u32 s69, s68, 114688
    buffer_load_dwordx4 v8, s[48:51], s68 offen offset:0 lds
    buffer_load_dwordx4 v9, s[48:51], s68 offen offset:1024 lds
    buffer_load_dwordx4 v10, s[48:51], s68 offen offset:2048 lds
    buffer_load_dwordx4 v11, s[48:51], s68 offen offset:3072 lds
    s_mov_b32 m0, 12288
    s_nop 0
    buffer_load_dwordx4 v8, s[48:51], s69 offen offset:0 lds
    buffer_load_dwordx4 v9, s[48:51], s69 offen offset:1024 lds
    buffer_load_dwordx4 v10, s[48:51], s69 offen offset:2048 lds
    buffer_load_dwordx4 v11, s[48:51], s69 offen offset:3072 lds
    s_waitcnt vmcnt(24)
    s_barrier
    s_waitcnt vmcnt(16)
    s_barrier
    s_add_u32 s68, s61, 0
    s_and_b32 s68, s68, 7
    s_mul_i32 s68, s68, 65536
    s_add_u32 s68, s68, s65
    s_mov_b32 m0, 16384
    s_add_u32 s69, s68, 32768
    buffer_load_dwordx4 v12, s[52:55], s68 offen offset:0 lds
    buffer_load_dwordx4 v13, s[52:55], s68 offen offset:1024 lds
    buffer_load_dwordx4 v14, s[52:55], s68 offen offset:2048 lds
    buffer_load_dwordx4 v15, s[52:55], s68 offen offset:3072 lds
    s_mov_b32 m0, 20480
    s_nop 0
    buffer_load_dwordx4 v12, s[52:55], s69 offen offset:0 lds
    buffer_load_dwordx4 v13, s[52:55], s69 offen offset:1024 lds
    buffer_load_dwordx4 v14, s[52:55], s69 offen offset:2048 lds
    buffer_load_dwordx4 v15, s[52:55], s69 offen offset:3072 lds
    s_waitcnt vmcnt(16)
    s_barrier
    s_add_u32 s68, s61, 1
    s_and_b32 s68, s68, 7
    s_mul_i32 s68, s68, 65536
    s_add_u32 s68, s68, s65
    s_mov_b32 m0, 24576
    s_add_u32 s69, s68, 32768
    buffer_load_dwordx4 v12, s[52:55], s68 offen offset:0 lds
    buffer_load_dwordx4 v13, s[52:55], s68 offen offset:1024 lds
    buffer_load_dwordx4 v14, s[52:55], s68 offen offset:2048 lds
    buffer_load_dwordx4 v15, s[52:55], s68 offen offset:3072 lds
    s_mov_b32 m0, 28672
    s_nop 0
    buffer_load_dwordx4 v12, s[52:55], s69 offen offset:0 lds
    buffer_load_dwordx4 v13, s[52:55], s69 offen offset:1024 lds
    buffer_load_dwordx4 v14, s[52:55], s69 offen offset:2048 lds
    buffer_load_dwordx4 v15, s[52:55], s69 offen offset:3072 lds
    s_waitcnt vmcnt(16)
    s_barrier
    s_add_u32 s68, s61, 2
    s_and_b32 s68, s68, 7
    s_mul_i32 s68, s68, 65536
    s_add_u32 s68, s68, s65
    s_mov_b32 m0, 0
    s_add_u32 s69, s68, 32768
    buffer_load_dwordx4 v12, s[52:55], s68 offen offset:0 lds
    buffer_load_dwordx4 v13, s[52:55], s68 offen offset:1024 lds
    buffer_load_dwordx4 v14, s[52:55], s68 offen offset:2048 lds
    buffer_load_dwordx4 v15, s[52:55], s68 offen offset:3072 lds
    s_mov_b32 m0, 4096
    s_nop 0
    buffer_load_dwordx4 v12, s[52:55], s69 offen offset:0 lds
    buffer_load_dwordx4 v13, s[52:55], s69 offen offset:1024 lds
    buffer_load_dwordx4 v14, s[52:55], s69 offen offset:2048 lds
    buffer_load_dwordx4 v15, s[52:55], s69 offen offset:3072 lds
    s_add_u32 s68, s61, 3
    s_and_b32 s68, s68, 7
    s_mul_i32 s68, s68, 65536
    s_add_u32 s68, s68, s65
    s_mov_b32 m0, 32768
    s_add_u32 s69, s68, 32768
    buffer_load_dwordx4 v12, s[52:55], s68 offen offset:0 lds
    buffer_load_dwordx4 v13, s[52:55], s68 offen offset:1024 lds
    buffer_load_dwordx4 v14, s[52:55], s68 offen offset:2048 lds
    buffer_load_dwordx4 v15, s[52:55], s68 offen offset:3072 lds
    s_mov_b32 m0, 36864
    s_nop 0
    buffer_load_dwordx4 v12, s[52:55], s69 offen offset:0 lds
    buffer_load_dwordx4 v13, s[52:55], s69 offen offset:1024 lds
    buffer_load_dwordx4 v14, s[52:55], s69 offen offset:2048 lds
    buffer_load_dwordx4 v15, s[52:55], s69 offen offset:3072 lds
    s_branch tl_q
tl_spare:
    v_mul_u32_u24 v12, 1024, v23
    v_add_u32 v12, v12, v22
    v_add_u32 v13, 7168, v12
    v_add_u32 v14, 14336, v12
    v_add_u32 v15, 21504, v12
    v_mul_u32_u24 v16, 4096, v23
    v_add_u32 v16, v16, v22
    v_add_u32 v17, 31744, v16
    v_add_u32 v18, 63488, v16
    v_add_u32 v19, 95232, v16
    v_lshlrev_b32 v25, 4, v1
    s_mul_i32 s32, s10, 112
    s_mul_i32 s64, s9, 224
    s_add_u32 s32, s32, s64
    s_lshr_b32 s32, s32, 6
    s_sub_u32 s64, s32, 14
    s_cmp_ge_u32 s32, 14
    s_cselect_b32 s32, s64, s32
    s_mul_i32 s33, s10, 112
    s_lshr_b32 s33, s33, 6
    s_sub_u32 s64, s33, 14
    s_cmp_ge_u32 s33, 14
    s_cselect_b32 s33, s64, s33
    s_and_b32 s34, s4, 1
    s_mul_i32 s34, s34, 14
    s_sub_u32 s35, 14, s34
    s_lshl_b32 s61, s9, 1
    s_add_u32 s61, s61, s10
    s_lshl_b32 s67, s6, 7
    s_xor_b32 s64, s7, 4
    s_lshl_b32 s76, s64, 18
    s_add_u32 s76, s76, 0x10000
    s_mul_i32 s77, s64, 229376
    s_add_u32 s77, s77, 0x220000
    s_waitcnt vmcnt(16)
    s_barrier
    s_add_u32 s68, s60, 2
    s_and_b32 s68, s68, 3
    s_or_b32 s68, s68, s62
    s_mul_i32 s68, s68, 196608
    s_add_u32 s68, s68, s65
    s_mov_b32 m0, 49152
    s_add_u32 s69, s68, 98304
    buffer_load_dwordx4 v4, s[44:47], s68 offen offset:0 lds
    buffer_load_dwordx4 v5, s[44:47], s68 offen offset:1024 lds
    buffer_load_dwordx4 v6, s[44:47], s68 offen offset:2048 lds
    buffer_load_dwordx4 v7, s[44:47], s68 offen offset:3072 lds
    s_mov_b32 m0, 53248
    s_nop 0
    buffer_load_dwordx4 v4, s[44:47], s69 offen offset:0 lds
    buffer_load_dwordx4 v5, s[44:47], s69 offen offset:1024 lds
    buffer_load_dwordx4 v6, s[44:47], s69 offen offset:2048 lds
    buffer_load_dwordx4 v7, s[44:47], s69 offen offset:3072 lds
    s_add_u32 s68, s68, 1024
    s_mov_b32 m0, 57344
    s_add_u32 s69, s68, 98304
    buffer_load_dwordx4 v4, s[44:47], s68 offen offset:0 lds
    buffer_load_dwordx4 v5, s[44:47], s68 offen offset:1024 lds
    buffer_load_dwordx4 v6, s[44:47], s68 offen offset:2048 lds
    buffer_load_dwordx4 v7, s[44:47], s68 offen offset:3072 lds
    s_mov_b32 m0, 61440
    s_nop 0
    buffer_load_dwordx4 v4, s[44:47], s69 offen offset:0 lds
    buffer_load_dwordx4 v5, s[44:47], s69 offen offset:1024 lds
    buffer_load_dwordx4 v6, s[44:47], s69 offen offset:2048 lds
    buffer_load_dwordx4 v7, s[44:47], s69 offen offset:3072 lds
    s_waitcnt vmcnt(16)
    s_barrier
    s_add_u32 s68, s60, 3
    s_and_b32 s68, s68, 3
    s_or_b32 s68, s68, s62
    s_mul_i32 s68, s68, 196608
    s_add_u32 s68, s68, s65
    s_mov_b32 m0, 0
    s_add_u32 s69, s68, 98304
    buffer_load_dwordx4 v4, s[44:47], s68 offen offset:0 lds
    buffer_load_dwordx4 v5, s[44:47], s68 offen offset:1024 lds
    buffer_load_dwordx4 v6, s[44:47], s68 offen offset:2048 lds
    buffer_load_dwordx4 v7, s[44:47], s68 offen offset:3072 lds
    s_mov_b32 m0, 4096
    s_nop 0
    buffer_load_dwordx4 v4, s[44:47], s69 offen offset:0 lds
    buffer_load_dwordx4 v5, s[44:47], s69 offen offset:1024 lds
    buffer_load_dwordx4 v6, s[44:47], s69 offen offset:2048 lds
    buffer_load_dwordx4 v7, s[44:47], s69 offen offset:3072 lds
    s_add_u32 s68, s68, 1024
    s_mov_b32 m0, 8192
    s_add_u32 s69, s68, 98304
    buffer_load_dwordx4 v4, s[44:47], s68 offen offset:0 lds
    buffer_load_dwordx4 v5, s[44:47], s68 offen offset:1024 lds
    buffer_load_dwordx4 v6, s[44:47], s68 offen offset:2048 lds
    buffer_load_dwordx4 v7, s[44:47], s68 offen offset:3072 lds
    s_mov_b32 m0, 12288
    s_nop 0
    buffer_load_dwordx4 v4, s[44:47], s69 offen offset:0 lds
    buffer_load_dwordx4 v5, s[44:47], s69 offen offset:1024 lds
    buffer_load_dwordx4 v6, s[44:47], s69 offen offset:2048 lds
    buffer_load_dwordx4 v7, s[44:47], s69 offen offset:3072 lds
    s_waitcnt vmcnt(16)
    s_barrier
    s_add_u32 s68, s60, 0
    s_and_b32 s68, s68, 3
    s_or_b32 s68, s68, s62
    s_xor_b32 s68, s68, 4
    s_mul_i32 s68, s68, 196608
    s_add_u32 s68, s68, s65
    s_mov_b32 m0, 16384
    s_add_u32 s69, s68, 98304
    buffer_load_dwordx4 v4, s[44:47], s68 offen offset:0 lds
    buffer_load_dwordx4 v5, s[44:47], s68 offen offset:1024 lds
    buffer_load_dwordx4 v6, s[44:47], s68 offen offset:2048 lds
    buffer_load_dwordx4 v7, s[44:47], s68 offen offset:3072 lds
    s_mov_b32 m0, 20480
    s_nop 0
    buffer_load_dwordx4 v4, s[44:47], s69 offen offset:0 lds
    buffer_load_dwordx4 v5, s[44:47], s69 offen offset:1024 lds
    buffer_load_dwordx4 v6, s[44:47], s69 offen offset:2048 lds
    buffer_load_dwordx4 v7, s[44:47], s69 offen offset:3072 lds
    s_add_u32 s68, s68, 1024
    s_mov_b32 m0, 24576
    s_add_u32 s69, s68, 98304
    buffer_load_dwordx4 v4, s[44:47], s68 offen offset:0 lds
    buffer_load_dwordx4 v5, s[44:47], s68 offen offset:1024 lds
    buffer_load_dwordx4 v6, s[44:47], s68 offen offset:2048 lds
    buffer_load_dwordx4 v7, s[44:47], s68 offen offset:3072 lds
    s_mov_b32 m0, 28672
    s_nop 0
    buffer_load_dwordx4 v4, s[44:47], s69 offen offset:0 lds
    buffer_load_dwordx4 v5, s[44:47], s69 offen offset:1024 lds
    buffer_load_dwordx4 v6, s[44:47], s69 offen offset:2048 lds
    buffer_load_dwordx4 v7, s[44:47], s69 offen offset:3072 lds
    s_waitcnt vmcnt(16)
    s_barrier
    s_add_u32 s68, s60, 1
    s_and_b32 s68, s68, 3
    s_or_b32 s68, s68, s62
    s_xor_b32 s68, s68, 4
    s_mul_i32 s68, s68, 196608
    s_add_u32 s68, s68, s65
    s_mov_b32 m0, 49152
    s_add_u32 s69, s68, 98304
    buffer_load_dwordx4 v4, s[44:47], s68 offen offset:0 lds
    buffer_load_dwordx4 v5, s[44:47], s68 offen offset:1024 lds
    buffer_load_dwordx4 v6, s[44:47], s68 offen offset:2048 lds
    buffer_load_dwordx4 v7, s[44:47], s68 offen offset:3072 lds
    s_mov_b32 m0, 53248
    s_nop 0
    buffer_load_dwordx4 v4, s[44:47], s69 offen offset:0 lds
    buffer_load_dwordx4 v5, s[44:47], s69 offen offset:1024 lds
    buffer_load_dwordx4 v6, s[44:47], s69 offen offset:2048 lds
    buffer_load_dwordx4 v7, s[44:47], s69 offen offset:3072 lds
    s_add_u32 s68, s68, 1024
    s_mov_b32 m0, 57344
    s_add_u32 s69, s68, 98304
    buffer_load_dwordx4 v4, s[44:47], s68 offen offset:0 lds
    buffer_load_dwordx4 v5, s[44:47], s68 offen offset:1024 lds
    buffer_load_dwordx4 v6, s[44:47], s68 offen offset:2048 lds
    buffer_load_dwordx4 v7, s[44:47], s68 offen offset:3072 lds
    s_mov_b32 m0, 61440
    s_nop 0
    buffer_load_dwordx4 v4, s[44:47], s69 offen offset:0 lds
    buffer_load_dwordx4 v5, s[44:47], s69 offen offset:1024 lds
    buffer_load_dwordx4 v6, s[44:47], s69 offen offset:2048 lds
    buffer_load_dwordx4 v7, s[44:47], s69 offen offset:3072 lds
    s_waitcnt vmcnt(16)
    s_barrier
    s_add_u32 s68, s60, 2
    s_and_b32 s68, s68, 3
    s_or_b32 s68, s68, s62
    s_xor_b32 s68, s68, 4
    s_mul_i32 s68, s68, 196608
    s_add_u32 s68, s68, s65
    s_mov_b32 m0, 0
    s_add_u32 s69, s68, 98304
    buffer_load_dwordx4 v4, s[44:47], s68 offen offset:0 lds
    buffer_load_dwordx4 v5, s[44:47], s68 offen offset:1024 lds
    buffer_load_dwordx4 v6, s[44:47], s68 offen offset:2048 lds
    buffer_load_dwordx4 v7, s[44:47], s68 offen offset:3072 lds
    s_mov_b32 m0, 4096
    s_nop 0
    buffer_load_dwordx4 v4, s[44:47], s69 offen offset:0 lds
    buffer_load_dwordx4 v5, s[44:47], s69 offen offset:1024 lds
    buffer_load_dwordx4 v6, s[44:47], s69 offen offset:2048 lds
    buffer_load_dwordx4 v7, s[44:47], s69 offen offset:3072 lds
    s_add_u32 s68, s68, 1024
    s_mov_b32 m0, 8192
    s_add_u32 s69, s68, 98304
    buffer_load_dwordx4 v4, s[44:47], s68 offen offset:0 lds
    buffer_load_dwordx4 v5, s[44:47], s68 offen offset:1024 lds
    buffer_load_dwordx4 v6, s[44:47], s68 offen offset:2048 lds
    buffer_load_dwordx4 v7, s[44:47], s68 offen offset:3072 lds
    s_mov_b32 m0, 12288
    s_nop 0
    buffer_load_dwordx4 v4, s[44:47], s69 offen offset:0 lds
    buffer_load_dwordx4 v5, s[44:47], s69 offen offset:1024 lds
    buffer_load_dwordx4 v6, s[44:47], s69 offen offset:2048 lds
    buffer_load_dwordx4 v7, s[44:47], s69 offen offset:3072 lds
    s_waitcnt vmcnt(16)
    s_barrier
    s_add_u32 s68, s60, 3
    s_and_b32 s68, s68, 3
    s_or_b32 s68, s68, s62
    s_xor_b32 s68, s68, 4
    s_mul_i32 s68, s68, 196608
    s_add_u32 s68, s68, s65
    s_mov_b32 m0, 16384
    s_add_u32 s69, s68, 98304
    buffer_load_dwordx4 v4, s[44:47], s68 offen offset:0 lds
    buffer_load_dwordx4 v5, s[44:47], s68 offen offset:1024 lds
    buffer_load_dwordx4 v6, s[44:47], s68 offen offset:2048 lds
    buffer_load_dwordx4 v7, s[44:47], s68 offen offset:3072 lds
    s_mov_b32 m0, 20480
    s_nop 0
    buffer_load_dwordx4 v4, s[44:47], s69 offen offset:0 lds
    buffer_load_dwordx4 v5, s[44:47], s69 offen offset:1024 lds
    buffer_load_dwordx4 v6, s[44:47], s69 offen offset:2048 lds
    buffer_load_dwordx4 v7, s[44:47], s69 offen offset:3072 lds
    s_add_u32 s68, s68, 1024
    s_mov_b32 m0, 24576
    s_add_u32 s69, s68, 98304
    buffer_load_dwordx4 v4, s[44:47], s68 offen offset:0 lds
    buffer_load_dwordx4 v5, s[44:47], s68 offen offset:1024 lds
    buffer_load_dwordx4 v6, s[44:47], s68 offen offset:2048 lds
    buffer_load_dwordx4 v7, s[44:47], s68 offen offset:3072 lds
    s_mov_b32 m0, 28672
    s_nop 0
    buffer_load_dwordx4 v4, s[44:47], s69 offen offset:0 lds
    buffer_load_dwordx4 v5, s[44:47], s69 offen offset:1024 lds
    buffer_load_dwordx4 v6, s[44:47], s69 offen offset:2048 lds
    buffer_load_dwordx4 v7, s[44:47], s69 offen offset:3072 lds
    s_waitcnt vmcnt(16)
    s_barrier
    v_mul_u32_u24 v24, 3584, v1
    s_add_u32 s72, s30, 0
    s_mul_i32 s72, s72, 229376
    s_lshr_b32 s70, s4, 1
    s_mul_i32 s70, s70, 7
    s_add_u32 s70, s70, s9
    s_lshl_b32 s70, s70, 7
    s_add_u32 s72, s72, s70
    s_cmp_eq_u32 s9, 3
    s_cselect_b32 s73, 0, 512
    buffer_load_dword v21, v24, s[48:51], s72 offen
    s_add_u32 s70, s72, s73
    buffer_load_dword v21, v24, s[48:51], s70 offen
    s_add_u32 s72, s72, 229376
    buffer_load_dword v21, v24, s[48:51], s72 offen
    s_add_u32 s70, s72, s73
    buffer_load_dword v21, v24, s[48:51], s70 offen
    s_add_u32 s72, s72, 229376
    s_waitcnt vmcnt(4)
    s_barrier
    buffer_load_dword v21, v24, s[48:51], s72 offen
    s_add_u32 s70, s72, s73
    buffer_load_dword v21, v24, s[48:51], s70 offen
    s_add_u32 s72, s72, 229376
    s_waitcnt vmcnt(5)
    buffer_load_dword v21, v24, s[48:51], s72 offen
    s_add_u32 s70, s72, s73
    s_waitcnt vmcnt(5)
    buffer_load_dword v21, v24, s[48:51], s70 offen
    s_add_u32 s72, s72, 229376
    s_waitcnt vmcnt(5)
    buffer_load_dword v21, v24, s[48:51], s72 offen
    s_add_u32 s70, s72, s73
    s_waitcnt vmcnt(5)
    buffer_load_dword v21, v24, s[48:51], s70 offen
    s_add_u32 s72, s72, 229376
    s_barrier
    s_waitcnt vmcnt(5)
    buffer_load_dword v21, v24, s[48:51], s72 offen
    s_add_u32 s70, s72, s73
    s_waitcnt vmcnt(5)
    buffer_load_dword v21, v24, s[48:51], s70 offen
    s_add_u32 s72, s72, 229376
    s_waitcnt vmcnt(5)
    buffer_load_dword v21, v24, s[48:51], s72 offen
    s_add_u32 s70, s72, s73
    s_waitcnt vmcnt(5)
    buffer_load_dword v21, v24, s[48:51], s70 offen
    s_add_u32 s72, s72, 229376
    s_waitcnt vmcnt(5)
    buffer_load_dword v21, v24, s[48:51], s72 offen
    s_add_u32 s70, s72, s73
    s_waitcnt vmcnt(5)
    buffer_load_dword v21, v24, s[48:51], s70 offen
    s_add_u32 s72, s72, 229376
    v_lshlrev_b32 v20, 12, v1
    s_lshr_b32 s70, s4, 1
    s_lshl_b32 s70, s70, 10
    s_add_u32 s68, s34, s9
    s_lshl_b32 s68, s68, 18
    s_add_u32 s70, s70, s68
    s_sub_u32 s71, s35, s34
    s_lshl_b32 s71, s71, 18
    s_add_u32 s71, s71, s70
    s_waitcnt vmcnt(5)
    s_add_u32 s68, s70, 0x0
    buffer_load_dword v21, v20, s[56:59], s68 offen offset:384
    s_waitcnt vmcnt(5)
    s_add_u32 s68, s70, 0x100000
    buffer_load_dword v21, v20, s[56:59], s68 offen offset:384
    s_waitcnt vmcnt(5)
    s_add_u32 s68, s70, 0x200000
    buffer_load_dword v21, v20, s[56:59], s68 offen offset:384
    s_waitcnt vmcnt(5)
    s_add_u32 s68, s70, 0x300000
    buffer_load_dword v21, v20, s[56:59], s68 offen offset:384
    s_waitcnt vmcnt(5)
    s_add_u32 s68, s70, 0x0
    buffer_load_dword v21, v20, s[56:59], s68 offen offset:0
    s_waitcnt vmcnt(5)
    s_add_u32 s68, s70, 0x0
    buffer_load_dword v21, v20, s[56:59], s68 offen offset:128
    s_waitcnt vmcnt(5)
    s_add_u32 s68, s70, 0x0
    buffer_load_dword v21, v20, s[56:59], s68 offen offset:256
    s_waitcnt vmcnt(5)
    s_add_u32 s68, s70, 0x0
    buffer_load_dword v21, v20, s[56:59], s68 offen offset:512
    s_waitcnt vmcnt(5)
    s_add_u32 s68, s70, 0x0
    buffer_load_dword v21, v20, s[56:59], s68 offen offset:640
    s_waitcnt vmcnt(5)
    s_add_u32 s68, s70, 0x0
    buffer_load_dword v21, v20, s[56:59], s68 offen offset:768
    s_waitcnt vmcnt(5)
    s_add_u32 s68, s70, 0x0
    buffer_load_dword v21, v20, s[56:59], s68 offen offset:896
    s_waitcnt vmcnt(5)
    s_add_u32 s68, s70, 0x100000
    buffer_load_dword v21, v20, s[56:59], s68 offen offset:0
    s_waitcnt vmcnt(5)
    s_add_u32 s68, s70, 0x100000
    buffer_load_dword v21, v20, s[56:59], s68 offen offset:128
    s_waitcnt vmcnt(5)
    s_add_u32 s68, s70, 0x100000
    buffer_load_dword v21, v20, s[56:59], s68 offen offset:256
    s_waitcnt vmcnt(5)
    s_add_u32 s68, s71, 0x0
    buffer_load_dword v21, v20, s[56:59], s68 offen offset:384
    s_waitcnt vmcnt(5)
    s_add_u32 s68, s71, 0x100000
    buffer_load_dword v21, v20, s[56:59], s68 offen offset:384
    s_waitcnt vmcnt(5)
    s_add_u32 s68, s71, 0x200000
    buffer_load_dword v21, v20, s[56:59], s68 offen offset:384
    s_waitcnt vmcnt(5)
    s_add_u32 s68, s71, 0x300000
    buffer_load_dword v21, v20, s[56:59], s68 offen offset:384
    s_add_u32 s68, s61, 0
    s_and_b32 s68, s68, 7
    s_mul_i32 s68, s68, 65536
    s_add_u32 s68, s68, s65
    s_mov_b32 m0, 16384
    s_add_u32 s69, s68, 32768
    buffer_load_dwordx4 v12, s[52:55], s68 offen offset:0 lds
    buffer_load_dwordx4 v13, s[52:55], s68 offen offset:1024 lds
    buffer_load_dwordx4 v14, s[52:55], s68 offen offset:2048 lds
    buffer_load_dwordx4 v15, s[52:55], s68 offen offset:3072 lds
    s_mov_b32 m0, 20480
    s_nop 0
    buffer_load_dwordx4 v12, s[52:55], s69 offen offset:0 lds
    buffer_load_dwordx4 v13, s[52:55], s69 offen offset:1024 lds
    buffer_load_dwordx4 v14, s[52:55], s69 offen offset:2048 lds
    buffer_load_dwordx4 v15, s[52:55], s69 offen offset:3072 lds
    s_add_u32 s68, s61, 1
    s_and_b32 s68, s68, 7
    s_mul_i32 s68, s68, 65536
    s_add_u32 s68, s68, s65
    s_mov_b32 m0, 24576
    s_add_u32 s69, s68, 32768
    buffer_load_dwordx4 v12, s[52:55], s68 offen offset:0 lds
    buffer_load_dwordx4 v13, s[52:55], s68 offen offset:1024 lds
    buffer_load_dwordx4 v14, s[52:55], s68 offen offset:2048 lds
    buffer_load_dwordx4 v15, s[52:55], s68 offen offset:3072 lds
    s_mov_b32 m0, 28672
    s_nop 0
    buffer_load_dwordx4 v12, s[52:55], s69 offen offset:0 lds
    buffer_load_dwordx4 v13, s[52:55], s69 offen offset:1024 lds
    buffer_load_dwordx4 v14, s[52:55], s69 offen offset:2048 lds
    buffer_load_dwordx4 v15, s[52:55], s69 offen offset:3072 lds
    s_add_u32 s68, s61, 2
    s_and_b32 s68, s68, 7
    s_mul_i32 s68, s68, 65536
    s_add_u32 s68, s68, s65
    s_mov_b32 m0, 0
    s_add_u32 s69, s68, 32768
    buffer_load_dwordx4 v12, s[52:55], s68 offen offset:0 lds
    buffer_load_dwordx4 v13, s[52:55], s68 offen offset:1024 lds
    buffer_load_dwordx4 v14, s[52:55], s68 offen offset:2048 lds
    buffer_load_dwordx4 v15, s[52:55], s68 offen offset:3072 lds
    s_mov_b32 m0, 4096
    s_nop 0
    buffer_load_dwordx4 v12, s[52:55], s69 offen offset:0 lds
    buffer_load_dwordx4 v13, s[52:55], s69 offen offset:1024 lds
    buffer_load_dwordx4 v14, s[52:55], s69 offen offset:2048 lds
    buffer_load_dwordx4 v15, s[52:55], s69 offen offset:3072 lds
    s_add_u32 s68, s61, 3
    s_and_b32 s68, s68, 7
    s_mul_i32 s68, s68, 65536
    s_add_u32 s68, s68, s65
    s_mov_b32 m0, 32768
    s_add_u32 s69, s68, 32768
    buffer_load_dwordx4 v12, s[52:55], s68 offen offset:0 lds
    buffer_load_dwordx4 v13, s[52:55], s68 offen offset:1024 lds
    buffer_load_dwordx4 v14, s[52:55], s68 offen offset:2048 lds
    buffer_load_dwordx4 v15, s[52:55], s68 offen offset:3072 lds
    s_mov_b32 m0, 36864
    s_nop 0
    buffer_load_dwordx4 v12, s[52:55], s69 offen offset:0 lds
    buffer_load_dwordx4 v13, s[52:55], s69 offen offset:1024 lds
    buffer_load_dwordx4 v14, s[52:55], s69 offen offset:2048 lds
    buffer_load_dwordx4 v15, s[52:55], s69 offen offset:3072 lds
tl_q:
    s_barrier
    s_add_u32 s68, s61, 4
    s_and_b32 s68, s68, 7
    s_mul_i32 s68, s68, 65536
    s_add_u32 s68, s68, s65
    s_mov_b32 m0, 8192
    s_add_u32 s69, s68, 32768
    buffer_load_dwordx4 v12, s[52:55], s68 offen offset:0 lds
    buffer_load_dwordx4 v13, s[52:55], s68 offen offset:1024 lds
    buffer_load_dwordx4 v14, s[52:55], s68 offen offset:2048 lds
    buffer_load_dwordx4 v15, s[52:55], s68 offen offset:3072 lds
    s_mov_b32 m0, 12288
    s_nop 0
    buffer_load_dwordx4 v12, s[52:55], s69 offen offset:0 lds
    buffer_load_dwordx4 v13, s[52:55], s69 offen offset:1024 lds
    buffer_load_dwordx4 v14, s[52:55], s69 offen offset:2048 lds
    buffer_load_dwordx4 v15, s[52:55], s69 offen offset:3072 lds
    s_add_u32 s68, s61, 5
    s_and_b32 s68, s68, 7
    s_mul_i32 s68, s68, 65536
    s_add_u32 s68, s68, s65
    s_mov_b32 m0, 40960
    s_add_u32 s69, s68, 32768
    buffer_load_dwordx4 v12, s[52:55], s68 offen offset:0 lds
    buffer_load_dwordx4 v13, s[52:55], s68 offen offset:1024 lds
    buffer_load_dwordx4 v14, s[52:55], s68 offen offset:2048 lds
    buffer_load_dwordx4 v15, s[52:55], s68 offen offset:3072 lds
    s_mov_b32 m0, 45056
    s_nop 0
    buffer_load_dwordx4 v12, s[52:55], s69 offen offset:0 lds
    buffer_load_dwordx4 v13, s[52:55], s69 offen offset:1024 lds
    buffer_load_dwordx4 v14, s[52:55], s69 offen offset:2048 lds
    buffer_load_dwordx4 v15, s[52:55], s69 offen offset:3072 lds
    s_add_u32 s68, s61, 6
    s_and_b32 s68, s68, 7
    s_mul_i32 s68, s68, 65536
    s_add_u32 s68, s68, s65
    s_mov_b32 m0, 49152
    s_add_u32 s69, s68, 32768
    buffer_load_dwordx4 v12, s[52:55], s68 offen offset:0 lds
    buffer_load_dwordx4 v13, s[52:55], s68 offen offset:1024 lds
    buffer_load_dwordx4 v14, s[52:55], s68 offen offset:2048 lds
    buffer_load_dwordx4 v15, s[52:55], s68 offen offset:3072 lds
    s_mov_b32 m0, 53248
    s_nop 0
    buffer_load_dwordx4 v12, s[52:55], s69 offen offset:0 lds
    buffer_load_dwordx4 v13, s[52:55], s69 offen offset:1024 lds
    buffer_load_dwordx4 v14, s[52:55], s69 offen offset:2048 lds
    buffer_load_dwordx4 v15, s[52:55], s69 offen offset:3072 lds
    s_waitcnt vmcnt(48)
    s_barrier
    s_add_u32 s68, s61, 7
    s_and_b32 s68, s68, 7
    s_mul_i32 s68, s68, 65536
    s_add_u32 s68, s68, s65
    s_mov_b32 m0, 57344
    s_add_u32 s69, s68, 32768
    buffer_load_dwordx4 v12, s[52:55], s68 offen offset:0 lds
    buffer_load_dwordx4 v13, s[52:55], s68 offen offset:1024 lds
    buffer_load_dwordx4 v14, s[52:55], s68 offen offset:2048 lds
    buffer_load_dwordx4 v15, s[52:55], s68 offen offset:3072 lds
    s_mov_b32 m0, 61440
    s_nop 0
    buffer_load_dwordx4 v12, s[52:55], s69 offen offset:0 lds
    buffer_load_dwordx4 v13, s[52:55], s69 offen offset:1024 lds
    buffer_load_dwordx4 v14, s[52:55], s69 offen offset:2048 lds
    buffer_load_dwordx4 v15, s[52:55], s69 offen offset:3072 lds
    s_add_u32 s68, s32, 0
    s_add_u32 s68, s68, s34
    s_mul_i32 s68, s68, 262144
    s_add_u32 s68, s68, s67
    s_mov_b32 m0, 65536
    s_add_u32 s69, s68, 131072
    buffer_load_dwordx4 v16, s[56:59], s68 offen offset:0 lds
    buffer_load_dwordx4 v17, s[56:59], s68 offen offset:1024 lds
    buffer_load_dwordx4 v18, s[56:59], s68 offen offset:2048 lds
    buffer_load_dwordx4 v19, s[56:59], s68 offen offset:3072 lds
    s_mov_b32 m0, 69632
    s_nop 0
    buffer_load_dwordx4 v16, s[56:59], s69 offen offset:0 lds
    buffer_load_dwordx4 v17, s[56:59], s69 offen offset:1024 lds
    buffer_load_dwordx4 v18, s[56:59], s69 offen offset:2048 lds
    buffer_load_dwordx4 v19, s[56:59], s69 offen offset:3072 lds
    s_waitcnt vmcnt(56)
    s_barrier
    s_cmp_ge_u32 s32, 13
    s_cselect_b32 s68, -13, 1
    s_add_u32 s68, s68, s32
    s_add_u32 s68, s68, s34
    s_mul_i32 s68, s68, 262144
    s_add_u32 s68, s68, s67
    s_mov_b32 m0, 16384
    s_add_u32 s69, s68, 131072
    buffer_load_dwordx4 v16, s[56:59], s68 offen offset:0 lds
    buffer_load_dwordx4 v17, s[56:59], s68 offen offset:1024 lds
    buffer_load_dwordx4 v18, s[56:59], s68 offen offset:2048 lds
    buffer_load_dwordx4 v19, s[56:59], s68 offen offset:3072 lds
    s_mov_b32 m0, 20480
    s_nop 0
    buffer_load_dwordx4 v16, s[56:59], s69 offen offset:0 lds
    buffer_load_dwordx4 v17, s[56:59], s69 offen offset:1024 lds
    buffer_load_dwordx4 v18, s[56:59], s69 offen offset:2048 lds
    buffer_load_dwordx4 v19, s[56:59], s69 offen offset:3072 lds
    s_cmp_ge_u32 s32, 12
    s_cselect_b32 s68, -12, 2
    s_add_u32 s68, s68, s32
    s_add_u32 s68, s68, s34
    s_mul_i32 s68, s68, 262144
    s_add_u32 s68, s68, s67
    s_mov_b32 m0, 73728
    s_add_u32 s69, s68, 131072
    buffer_load_dwordx4 v16, s[56:59], s68 offen offset:0 lds
    buffer_load_dwordx4 v17, s[56:59], s68 offen offset:1024 lds
    buffer_load_dwordx4 v18, s[56:59], s68 offen offset:2048 lds
    buffer_load_dwordx4 v19, s[56:59], s68 offen offset:3072 lds
    s_mov_b32 m0, 77824
    s_nop 0
    buffer_load_dwordx4 v16, s[56:59], s69 offen offset:0 lds
    buffer_load_dwordx4 v17, s[56:59], s69 offen offset:1024 lds
    buffer_load_dwordx4 v18, s[56:59], s69 offen offset:2048 lds
    buffer_load_dwordx4 v19, s[56:59], s69 offen offset:3072 lds
    s_waitcnt vmcnt(63)
    s_barrier
    s_cmp_ge_u32 s32, 11
    s_cselect_b32 s68, -11, 3
    s_add_u32 s68, s68, s32
    s_add_u32 s68, s68, s34
    s_mul_i32 s68, s68, 262144
    s_add_u32 s68, s68, s67
    s_mov_b32 m0, 24576
    s_add_u32 s69, s68, 131072
    buffer_load_dwordx4 v16, s[56:59], s68 offen offset:0 lds
    buffer_load_dwordx4 v17, s[56:59], s68 offen offset:1024 lds
    buffer_load_dwordx4 v18, s[56:59], s68 offen offset:2048 lds
    buffer_load_dwordx4 v19, s[56:59], s68 offen offset:3072 lds
    s_mov_b32 m0, 28672
    s_nop 0
    buffer_load_dwordx4 v16, s[56:59], s69 offen offset:0 lds
    buffer_load_dwordx4 v17, s[56:59], s69 offen offset:1024 lds
    buffer_load_dwordx4 v18, s[56:59], s69 offen offset:2048 lds
    buffer_load_dwordx4 v19, s[56:59], s69 offen offset:3072 lds
    s_cmp_ge_u32 s32, 10
    s_cselect_b32 s68, -10, 4
    s_add_u32 s68, s68, s32
    s_add_u32 s68, s68, s34
    s_mul_i32 s68, s68, 262144
    s_add_u32 s68, s68, s67
    s_mov_b32 m0, 81920
    s_add_u32 s69, s68, 131072
    buffer_load_dwordx4 v16, s[56:59], s68 offen offset:0 lds
    buffer_load_dwordx4 v17, s[56:59], s68 offen offset:1024 lds
    buffer_load_dwordx4 v18, s[56:59], s68 offen offset:2048 lds
    buffer_load_dwordx4 v19, s[56:59], s68 offen offset:3072 lds
    s_mov_b32 m0, 86016
    s_nop 0
    buffer_load_dwordx4 v16, s[56:59], s69 offen offset:0 lds
    buffer_load_dwordx4 v17, s[56:59], s69 offen offset:1024 lds
    buffer_load_dwordx4 v18, s[56:59], s69 offen offset:2048 lds
    buffer_load_dwordx4 v19, s[56:59], s69 offen offset:3072 lds
    s_waitcnt vmcnt(63)
    s_barrier
    s_cmp_ge_u32 s32, 9
    s_cselect_b32 s68, -9, 5
    s_add_u32 s68, s68, s32
    s_add_u32 s68, s68, s34
    s_mul_i32 s68, s68, 262144
    s_add_u32 s68, s68, s67
    s_mov_b32 m0, 0
    s_add_u32 s69, s68, 131072
    buffer_load_dwordx4 v16, s[56:59], s68 offen offset:0 lds
    buffer_load_dwordx4 v17, s[56:59], s68 offen offset:1024 lds
    buffer_load_dwordx4 v18, s[56:59], s68 offen offset:2048 lds
    buffer_load_dwordx4 v19, s[56:59], s68 offen offset:3072 lds
    s_mov_b32 m0, 4096
    s_nop 0
    buffer_load_dwordx4 v16, s[56:59], s69 offen offset:0 lds
    buffer_load_dwordx4 v17, s[56:59], s69 offen offset:1024 lds
    buffer_load_dwordx4 v18, s[56:59], s69 offen offset:2048 lds
    buffer_load_dwordx4 v19, s[56:59], s69 offen offset:3072 lds
    s_cmp_ge_u32 s32, 8
    s_cselect_b32 s68, -8, 6
    s_add_u32 s68, s68, s32
    s_add_u32 s68, s68, s34
    s_mul_i32 s68, s68, 262144
    s_add_u32 s68, s68, s67
    s_mov_b32 m0, 90112
    s_add_u32 s69, s68, 131072
    buffer_load_dwordx4 v16, s[56:59], s68 offen offset:0 lds
    buffer_load_dwordx4 v17, s[56:59], s68 offen offset:1024 lds
    buffer_load_dwordx4 v18, s[56:59], s68 offen offset:2048 lds
    buffer_load_dwordx4 v19, s[56:59], s68 offen offset:3072 lds
    s_mov_b32 m0, 94208
    s_nop 0
    buffer_load_dwordx4 v16, s[56:59], s69 offen offset:0 lds
    buffer_load_dwordx4 v17, s[56:59], s69 offen offset:1024 lds
    buffer_load_dwordx4 v18, s[56:59], s69 offen offset:2048 lds
    buffer_load_dwordx4 v19, s[56:59], s69 offen offset:3072 lds
    s_barrier
    s_cmp_ge_u32 s32, 7
    s_cselect_b32 s68, -7, 7
    s_add_u32 s68, s68, s32
    s_add_u32 s68, s68, s34
    s_mul_i32 s68, s68, 262144
    s_add_u32 s68, s68, s67
    s_mov_b32 m0, 32768
    s_add_u32 s69, s68, 131072
    buffer_load_dwordx4 v16, s[56:59], s68 offen offset:0 lds
    buffer_load_dwordx4 v17, s[56:59], s68 offen offset:1024 lds
    buffer_load_dwordx4 v18, s[56:59], s68 offen offset:2048 lds
    buffer_load_dwordx4 v19, s[56:59], s68 offen offset:3072 lds
    s_mov_b32 m0, 36864
    s_nop 0
    buffer_load_dwordx4 v16, s[56:59], s69 offen offset:0 lds
    buffer_load_dwordx4 v17, s[56:59], s69 offen offset:1024 lds
    buffer_load_dwordx4 v18, s[56:59], s69 offen offset:2048 lds
    buffer_load_dwordx4 v19, s[56:59], s69 offen offset:3072 lds
    s_cmp_ge_u32 s32, 6
    s_cselect_b32 s68, -6, 8
    s_add_u32 s68, s68, s32
    s_add_u32 s68, s68, s34
    s_mul_i32 s68, s68, 262144
    s_add_u32 s68, s68, s67
    s_mov_b32 m0, 98304
    s_add_u32 s69, s68, 131072
    buffer_load_dwordx4 v16, s[56:59], s68 offen offset:0 lds
    buffer_load_dwordx4 v17, s[56:59], s68 offen offset:1024 lds
    buffer_load_dwordx4 v18, s[56:59], s68 offen offset:2048 lds
    buffer_load_dwordx4 v19, s[56:59], s68 offen offset:3072 lds
    s_mov_b32 m0, 102400
    s_nop 0
    buffer_load_dwordx4 v16, s[56:59], s69 offen offset:0 lds
    buffer_load_dwordx4 v17, s[56:59], s69 offen offset:1024 lds
    buffer_load_dwordx4 v18, s[56:59], s69 offen offset:2048 lds
    buffer_load_dwordx4 v19, s[56:59], s69 offen offset:3072 lds
    s_waitcnt vmcnt(63)
    s_barrier
    s_cmp_ge_u32 s32, 5
    s_cselect_b32 s68, -5, 9
    s_add_u32 s68, s68, s32
    s_add_u32 s68, s68, s34
    s_mul_i32 s68, s68, 262144
    s_add_u32 s68, s68, s67
    s_mov_b32 m0, 8192
    s_add_u32 s69, s68, 131072
    buffer_load_dwordx4 v16, s[56:59], s68 offen offset:0 lds
    buffer_load_dwordx4 v17, s[56:59], s68 offen offset:1024 lds
    buffer_load_dwordx4 v18, s[56:59], s68 offen offset:2048 lds
    buffer_load_dwordx4 v19, s[56:59], s68 offen offset:3072 lds
    s_mov_b32 m0, 12288
    s_nop 0
    buffer_load_dwordx4 v16, s[56:59], s69 offen offset:0 lds
    buffer_load_dwordx4 v17, s[56:59], s69 offen offset:1024 lds
    buffer_load_dwordx4 v18, s[56:59], s69 offen offset:2048 lds
    buffer_load_dwordx4 v19, s[56:59], s69 offen offset:3072 lds
    s_barrier
    s_cmp_ge_u32 s32, 4
    s_cselect_b32 s68, -4, 10
    s_add_u32 s68, s68, s32
    s_add_u32 s68, s68, s34
    s_mul_i32 s68, s68, 262144
    s_add_u32 s68, s68, s67
    s_mov_b32 m0, 40960
    s_add_u32 s69, s68, 131072
    buffer_load_dwordx4 v16, s[56:59], s68 offen offset:0 lds
    buffer_load_dwordx4 v17, s[56:59], s68 offen offset:1024 lds
    buffer_load_dwordx4 v18, s[56:59], s68 offen offset:2048 lds
    buffer_load_dwordx4 v19, s[56:59], s68 offen offset:3072 lds
    s_mov_b32 m0, 45056
    s_nop 0
    buffer_load_dwordx4 v16, s[56:59], s69 offen offset:0 lds
    buffer_load_dwordx4 v17, s[56:59], s69 offen offset:1024 lds
    buffer_load_dwordx4 v18, s[56:59], s69 offen offset:2048 lds
    buffer_load_dwordx4 v19, s[56:59], s69 offen offset:3072 lds
    s_barrier
    s_cmp_ge_u32 s32, 3
    s_cselect_b32 s68, -3, 11
    s_add_u32 s68, s68, s32
    s_add_u32 s68, s68, s34
    s_mul_i32 s68, s68, 262144
    s_add_u32 s68, s68, s67
    s_mov_b32 m0, 49152
    s_add_u32 s69, s68, 131072
    buffer_load_dwordx4 v16, s[56:59], s68 offen offset:0 lds
    buffer_load_dwordx4 v17, s[56:59], s68 offen offset:1024 lds
    buffer_load_dwordx4 v18, s[56:59], s68 offen offset:2048 lds
    buffer_load_dwordx4 v19, s[56:59], s68 offen offset:3072 lds
    s_mov_b32 m0, 53248
    s_nop 0
    buffer_load_dwordx4 v16, s[56:59], s69 offen offset:0 lds
    buffer_load_dwordx4 v17, s[56:59], s69 offen offset:1024 lds
    buffer_load_dwordx4 v18, s[56:59], s69 offen offset:2048 lds
    buffer_load_dwordx4 v19, s[56:59], s69 offen offset:3072 lds
    s_barrier
    s_cmp_ge_u32 s32, 2
    s_cselect_b32 s68, -2, 12
    s_add_u32 s68, s68, s32
    s_add_u32 s68, s68, s34
    s_mul_i32 s68, s68, 262144
    s_add_u32 s68, s68, s67
    s_mov_b32 m0, 57344
    s_add_u32 s69, s68, 131072
    buffer_load_dwordx4 v16, s[56:59], s68 offen offset:0 lds
    buffer_load_dwordx4 v17, s[56:59], s68 offen offset:1024 lds
    buffer_load_dwordx4 v18, s[56:59], s68 offen offset:2048 lds
    buffer_load_dwordx4 v19, s[56:59], s68 offen offset:3072 lds
    s_mov_b32 m0, 61440
    s_nop 0
    buffer_load_dwordx4 v16, s[56:59], s69 offen offset:0 lds
    buffer_load_dwordx4 v17, s[56:59], s69 offen offset:1024 lds
    buffer_load_dwordx4 v18, s[56:59], s69 offen offset:2048 lds
    buffer_load_dwordx4 v19, s[56:59], s69 offen offset:3072 lds
    s_waitcnt vmcnt(63)
    s_barrier
    s_cmp_ge_u32 s32, 1
    s_cselect_b32 s68, -1, 13
    s_add_u32 s68, s68, s32
    s_add_u32 s68, s68, s34
    s_mul_i32 s68, s68, 262144
    s_add_u32 s68, s68, s67
    s_mov_b32 m0, 65536
    s_add_u32 s69, s68, 131072
    buffer_load_dwordx4 v16, s[56:59], s68 offen offset:0 lds
    buffer_load_dwordx4 v17, s[56:59], s68 offen offset:1024 lds
    buffer_load_dwordx4 v18, s[56:59], s68 offen offset:2048 lds
    buffer_load_dwordx4 v19, s[56:59], s68 offen offset:3072 lds
    s_mov_b32 m0, 69632
    s_nop 0
    buffer_load_dwordx4 v16, s[56:59], s69 offen offset:0 lds
    buffer_load_dwordx4 v17, s[56:59], s69 offen offset:1024 lds
    buffer_load_dwordx4 v18, s[56:59], s69 offen offset:2048 lds
    buffer_load_dwordx4 v19, s[56:59], s69 offen offset:3072 lds
    s_barrier
    s_barrier
    s_add_u32 s68, s33, 0
    s_add_u32 s68, s68, s35
    s_mul_i32 s68, s68, 262144
    s_add_u32 s68, s68, s67
    s_mov_b32 m0, 16384
    s_add_u32 s69, s68, 131072
    buffer_load_dwordx4 v16, s[56:59], s68 offen offset:0 lds
    buffer_load_dwordx4 v17, s[56:59], s68 offen offset:1024 lds
    buffer_load_dwordx4 v18, s[56:59], s68 offen offset:2048 lds
    buffer_load_dwordx4 v19, s[56:59], s68 offen offset:3072 lds
    s_mov_b32 m0, 20480
    s_nop 0
    buffer_load_dwordx4 v16, s[56:59], s69 offen offset:0 lds
    buffer_load_dwordx4 v17, s[56:59], s69 offen offset:1024 lds
    buffer_load_dwordx4 v18, s[56:59], s69 offen offset:2048 lds
    buffer_load_dwordx4 v19, s[56:59], s69 offen offset:3072 lds
    s_barrier
    s_cmp_ge_u32 s33, 13
    s_cselect_b32 s68, -13, 1
    s_add_u32 s68, s68, s33
    s_add_u32 s68, s68, s35
    s_mul_i32 s68, s68, 262144
    s_add_u32 s68, s68, s67
    s_mov_b32 m0, 24576
    s_add_u32 s69, s68, 131072
    buffer_load_dwordx4 v16, s[56:59], s68 offen offset:0 lds
    buffer_load_dwordx4 v17, s[56:59], s68 offen offset:1024 lds
    buffer_load_dwordx4 v18, s[56:59], s68 offen offset:2048 lds
    buffer_load_dwordx4 v19, s[56:59], s68 offen offset:3072 lds
    s_mov_b32 m0, 28672
    s_nop 0
    buffer_load_dwordx4 v16, s[56:59], s69 offen offset:0 lds
    buffer_load_dwordx4 v17, s[56:59], s69 offen offset:1024 lds
    buffer_load_dwordx4 v18, s[56:59], s69 offen offset:2048 lds
    buffer_load_dwordx4 v19, s[56:59], s69 offen offset:3072 lds
    s_waitcnt vmcnt(63)
    s_barrier
    s_barrier
    s_cmp_ge_u32 s33, 12
    s_cselect_b32 s68, -12, 2
    s_add_u32 s68, s68, s33
    s_add_u32 s68, s68, s35
    s_mul_i32 s68, s68, 262144
    s_add_u32 s68, s68, s67
    s_mov_b32 m0, 0
    s_add_u32 s69, s68, 131072
    buffer_load_dwordx4 v16, s[56:59], s68 offen offset:0 lds
    buffer_load_dwordx4 v17, s[56:59], s68 offen offset:1024 lds
    buffer_load_dwordx4 v18, s[56:59], s68 offen offset:2048 lds
    buffer_load_dwordx4 v19, s[56:59], s68 offen offset:3072 lds
    s_mov_b32 m0, 4096
    s_nop 0
    buffer_load_dwordx4 v16, s[56:59], s69 offen offset:0 lds
    buffer_load_dwordx4 v17, s[56:59], s69 offen offset:1024 lds
    buffer_load_dwordx4 v18, s[56:59], s69 offen offset:2048 lds
    buffer_load_dwordx4 v19, s[56:59], s69 offen offset:3072 lds
    s_barrier
    s_cmp_ge_u32 s33, 11
    s_cselect_b32 s68, -11, 3
    s_add_u32 s68, s68, s33
    s_add_u32 s68, s68, s35
    s_mul_i32 s68, s68, 262144
    s_add_u32 s68, s68, s67
    s_mov_b32 m0, 73728
    s_add_u32 s69, s68, 131072
    buffer_load_dwordx4 v16, s[56:59], s68 offen offset:0 lds
    buffer_load_dwordx4 v17, s[56:59], s68 offen offset:1024 lds
    buffer_load_dwordx4 v18, s[56:59], s68 offen offset:2048 lds
    buffer_load_dwordx4 v19, s[56:59], s68 offen offset:3072 lds
    s_mov_b32 m0, 77824
    s_nop 0
    buffer_load_dwordx4 v16, s[56:59], s69 offen offset:0 lds
    buffer_load_dwordx4 v17, s[56:59], s69 offen offset:1024 lds
    buffer_load_dwordx4 v18, s[56:59], s69 offen offset:2048 lds
    buffer_load_dwordx4 v19, s[56:59], s69 offen offset:3072 lds
    s_waitcnt vmcnt(63)
    s_barrier
    s_barrier
    s_cmp_ge_u32 s33, 10
    s_cselect_b32 s68, -10, 4
    s_add_u32 s68, s68, s33
    s_add_u32 s68, s68, s35
    s_mul_i32 s68, s68, 262144
    s_add_u32 s68, s68, s67
    s_mov_b32 m0, 32768
    s_add_u32 s69, s68, 131072
    buffer_load_dwordx4 v16, s[56:59], s68 offen offset:0 lds
    buffer_load_dwordx4 v17, s[56:59], s68 offen offset:1024 lds
    buffer_load_dwordx4 v18, s[56:59], s68 offen offset:2048 lds
    buffer_load_dwordx4 v19, s[56:59], s68 offen offset:3072 lds
    s_mov_b32 m0, 36864
    s_nop 0
    buffer_load_dwordx4 v16, s[56:59], s69 offen offset:0 lds
    buffer_load_dwordx4 v17, s[56:59], s69 offen offset:1024 lds
    buffer_load_dwordx4 v18, s[56:59], s69 offen offset:2048 lds
    buffer_load_dwordx4 v19, s[56:59], s69 offen offset:3072 lds
    s_waitcnt vmcnt(63)
    s_barrier
    s_cmp_ge_u32 s33, 9
    s_cselect_b32 s68, -9, 5
    s_add_u32 s68, s68, s33
    s_add_u32 s68, s68, s35
    s_mul_i32 s68, s68, 262144
    s_add_u32 s68, s68, s67
    s_mov_b32 m0, 8192
    s_add_u32 s69, s68, 131072
    buffer_load_dwordx4 v16, s[56:59], s68 offen offset:0 lds
    buffer_load_dwordx4 v17, s[56:59], s68 offen offset:1024 lds
    buffer_load_dwordx4 v18, s[56:59], s68 offen offset:2048 lds
    buffer_load_dwordx4 v19, s[56:59], s68 offen offset:3072 lds
    s_mov_b32 m0, 12288
    s_nop 0
    buffer_load_dwordx4 v16, s[56:59], s69 offen offset:0 lds
    buffer_load_dwordx4 v17, s[56:59], s69 offen offset:1024 lds
    buffer_load_dwordx4 v18, s[56:59], s69 offen offset:2048 lds
    buffer_load_dwordx4 v19, s[56:59], s69 offen offset:3072 lds
    s_waitcnt vmcnt(63)
    s_barrier
    s_waitcnt vmcnt(56)
    s_barrier
    s_cmp_ge_u32 s33, 8
    s_cselect_b32 s68, -8, 6
    s_add_u32 s68, s68, s33
    s_add_u32 s68, s68, s35
    s_mul_i32 s68, s68, 262144
    s_add_u32 s68, s68, s67
    s_mov_b32 m0, 40960
    s_add_u32 s69, s68, 131072
    buffer_load_dwordx4 v16, s[56:59], s68 offen offset:0 lds
    buffer_load_dwordx4 v17, s[56:59], s68 offen offset:1024 lds
    buffer_load_dwordx4 v18, s[56:59], s68 offen offset:2048 lds
    buffer_load_dwordx4 v19, s[56:59], s68 offen offset:3072 lds
    s_mov_b32 m0, 45056
    s_nop 0
    buffer_load_dwordx4 v16, s[56:59], s69 offen offset:0 lds
    buffer_load_dwordx4 v17, s[56:59], s69 offen offset:1024 lds
    buffer_load_dwordx4 v18, s[56:59], s69 offen offset:2048 lds
    buffer_load_dwordx4 v19, s[56:59], s69 offen offset:3072 lds
    s_waitcnt vmcnt(56)
    s_barrier
    s_waitcnt vmcnt(48)
    s_barrier
    s_cmp_ge_u32 s33, 7
    s_cselect_b32 s68, -7, 7
    s_add_u32 s68, s68, s33
    s_add_u32 s68, s68, s35
    s_mul_i32 s68, s68, 262144
    s_add_u32 s68, s68, s67
    s_mov_b32 m0, 49152
    s_add_u32 s69, s68, 131072
    buffer_load_dwordx4 v16, s[56:59], s68 offen offset:0 lds
    buffer_load_dwordx4 v17, s[56:59], s68 offen offset:1024 lds
    buffer_load_dwordx4 v18, s[56:59], s68 offen offset:2048 lds
    buffer_load_dwordx4 v19, s[56:59], s68 offen offset:3072 lds
    s_mov_b32 m0, 53248
    s_nop 0
    buffer_load_dwordx4 v16, s[56:59], s69 offen offset:0 lds
    buffer_load_dwordx4 v17, s[56:59], s69 offen offset:1024 lds
    buffer_load_dwordx4 v18, s[56:59], s69 offen offset:2048 lds
    buffer_load_dwordx4 v19, s[56:59], s69 offen offset:3072 lds
    s_waitcnt vmcnt(48)
    s_barrier
    s_cmp_ge_u32 s33, 6
    s_cselect_b32 s68, -6, 8
    s_add_u32 s68, s68, s33
    s_add_u32 s68, s68, s35
    s_mul_i32 s68, s68, 262144
    s_add_u32 s68, s68, s67
    s_mov_b32 m0, 16384
    s_add_u32 s69, s68, 131072
    buffer_load_dwordx4 v16, s[56:59], s68 offen offset:0 lds
    buffer_load_dwordx4 v17, s[56:59], s68 offen offset:1024 lds
    buffer_load_dwordx4 v18, s[56:59], s68 offen offset:2048 lds
    buffer_load_dwordx4 v19, s[56:59], s68 offen offset:3072 lds
    s_mov_b32 m0, 20480
    s_nop 0
    buffer_load_dwordx4 v16, s[56:59], s69 offen offset:0 lds
    buffer_load_dwordx4 v17, s[56:59], s69 offen offset:1024 lds
    buffer_load_dwordx4 v18, s[56:59], s69 offen offset:2048 lds
    buffer_load_dwordx4 v19, s[56:59], s69 offen offset:3072 lds
    s_waitcnt vmcnt(48)
    s_barrier
    s_waitcnt vmcnt(40)
    s_barrier
    s_cmp_ge_u32 s33, 5
    s_cselect_b32 s68, -5, 9
    s_add_u32 s68, s68, s33
    s_add_u32 s68, s68, s35
    s_mul_i32 s68, s68, 262144
    s_add_u32 s68, s68, s67
    s_mov_b32 m0, 0
    s_add_u32 s69, s68, 131072
    buffer_load_dwordx4 v16, s[56:59], s68 offen offset:0 lds
    buffer_load_dwordx4 v17, s[56:59], s68 offen offset:1024 lds
    buffer_load_dwordx4 v18, s[56:59], s68 offen offset:2048 lds
    buffer_load_dwordx4 v19, s[56:59], s68 offen offset:3072 lds
    s_mov_b32 m0, 4096
    s_nop 0
    buffer_load_dwordx4 v16, s[56:59], s69 offen offset:0 lds
    buffer_load_dwordx4 v17, s[56:59], s69 offen offset:1024 lds
    buffer_load_dwordx4 v18, s[56:59], s69 offen offset:2048 lds
    buffer_load_dwordx4 v19, s[56:59], s69 offen offset:3072 lds
    s_waitcnt vmcnt(40)
    s_barrier
    s_cmp_ge_u32 s33, 4
    s_cselect_b32 s68, -4, 10
    s_add_u32 s68, s68, s33
    s_add_u32 s68, s68, s35
    s_mul_i32 s68, s68, 262144
    s_add_u32 s68, s68, s67
    s_mov_b32 m0, 24576
    s_add_u32 s69, s68, 131072
    buffer_load_dwordx4 v16, s[56:59], s68 offen offset:0 lds
    buffer_load_dwordx4 v17, s[56:59], s68 offen offset:1024 lds
    buffer_load_dwordx4 v18, s[56:59], s68 offen offset:2048 lds
    buffer_load_dwordx4 v19, s[56:59], s68 offen offset:3072 lds
    s_mov_b32 m0, 28672
    s_nop 0
    buffer_load_dwordx4 v16, s[56:59], s69 offen offset:0 lds
    buffer_load_dwordx4 v17, s[56:59], s69 offen offset:1024 lds
    buffer_load_dwordx4 v18, s[56:59], s69 offen offset:2048 lds
    buffer_load_dwordx4 v19, s[56:59], s69 offen offset:3072 lds
    s_waitcnt vmcnt(40)
    s_barrier
    s_waitcnt vmcnt(32)
    s_barrier
    s_cmp_ge_u32 s33, 3
    s_cselect_b32 s68, -3, 11
    s_add_u32 s68, s68, s33
    s_add_u32 s68, s68, s35
    s_mul_i32 s68, s68, 262144
    s_add_u32 s68, s68, s67
    s_mov_b32 m0, 8192
    s_add_u32 s69, s68, 131072
    buffer_load_dwordx4 v16, s[56:59], s68 offen offset:0 lds
    buffer_load_dwordx4 v17, s[56:59], s68 offen offset:1024 lds
    buffer_load_dwordx4 v18, s[56:59], s68 offen offset:2048 lds
    buffer_load_dwordx4 v19, s[56:59], s68 offen offset:3072 lds
    s_mov_b32 m0, 12288
    s_nop 0
    buffer_load_dwordx4 v16, s[56:59], s69 offen offset:0 lds
    buffer_load_dwordx4 v17, s[56:59], s69 offen offset:1024 lds
    buffer_load_dwordx4 v18, s[56:59], s69 offen offset:2048 lds
    buffer_load_dwordx4 v19, s[56:59], s69 offen offset:3072 lds
    s_waitcnt vmcnt(32)
    s_barrier
    s_cmp_ge_u32 s33, 2
    s_cselect_b32 s68, -2, 12
    s_add_u32 s68, s68, s33
    s_add_u32 s68, s68, s35
    s_mul_i32 s68, s68, 262144
    s_add_u32 s68, s68, s67
    s_mov_b32 m0, 32768
    s_add_u32 s69, s68, 131072
    buffer_load_dwordx4 v16, s[56:59], s68 offen offset:0 lds
    buffer_load_dwordx4 v17, s[56:59], s68 offen offset:1024 lds
    buffer_load_dwordx4 v18, s[56:59], s68 offen offset:2048 lds
    buffer_load_dwordx4 v19, s[56:59], s68 offen offset:3072 lds
    s_mov_b32 m0, 36864
    s_nop 0
    buffer_load_dwordx4 v16, s[56:59], s69 offen offset:0 lds
    buffer_load_dwordx4 v17, s[56:59], s69 offen offset:1024 lds
    buffer_load_dwordx4 v18, s[56:59], s69 offen offset:2048 lds
    buffer_load_dwordx4 v19, s[56:59], s69 offen offset:3072 lds
    s_waitcnt vmcnt(32)
    s_barrier
    s_waitcnt vmcnt(24)
    s_barrier
    s_cmp_ge_u32 s33, 1
    s_cselect_b32 s68, -1, 13
    s_add_u32 s68, s68, s33
    s_add_u32 s68, s68, s35
    s_mul_i32 s68, s68, 262144
    s_add_u32 s68, s68, s67
    s_mov_b32 m0, 16384
    s_add_u32 s69, s68, 131072
    buffer_load_dwordx4 v16, s[56:59], s68 offen offset:0 lds
    buffer_load_dwordx4 v17, s[56:59], s68 offen offset:1024 lds
    buffer_load_dwordx4 v18, s[56:59], s68 offen offset:2048 lds
    buffer_load_dwordx4 v19, s[56:59], s68 offen offset:3072 lds
    s_mov_b32 m0, 20480
    s_nop 0
    buffer_load_dwordx4 v16, s[56:59], s69 offen offset:0 lds
    buffer_load_dwordx4 v17, s[56:59], s69 offen offset:1024 lds
    buffer_load_dwordx4 v18, s[56:59], s69 offen offset:2048 lds
    buffer_load_dwordx4 v19, s[56:59], s69 offen offset:3072 lds
    s_waitcnt vmcnt(24)
    s_barrier
    s_waitcnt vmcnt(16)
    s_barrier
    s_waitcnt vmcnt(8)
    s_barrier
    s_waitcnt vmcnt(0)
    s_barrier
    s_endpgm
fl_entry:
    v_lshlrev_b32 v8, 10, v23
    v_lshrrev_b32 v2, 4, v1
    v_xor_b32 v2, v1, v2
    v_and_b32 v2, 7, v2
    v_lshl_add_u32 v8, v2, 4, v8
    v_xor_b32 v9, 64, v8
    v_add_u32 v9, 7168, v9
    v_add_u32 v10, 14336, v8
    v_add_u32 v11, 14336, v9
    s_add_u32 s65, s65, 2048
    s_lshl_b32 s66, s6, 16
    s_mov_b32 s48, s16
    s_mov_b32 s49, s17
    s_mov_b32 s50, 0x200000
    s_mov_b32 s51, 0x20000
    s_add_u32 s68, s60, 0
    s_and_b32 s68, s68, 3
    s_or_b32 s68, s68, s62
    s_lshl_b32 s68, s68, 7
    s_add_u32 s68, s68, s66
    s_mov_b32 m0, 147456
    s_add_u32 s69, s68, 32768
    buffer_load_dwordx4 v8, s[48:51], s68 offen offset:0 lds
    buffer_load_dwordx4 v9, s[48:51], s68 offen offset:1024 lds
    buffer_load_dwordx4 v10, s[48:51], s68 offen offset:2048 lds
    buffer_load_dwordx4 v11, s[48:51], s68 offen offset:3072 lds
    s_mov_b32 m0, 151552
    s_nop 0
    buffer_load_dwordx4 v8, s[48:51], s69 offen offset:0 lds
    buffer_load_dwordx4 v9, s[48:51], s69 offen offset:1024 lds
    buffer_load_dwordx4 v10, s[48:51], s69 offen offset:2048 lds
    buffer_load_dwordx4 v11, s[48:51], s69 offen offset:3072 lds
    s_add_u32 s68, s60, 0
    s_and_b32 s68, s68, 3
    s_or_b32 s68, s68, s62
    s_mul_i32 s68, s68, 196608
    s_add_u32 s68, s68, s65
    s_mov_b32 m0, 139264
    s_add_u32 s69, s68, 98304
    buffer_load_dwordx4 v4, s[44:47], s68 offen offset:0 lds
    buffer_load_dwordx4 v5, s[44:47], s68 offen offset:1024 lds
    buffer_load_dwordx4 v6, s[44:47], s68 offen offset:2048 lds
    buffer_load_dwordx4 v7, s[44:47], s68 offen offset:3072 lds
    s_mov_b32 m0, 143360
    s_nop 0
    buffer_load_dwordx4 v4, s[44:47], s69 offen offset:0 lds
    buffer_load_dwordx4 v5, s[44:47], s69 offen offset:1024 lds
    buffer_load_dwordx4 v6, s[44:47], s69 offen offset:2048 lds
    buffer_load_dwordx4 v7, s[44:47], s69 offen offset:3072 lds
    s_add_u32 s68, s60, 1
    s_and_b32 s68, s68, 3
    s_or_b32 s68, s68, s62
    s_lshl_b32 s68, s68, 7
    s_add_u32 s68, s68, s66
    s_mov_b32 m0, 131072
    s_add_u32 s69, s68, 32768
    buffer_load_dwordx4 v8, s[48:51], s68 offen offset:0 lds
    buffer_load_dwordx4 v9, s[48:51], s68 offen offset:1024 lds
    buffer_load_dwordx4 v10, s[48:51], s68 offen offset:2048 lds
    buffer_load_dwordx4 v11, s[48:51], s68 offen offset:3072 lds
    s_mov_b32 m0, 135168
    s_nop 0
    buffer_load_dwordx4 v8, s[48:51], s69 offen offset:0 lds
    buffer_load_dwordx4 v9, s[48:51], s69 offen offset:1024 lds
    buffer_load_dwordx4 v10, s[48:51], s69 offen offset:2048 lds
    buffer_load_dwordx4 v11, s[48:51], s69 offen offset:3072 lds
    s_add_u32 s68, s60, 1
    s_and_b32 s68, s68, 3
    s_or_b32 s68, s68, s62
    s_mul_i32 s68, s68, 196608
    s_add_u32 s68, s68, s65
    s_mov_b32 m0, 122880
    s_add_u32 s69, s68, 98304
    buffer_load_dwordx4 v4, s[44:47], s68 offen offset:0 lds
    buffer_load_dwordx4 v5, s[44:47], s68 offen offset:1024 lds
    buffer_load_dwordx4 v6, s[44:47], s68 offen offset:2048 lds
    buffer_load_dwordx4 v7, s[44:47], s68 offen offset:3072 lds
    s_mov_b32 m0, 126976
    s_nop 0
    buffer_load_dwordx4 v4, s[44:47], s69 offen offset:0 lds
    buffer_load_dwordx4 v5, s[44:47], s69 offen offset:1024 lds
    buffer_load_dwordx4 v6, s[44:47], s69 offen offset:2048 lds
    buffer_load_dwordx4 v7, s[44:47], s69 offen offset:3072 lds
    s_mov_b32 s64, 0x665000
    s_load_dword s11, s[38:39], s64
    v_lshlrev_b32 v12, 4, v1
    v_lshrrev_b32 v13, 1, v1
    v_lshlrev_b32 v13, 8, v13
    v_and_b32 v2, 1, v1
    v_lshl_add_u32 v13, v2, 4, v13
    s_mul_i32 s23, s10, 147
    s_mul_i32 s64, s9, 256
    s_add_u32 s23, s23, s64
    s_lshr_b32 s23, s23, 6
    s_sub_u32 s64, s23, 16
    s_cmp_ge_u32 s23, 16
    s_cselect_b32 s23, s64, s23
    s_mul_i32 s26, s10, 147
    s_lshr_b32 s26, s26, 6
    s_sub_u32 s64, s26, 16
    s_cmp_ge_u32 s26, 16
    s_cselect_b32 s26, s64, s26
    s_and_b32 s27, s4, 1
    s_mul_i32 s27, s27, 16
    s_sub_u32 s30, 16, s27
    s_mul_i32 s32, s10, 112
    s_mul_i32 s64, s9, 224
    s_add_u32 s32, s32, s64
    s_lshr_b32 s32, s32, 6
    s_sub_u32 s64, s32, 14
    s_cmp_ge_u32 s32, 14
    s_cselect_b32 s32, s64, s32
    s_mul_i32 s33, s10, 112
    s_lshr_b32 s33, s33, 6
    s_sub_u32 s64, s33, 14
    s_cmp_ge_u32 s33, 14
    s_cselect_b32 s33, s64, s33
    s_and_b32 s34, s4, 1
    s_mul_i32 s34, s34, 14
    s_sub_u32 s35, 14, s34
    s_lshl_b32 s61, s9, 1
    s_add_u32 s61, s61, s10
    s_lshl_b32 s67, s7, 18
    s_add_u32 s67, s67, 0x10000
    s_add_u32 s70, s66, 0x410000
    s_mul_i32 s71, s7, 229376
    s_add_u32 s71, s71, 0x220000
    s_lshl_b32 s76, s6, 8
    s_add_u32 s77, s76, 0x660000
    s_lshl_b32 s78, s7, 2
    s_add_u32 s76, s76, s78
    s_add_u32 s76, s76, 0x663000
    s_lshl_b32 s78, s7, 8
    s_add_u32 s72, s78, 0x662800
    s_xor_b32 s52, s78, 1024
    s_add_u32 s52, s52, 0x662800
    s_add_u32 s78, s78, 0x662000
    s_lshl_b32 s53, s2, 8
    s_xor_b32 s54, s53, 256
    s_add_u32 s53, s53, 0x666000
    s_add_u32 s54, s54, 0x666000
    s_mov_b32 s40, s38
    s_mov_b32 s41, s39
    s_mov_b32 s42, 0x2000000
    s_mov_b32 s43, 0x20000
    s_mov_b32 s15, 0x663000
    s_waitcnt lgkmcnt(0)
    s_mul_i32 s11, s11, 0x9E3779B1
    s_add_u32 s11, s11, 0x7F4A7C15
    s_waitcnt vmcnt(16)
    s_barrier
    s_add_u32 s68, s60, 2
    s_and_b32 s68, s68, 3
    s_or_b32 s68, s68, s62
    s_lshl_b32 s68, s68, 7
    s_add_u32 s68, s68, s66
    s_mov_b32 m0, 114688
    s_add_u32 s69, s68, 32768
    buffer_load_dwordx4 v8, s[48:51], s68 offen offset:0 lds
    buffer_load_dwordx4 v9, s[48:51], s68 offen offset:1024 lds
    buffer_load_dwordx4 v10, s[48:51], s68 offen offset:2048 lds
    buffer_load_dwordx4 v11, s[48:51], s68 offen offset:3072 lds
    s_mov_b32 m0, 118784
    s_nop 0
    buffer_load_dwordx4 v8, s[48:51], s69 offen offset:0 lds
    buffer_load_dwordx4 v9, s[48:51], s69 offen offset:1024 lds
    buffer_load_dwordx4 v10, s[48:51], s69 offen offset:2048 lds
    buffer_load_dwordx4 v11, s[48:51], s69 offen offset:3072 lds
    s_add_u32 s68, s60, 2
    s_and_b32 s68, s68, 3
    s_or_b32 s68, s68, s62
    s_mul_i32 s68, s68, 196608
    s_add_u32 s68, s68, s65
    s_mov_b32 m0, 106496
    s_add_u32 s69, s68, 98304
    buffer_load_dwordx4 v4, s[44:47], s68 offen offset:0 lds
    buffer_load_dwordx4 v5, s[44:47], s68 offen offset:1024 lds
    buffer_load_dwordx4 v6, s[44:47], s68 offen offset:2048 lds
    buffer_load_dwordx4 v7, s[44:47], s68 offen offset:3072 lds
    s_mov_b32 m0, 110592
    s_nop 0
    buffer_load_dwordx4 v4, s[44:47], s69 offen offset:0 lds
    buffer_load_dwordx4 v5, s[44:47], s69 offen offset:1024 lds
    buffer_load_dwordx4 v6, s[44:47], s69 offen offset:2048 lds
    buffer_load_dwordx4 v7, s[44:47], s69 offen offset:3072 lds
    s_waitcnt vmcnt(16)
    s_barrier
    s_mov_b32 s73, s11
    s_atomic_swap s73, s[38:39], s76
    s_add_u32 s68, s60, 3
    s_and_b32 s68, s68, 3
    s_or_b32 s68, s68, s62
    s_lshl_b32 s68, s68, 7
    s_add_u32 s68, s68, s66
    s_mov_b32 m0, 147456
    s_add_u32 s69, s68, 32768
    buffer_load_dwordx4 v8, s[48:51], s68 offen offset:0 lds
    buffer_load_dwordx4 v9, s[48:51], s68 offen offset:1024 lds
    buffer_load_dwordx4 v10, s[48:51], s68 offen offset:2048 lds
    buffer_load_dwordx4 v11, s[48:51], s68 offen offset:3072 lds
    s_mov_b32 m0, 151552
    s_nop 0
    buffer_load_dwordx4 v8, s[48:51], s69 offen offset:0 lds
    buffer_load_dwordx4 v9, s[48:51], s69 offen offset:1024 lds
    buffer_load_dwordx4 v10, s[48:51], s69 offen offset:2048 lds
    buffer_load_dwordx4 v11, s[48:51], s69 offen offset:3072 lds
    s_add_u32 s68, s60, 3
    s_and_b32 s68, s68, 3
    s_or_b32 s68, s68, s62
    s_mul_i32 s68, s68, 196608
    s_add_u32 s68, s68, s65
    s_mov_b32 m0, 139264
    s_add_u32 s69, s68, 98304
    buffer_load_dwordx4 v4, s[44:47], s68 offen offset:0 lds
    buffer_load_dwordx4 v5, s[44:47], s68 offen offset:1024 lds
    buffer_load_dwordx4 v6, s[44:47], s68 offen offset:2048 lds
    buffer_load_dwordx4 v7, s[44:47], s68 offen offset:3072 lds
    s_mov_b32 m0, 143360
    s_nop 0
    buffer_load_dwordx4 v4, s[44:47], s69 offen offset:0 lds
    buffer_load_dwordx4 v5, s[44:47], s69 offen offset:1024 lds
    buffer_load_dwordx4 v6, s[44:47], s69 offen offset:2048 lds
    buffer_load_dwordx4 v7, s[44:47], s69 offen offset:3072 lds
    s_waitcnt vmcnt(16)
    s_barrier
    s_add_u32 s68, s60, 0
    s_and_b32 s68, s68, 3
    s_or_b32 s68, s68, s62
    s_xor_b32 s68, s68, 4
    s_lshl_b32 s68, s68, 7
    s_add_u32 s68, s68, s66
    s_mov_b32 m0, 131072
    s_add_u32 s69, s68, 32768
    buffer_load_dwordx4 v8, s[48:51], s68 offen offset:0 lds
    buffer_load_dwordx4 v9, s[48:51], s68 offen offset:1024 lds
    buffer_load_dwordx4 v10, s[48:51], s68 offen offset:2048 lds
    buffer_load_dwordx4 v11, s[48:51], s68 offen offset:3072 lds
    s_mov_b32 m0, 135168
    s_nop 0
    buffer_load_dwordx4 v8, s[48:51], s69 offen offset:0 lds
    buffer_load_dwordx4 v9, s[48:51], s69 offen offset:1024 lds
    buffer_load_dwordx4 v10, s[48:51], s69 offen offset:2048 lds
    buffer_load_dwordx4 v11, s[48:51], s69 offen offset:3072 lds
    s_add_u32 s68, s60, 0
    s_and_b32 s68, s68, 3
    s_or_b32 s68, s68, s62
    s_xor_b32 s68, s68, 4
    s_mul_i32 s68, s68, 196608
    s_add_u32 s68, s68, s65
    s_mov_b32 m0, 122880
    s_add_u32 s69, s68, 98304
    buffer_load_dwordx4 v4, s[44:47], s68 offen offset:0 lds
    buffer_load_dwordx4 v5, s[44:47], s68 offen offset:1024 lds
    buffer_load_dwordx4 v6, s[44:47], s68 offen offset:2048 lds
    buffer_load_dwordx4 v7, s[44:47], s68 offen offset:3072 lds
    s_mov_b32 m0, 126976
    s_nop 0
    buffer_load_dwordx4 v4, s[44:47], s69 offen offset:0 lds
    buffer_load_dwordx4 v5, s[44:47], s69 offen offset:1024 lds
    buffer_load_dwordx4 v6, s[44:47], s69 offen offset:2048 lds
    buffer_load_dwordx4 v7, s[44:47], s69 offen offset:3072 lds
    s_waitcnt vmcnt(16)
    s_barrier
    s_add_u32 s68, s60, 1
    s_and_b32 s68, s68, 3
    s_or_b32 s68, s68, s62
    s_xor_b32 s68, s68, 4
    s_lshl_b32 s68, s68, 7
    s_add_u32 s68, s68, s66
    s_mov_b32 m0, 114688
    s_add_u32 s69, s68, 32768
    buffer_load_dwordx4 v8, s[48:51], s68 offen offset:0 lds
    buffer_load_dwordx4 v9, s[48:51], s68 offen offset:1024 lds
    buffer_load_dwordx4 v10, s[48:51], s68 offen offset:2048 lds
    buffer_load_dwordx4 v11, s[48:51], s68 offen offset:3072 lds
    s_mov_b32 m0, 118784
    s_nop 0
    buffer_load_dwordx4 v8, s[48:51], s69 offen offset:0 lds
    buffer_load_dwordx4 v9, s[48:51], s69 offen offset:1024 lds
    buffer_load_dwordx4 v10, s[48:51], s69 offen offset:2048 lds
    buffer_load_dwordx4 v11, s[48:51], s69 offen offset:3072 lds
    s_add_u32 s68, s60, 1
    s_and_b32 s68, s68, 3
    s_or_b32 s68, s68, s62
    s_xor_b32 s68, s68, 4
    s_mul_i32 s68, s68, 196608
    s_add_u32 s68, s68, s65
    s_mov_b32 m0, 106496
    s_add_u32 s69, s68, 98304
    buffer_load_dwordx4 v4, s[44:47], s68 offen offset:0 lds
    buffer_load_dwordx4 v5, s[44:47], s68 offen offset:1024 lds
    buffer_load_dwordx4 v6, s[44:47], s68 offen offset:2048 lds
    buffer_load_dwordx4 v7, s[44:47], s68 offen offset:3072 lds
    s_mov_b32 m0, 110592
    s_nop 0
    buffer_load_dwordx4 v4, s[44:47], s69 offen offset:0 lds
    buffer_load_dwordx4 v5, s[44:47], s69 offen offset:1024 lds
    buffer_load_dwordx4 v6, s[44:47], s69 offen offset:2048 lds
    buffer_load_dwordx4 v7, s[44:47], s69 offen offset:3072 lds
    s_waitcnt vmcnt(16)
    s_barrier
    s_add_u32 s68, s60, 2
    s_and_b32 s68, s68, 3
    s_or_b32 s68, s68, s62
    s_xor_b32 s68, s68, 4
    s_lshl_b32 s68, s68, 7
    s_add_u32 s68, s68, s66
    s_mov_b32 m0, 147456
    s_add_u32 s69, s68, 32768
    buffer_load_dwordx4 v8, s[48:51], s68 offen offset:0 lds
    buffer_load_dwordx4 v9, s[48:51], s68 offen offset:1024 lds
    buffer_load_dwordx4 v10, s[48:51], s68 offen offset:2048 lds
    buffer_load_dwordx4 v11, s[48:51], s68 offen offset:3072 lds
    s_mov_b32 m0, 151552
    s_nop 0
    buffer_load_dwordx4 v8, s[48:51], s69 offen offset:0 lds
    buffer_load_dwordx4 v9, s[48:51], s69 offen offset:1024 lds
    buffer_load_dwordx4 v10, s[48:51], s69 offen offset:2048 lds
    buffer_load_dwordx4 v11, s[48:51], s69 offen offset:3072 lds
    s_add_u32 s68, s60, 2
    s_and_b32 s68, s68, 3
    s_or_b32 s68, s68, s62
    s_xor_b32 s68, s68, 4
    s_mul_i32 s68, s68, 196608
    s_add_u32 s68, s68, s65
    s_mov_b32 m0, 139264
    s_add_u32 s69, s68, 98304
    buffer_load_dwordx4 v4, s[44:47], s68 offen offset:0 lds
    buffer_load_dwordx4 v5, s[44:47], s68 offen offset:1024 lds
    buffer_load_dwordx4 v6, s[44:47], s68 offen offset:2048 lds
    buffer_load_dwordx4 v7, s[44:47], s68 offen offset:3072 lds
    s_mov_b32 m0, 143360
    s_nop 0
    buffer_load_dwordx4 v4, s[44:47], s69 offen offset:0 lds
    buffer_load_dwordx4 v5, s[44:47], s69 offen offset:1024 lds
    buffer_load_dwordx4 v6, s[44:47], s69 offen offset:2048 lds
    buffer_load_dwordx4 v7, s[44:47], s69 offen offset:3072 lds
    buffer_load_dwordx4 v[14:17], v13, s[40:43], s15 offen sc1
    s_cmp_ge_u32 s5, 28
    s_cbranch_scc1 fl_spare
    s_waitcnt vmcnt(17)
    s_barrier
    s_add_u32 s68, s60, 3
    s_and_b32 s68, s68, 3
    s_or_b32 s68, s68, s62
    s_xor_b32 s68, s68, 4
    s_lshl_b32 s68, s68, 7
    s_add_u32 s68, s68, s66
    s_mov_b32 m0, 131072
    s_add_u32 s69, s68, 32768
    buffer_load_dwordx4 v8, s[48:51], s68 offen offset:0 lds
    buffer_load_dwordx4 v9, s[48:51], s68 offen offset:1024 lds
    buffer_load_dwordx4 v10, s[48:51], s68 offen offset:2048 lds
    buffer_load_dwordx4 v11, s[48:51], s68 offen offset:3072 lds
    s_mov_b32 m0, 135168
    s_nop 0
    buffer_load_dwordx4 v8, s[48:51], s69 offen offset:0 lds
    buffer_load_dwordx4 v9, s[48:51], s69 offen offset:1024 lds
    buffer_load_dwordx4 v10, s[48:51], s69 offen offset:2048 lds
    buffer_load_dwordx4 v11, s[48:51], s69 offen offset:3072 lds
    s_add_u32 s68, s60, 3
    s_and_b32 s68, s68, 3
    s_or_b32 s68, s68, s62
    s_xor_b32 s68, s68, 4
    s_mul_i32 s68, s68, 196608
    s_add_u32 s68, s68, s65
    s_mov_b32 m0, 122880
    s_add_u32 s69, s68, 98304
    buffer_load_dwordx4 v4, s[44:47], s68 offen offset:0 lds
    buffer_load_dwordx4 v5, s[44:47], s68 offen offset:1024 lds
    buffer_load_dwordx4 v6, s[44:47], s68 offen offset:2048 lds
    buffer_load_dwordx4 v7, s[44:47], s68 offen offset:3072 lds
    s_mov_b32 m0, 126976
    s_nop 0
    buffer_load_dwordx4 v4, s[44:47], s69 offen offset:0 lds
    buffer_load_dwordx4 v5, s[44:47], s69 offen offset:1024 lds
    buffer_load_dwordx4 v6, s[44:47], s69 offen offset:2048 lds
    buffer_load_dwordx4 v7, s[44:47], s69 offen offset:3072 lds
    s_waitcnt vmcnt(17)
    s_barrier
    s_mov_b32 s75, 200000
    s_waitcnt vmcnt(16)
    s_branch fl_hf0_chk
fl_hf0:
    buffer_load_dwordx4 v[14:17], v13, s[40:43], s15 offen sc1
    s_waitcnt vmcnt(0)
fl_hf0_chk:
    v_xor_b32 v14, s11, v14
    v_xor_b32 v15, s11, v15
    v_xor_b32 v16, s11, v16
    v_xor_b32 v17, s11, v17
    v_or3_b32 v14, v14, v15, v16
    v_or_b32 v14, v14, v17
    v_cmp_ne_u32 vcc, 0, v14
    s_nop 0
    s_cmp_eq_u64 vcc, 0
    s_cbranch_scc1 fl_hf0_ok
    s_sub_u32 s75, s75, 1
    s_cmp_lg_u32 s75, 0
    s_cbranch_scc1 fl_hf0
fl_hf0_ok:
    s_cmp_lg_u32 s2, 0
    s_cbranch_scc1 fl_noe
    s_mov_b32 s68, 0x665000
    s_mov_b32 s73, s11
    s_atomic_swap s73, s[38:39], s68
fl_noe:
    s_add_u32 s68, s23, 0
    s_add_u32 s68, s68, s27
    s_lshl_b32 s68, s68, 13
    s_add_u32 s68, s68, s67
    s_mov_b32 m0, 114688
    s_add_u32 s69, s68, 4096
    buffer_load_dwordx4 v12, s[40:43], s68 offen offset:0 sc1 lds
    buffer_load_dwordx4 v12, s[40:43], s68 offen offset:1024 sc1 lds
    buffer_load_dwordx4 v12, s[40:43], s68 offen offset:2048 sc1 lds
    buffer_load_dwordx4 v12, s[40:43], s68 offen offset:3072 sc1 lds
    s_mov_b32 m0, 118784
    s_nop 0
    buffer_load_dwordx4 v12, s[40:43], s69 offen offset:0 sc1 lds
    buffer_load_dwordx4 v12, s[40:43], s69 offen offset:1024 sc1 lds
    buffer_load_dwordx4 v12, s[40:43], s69 offen offset:2048 sc1 lds
    buffer_load_dwordx4 v12, s[40:43], s69 offen offset:3072 sc1 lds
    s_cmp_ge_u32 s23, 15
    s_cselect_b32 s68, -15, 1
    s_add_u32 s68, s68, s23
    s_add_u32 s68, s68, s27
    s_lshl_b32 s68, s68, 13
    s_add_u32 s68, s68, s67
    s_mov_b32 m0, 106496
    s_add_u32 s69, s68, 4096
    buffer_load_dwordx4 v12, s[40:43], s68 offen offset:0 sc1 lds
    buffer_load_dwordx4 v12, s[40:43], s68 offen offset:1024 sc1 lds
    buffer_load_dwordx4 v12, s[40:43], s68 offen offset:2048 sc1 lds
    buffer_load_dwordx4 v12, s[40:43], s68 offen offset:3072 sc1 lds
    s_mov_b32 m0, 110592
    s_nop 0
    buffer_load_dwordx4 v12, s[40:43], s69 offen offset:0 sc1 lds
    buffer_load_dwordx4 v12, s[40:43], s69 offen offset:1024 sc1 lds
    buffer_load_dwordx4 v12, s[40:43], s69 offen offset:2048 sc1 lds
    buffer_load_dwordx4 v12, s[40:43], s69 offen offset:3072 sc1 lds
    s_waitcnt vmcnt(16)
    s_barrier
    s_cmp_ge_u32 s23, 14
    s_cselect_b32 s68, -14, 2
    s_add_u32 s68, s68, s23
    s_add_u32 s68, s68, s27
    s_lshl_b32 s68, s68, 13
    s_add_u32 s68, s68, s67
    s_mov_b32 m0, 147456
    s_add_u32 s69, s68, 4096
    buffer_load_dwordx4 v12, s[40:43], s68 offen offset:0 sc1 lds
    buffer_load_dwordx4 v12, s[40:43], s68 offen offset:1024 sc1 lds
    buffer_load_dwordx4 v12, s[40:43], s68 offen offset:2048 sc1 lds
    buffer_load_dwordx4 v12, s[40:43], s68 offen offset:3072 sc1 lds
    s_mov_b32 m0, 151552
    s_nop 0
    buffer_load_dwordx4 v12, s[40:43], s69 offen offset:0 sc1 lds
    buffer_load_dwordx4 v12, s[40:43], s69 offen offset:1024 sc1 lds
    buffer_load_dwordx4 v12, s[40:43], s69 offen offset:2048 sc1 lds
    buffer_load_dwordx4 v12, s[40:43], s69 offen offset:3072 sc1 lds
    s_cmp_ge_u32 s23, 13
    s_cselect_b32 s68, -13, 3
    s_add_u32 s68, s68, s23
    s_add_u32 s68, s68, s27
    s_lshl_b32 s68, s68, 13
    s_add_u32 s68, s68, s67
    s_mov_b32 m0, 139264
    s_add_u32 s69, s68, 4096
    buffer_load_dwordx4 v12, s[40:43], s68 offen offset:0 sc1 lds
    buffer_load_dwordx4 v12, s[40:43], s68 offen offset:1024 sc1 lds
    buffer_load_dwordx4 v12, s[40:43], s68 offen offset:2048 sc1 lds
    buffer_load_dwordx4 v12, s[40:43], s68 offen offset:3072 sc1 lds
    s_mov_b32 m0, 143360
    s_nop 0
    buffer_load_dwordx4 v12, s[40:43], s69 offen offset:0 sc1 lds
    buffer_load_dwordx4 v12, s[40:43], s69 offen offset:1024 sc1 lds
    buffer_load_dwordx4 v12, s[40:43], s69 offen offset:2048 sc1 lds
    buffer_load_dwordx4 v12, s[40:43], s69 offen offset:3072 sc1 lds
    s_waitcnt vmcnt(24)
    s_barrier
    s_cmp_ge_u32 s23, 12
    s_cselect_b32 s68, -12, 4
    s_add_u32 s68, s68, s23
    s_add_u32 s68, s68, s27
    s_lshl_b32 s68, s68, 13
    s_add_u32 s68, s68, s67
    s_mov_b32 m0, 131072
    s_add_u32 s69, s68, 4096
    buffer_load_dwordx4 v12, s[40:43], s68 offen offset:0 sc1 lds
    buffer_load_dwordx4 v12, s[40:43], s68 offen offset:1024 sc1 lds
    buffer_load_dwordx4 v12, s[40:43], s68 offen offset:2048 sc1 lds
    buffer_load_dwordx4 v12, s[40:43], s68 offen offset:3072 sc1 lds
    s_mov_b32 m0, 135168
    s_nop 0
    buffer_load_dwordx4 v12, s[40:43], s69 offen offset:0 sc1 lds
    buffer_load_dwordx4 v12, s[40:43], s69 offen offset:1024 sc1 lds
    buffer_load_dwordx4 v12, s[40:43], s69 offen offset:2048 sc1 lds
    buffer_load_dwordx4 v12, s[40:43], s69 offen offset:3072 sc1 lds
    s_waitcnt vmcnt(24)
    s_barrier
    s_cmp_ge_u32 s23, 11
    s_cselect_b32 s68, -11, 5
    s_add_u32 s68, s68, s23
    s_add_u32 s68, s68, s27
    s_lshl_b32 s68, s68, 13
    s_add_u32 s68, s68, s67
    s_mov_b32 m0, 122880
    s_add_u32 s69, s68, 4096
    buffer_load_dwordx4 v12, s[40:43], s68 offen offset:0 sc1 lds
    buffer_load_dwordx4 v12, s[40:43], s68 offen offset:1024 sc1 lds
    buffer_load_dwordx4 v12, s[40:43], s68 offen offset:2048 sc1 lds
    buffer_load_dwordx4 v12, s[40:43], s68 offen offset:3072 sc1 lds
    s_mov_b32 m0, 126976
    s_nop 0
    buffer_load_dwordx4 v12, s[40:43], s69 offen offset:0 sc1 lds
    buffer_load_dwordx4 v12, s[40:43], s69 offen offset:1024 sc1 lds
    buffer_load_dwordx4 v12, s[40:43], s69 offen offset:2048 sc1 lds
    buffer_load_dwordx4 v12, s[40:43], s69 offen offset:3072 sc1 lds
    s_waitcnt vmcnt(24)
    s_barrier
    s_cmp_ge_u32 s23, 10
    s_cselect_b32 s68, -10, 6
    s_add_u32 s68, s68, s23
    s_add_u32 s68, s68, s27
    s_lshl_b32 s68, s68, 13
    s_add_u32 s68, s68, s67
    s_mov_b32 m0, 114688
    s_add_u32 s69, s68, 4096
    buffer_load_dwordx4 v12, s[40:43], s68 offen offset:0 sc1 lds
    buffer_load_dwordx4 v12, s[40:43], s68 offen offset:1024 sc1 lds
    buffer_load_dwordx4 v12, s[40:43], s68 offen offset:2048 sc1 lds
    buffer_load_dwordx4 v12, s[40:43], s68 offen offset:3072 sc1 lds
    s_mov_b32 m0, 118784
    s_nop 0
    buffer_load_dwordx4 v12, s[40:43], s69 offen offset:0 sc1 lds
    buffer_load_dwordx4 v12, s[40:43], s69 offen offset:1024 sc1 lds
    buffer_load_dwordx4 v12, s[40:43], s69 offen offset:2048 sc1 lds
    buffer_load_dwordx4 v12, s[40:43], s69 offen offset:3072 sc1 lds
    s_waitcnt vmcnt(24)
    s_barrier
    s_cmp_ge_u32 s23, 9
    s_cselect_b32 s68, -9, 7
    s_add_u32 s68, s68, s23
    s_add_u32 s68, s68, s27
    s_lshl_b32 s68, s68, 13
    s_add_u32 s68, s68, s67
    s_mov_b32 m0, 147456
    s_add_u32 s69, s68, 4096
    buffer_load_dwordx4 v12, s[40:43], s68 offen offset:0 sc1 lds
    buffer_load_dwordx4 v12, s[40:43], s68 offen offset:1024 sc1 lds
    buffer_load_dwordx4 v12, s[40:43], s68 offen offset:2048 sc1 lds
    buffer_load_dwordx4 v12, s[40:43], s68 offen offset:3072 sc1 lds
    s_mov_b32 m0, 151552
    s_nop 0
    buffer_load_dwordx4 v12, s[40:43], s69 offen offset:0 sc1 lds
    buffer_load_dwordx4 v12, s[40:43], s69 offen offset:1024 sc1 lds
    buffer_load_dwordx4 v12, s[40:43], s69 offen offset:2048 sc1 lds
    buffer_load_dwordx4 v12, s[40:43], s69 offen offset:3072 sc1 lds
    s_waitcnt vmcnt(24)
    s_barrier
    s_cmp_ge_u32 s23, 8
    s_cselect_b32 s68, -8, 8
    s_add_u32 s68, s68, s23
    s_add_u32 s68, s68, s27
    s_lshl_b32 s68, s68, 13
    s_add_u32 s68, s68, s67
    s_mov_b32 m0, 139264
    s_add_u32 s69, s68, 4096
    buffer_load_dwordx4 v12, s[40:43], s68 offen offset:0 sc1 lds
    buffer_load_dwordx4 v12, s[40:43], s68 offen offset:1024 sc1 lds
    buffer_load_dwordx4 v12, s[40:43], s68 offen offset:2048 sc1 lds
    buffer_load_dwordx4 v12, s[40:43], s68 offen offset:3072 sc1 lds
    s_mov_b32 m0, 143360
    s_nop 0
    buffer_load_dwordx4 v12, s[40:43], s69 offen offset:0 sc1 lds
    buffer_load_dwordx4 v12, s[40:43], s69 offen offset:1024 sc1 lds
    buffer_load_dwordx4 v12, s[40:43], s69 offen offset:2048 sc1 lds
    buffer_load_dwordx4 v12, s[40:43], s69 offen offset:3072 sc1 lds
    s_waitcnt vmcnt(24)
    s_barrier
    s_mov_b32 s73, 1
    s_atomic_add s73, s[38:39], s78
    s_cmp_ge_u32 s23, 7
    s_cselect_b32 s68, -7, 9
    s_add_u32 s68, s68, s23
    s_add_u32 s68, s68, s27
    s_lshl_b32 s68, s68, 13
    s_add_u32 s68, s68, s67
    s_mov_b32 m0, 131072
    s_add_u32 s69, s68, 4096
    buffer_load_dwordx4 v12, s[40:43], s68 offen offset:0 sc1 lds
    buffer_load_dwordx4 v12, s[40:43], s68 offen offset:1024 sc1 lds
    buffer_load_dwordx4 v12, s[40:43], s68 offen offset:2048 sc1 lds
    buffer_load_dwordx4 v12, s[40:43], s68 offen offset:3072 sc1 lds
    s_mov_b32 m0, 135168
    s_nop 0
    buffer_load_dwordx4 v12, s[40:43], s69 offen offset:0 sc1 lds
    buffer_load_dwordx4 v12, s[40:43], s69 offen offset:1024 sc1 lds
    buffer_load_dwordx4 v12, s[40:43], s69 offen offset:2048 sc1 lds
    buffer_load_dwordx4 v12, s[40:43], s69 offen offset:3072 sc1 lds
    s_waitcnt vmcnt(24)
    s_barrier
    s_cmp_ge_u32 s23, 6
    s_cselect_b32 s68, -6, 10
    s_add_u32 s68, s68, s23
    s_add_u32 s68, s68, s27
    s_lshl_b32 s68, s68, 13
    s_add_u32 s68, s68, s67
    s_mov_b32 m0, 122880
    s_add_u32 s69, s68, 4096
    buffer_load_dwordx4 v12, s[40:43], s68 offen offset:0 sc1 lds
    buffer_load_dwordx4 v12, s[40:43], s68 offen offset:1024 sc1 lds
    buffer_load_dwordx4 v12, s[40:43], s68 offen offset:2048 sc1 lds
    buffer_load_dwordx4 v12, s[40:43], s68 offen offset:3072 sc1 lds
    s_mov_b32 m0, 126976
    s_nop 0
    buffer_load_dwordx4 v12, s[40:43], s69 offen offset:0 sc1 lds
    buffer_load_dwordx4 v12, s[40:43], s69 offen offset:1024 sc1 lds
    buffer_load_dwordx4 v12, s[40:43], s69 offen offset:2048 sc1 lds
    buffer_load_dwordx4 v12, s[40:43], s69 offen offset:3072 sc1 lds
    s_waitcnt vmcnt(24)
    s_barrier
    s_cmp_ge_u32 s23, 5
    s_cselect_b32 s68, -5, 11
    s_add_u32 s68, s68, s23
    s_add_u32 s68, s68, s27
    s_lshl_b32 s68, s68, 13
    s_add_u32 s68, s68, s67
    s_mov_b32 m0, 114688
    s_add_u32 s69, s68, 4096
    buffer_load_dwordx4 v12, s[40:43], s68 offen offset:0 sc1 lds
    buffer_load_dwordx4 v12, s[40:43], s68 offen offset:1024 sc1 lds
    buffer_load_dwordx4 v12, s[40:43], s68 offen offset:2048 sc1 lds
    buffer_load_dwordx4 v12, s[40:43], s68 offen offset:3072 sc1 lds
    s_mov_b32 m0, 118784
    s_nop 0
    buffer_load_dwordx4 v12, s[40:43], s69 offen offset:0 sc1 lds
    buffer_load_dwordx4 v12, s[40:43], s69 offen offset:1024 sc1 lds
    buffer_load_dwordx4 v12, s[40:43], s69 offen offset:2048 sc1 lds
    buffer_load_dwordx4 v12, s[40:43], s69 offen offset:3072 sc1 lds
    s_waitcnt vmcnt(24)
    s_barrier
    s_cmp_ge_u32 s23, 4
    s_cselect_b32 s68, -4, 12
    s_add_u32 s68, s68, s23
    s_add_u32 s68, s68, s27
    s_lshl_b32 s68, s68, 13
    s_add_u32 s68, s68, s67
    s_mov_b32 m0, 147456
    s_add_u32 s69, s68, 4096
    buffer_load_dwordx4 v12, s[40:43], s68 offen offset:0 sc1 lds
    buffer_load_dwordx4 v12, s[40:43], s68 offen offset:1024 sc1 lds
    buffer_load_dwordx4 v12, s[40:43], s68 offen offset:2048 sc1 lds
    buffer_load_dwordx4 v12, s[40:43], s68 offen offset:3072 sc1 lds
    s_mov_b32 m0, 151552
    s_nop 0
    buffer_load_dwordx4 v12, s[40:43], s69 offen offset:0 sc1 lds
    buffer_load_dwordx4 v12, s[40:43], s69 offen offset:1024 sc1 lds
    buffer_load_dwordx4 v12, s[40:43], s69 offen offset:2048 sc1 lds
    buffer_load_dwordx4 v12, s[40:43], s69 offen offset:3072 sc1 lds
    s_waitcnt vmcnt(24)
    s_barrier
    s_cmp_ge_u32 s23, 3
    s_cselect_b32 s68, -3, 13
    s_add_u32 s68, s68, s23
    s_add_u32 s68, s68, s27
    s_lshl_b32 s68, s68, 13
    s_add_u32 s68, s68, s67
    s_mov_b32 m0, 139264
    s_add_u32 s69, s68, 4096
    buffer_load_dwordx4 v12, s[40:43], s68 offen offset:0 sc1 lds
    buffer_load_dwordx4 v12, s[40:43], s68 offen offset:1024 sc1 lds
    buffer_load_dwordx4 v12, s[40:43], s68 offen offset:2048 sc1 lds
    buffer_load_dwordx4 v12, s[40:43], s68 offen offset:3072 sc1 lds
    s_mov_b32 m0, 143360
    s_nop 0
    buffer_load_dwordx4 v12, s[40:43], s69 offen offset:0 sc1 lds
    buffer_load_dwordx4 v12, s[40:43], s69 offen offset:1024 sc1 lds
    buffer_load_dwordx4 v12, s[40:43], s69 offen offset:2048 sc1 lds
    buffer_load_dwordx4 v12, s[40:43], s69 offen offset:3072 sc1 lds
    s_waitcnt vmcnt(24)
    s_barrier
    s_cmp_ge_u32 s23, 2
    s_cselect_b32 s68, -2, 14
    s_add_u32 s68, s68, s23
    s_add_u32 s68, s68, s27
    s_lshl_b32 s68, s68, 13
    s_add_u32 s68, s68, s67
    s_mov_b32 m0, 131072
    s_add_u32 s69, s68, 4096
    buffer_load_dwordx4 v12, s[40:43], s68 offen offset:0 sc1 lds
    buffer_load_dwordx4 v12, s[40:43], s68 offen offset:1024 sc1 lds
    buffer_load_dwordx4 v12, s[40:43], s68 offen offset:2048 sc1 lds
    buffer_load_dwordx4 v12, s[40:43], s68 offen offset:3072 sc1 lds
    s_mov_b32 m0, 135168
    s_nop 0
    buffer_load_dwordx4 v12, s[40:43], s69 offen offset:0 sc1 lds
    buffer_load_dwordx4 v12, s[40:43], s69 offen offset:1024 sc1 lds
    buffer_load_dwordx4 v12, s[40:43], s69 offen offset:2048 sc1 lds
    buffer_load_dwordx4 v12, s[40:43], s69 offen offset:3072 sc1 lds
    s_waitcnt vmcnt(24)
    s_barrier
    s_mov_b32 s74, 0
    s_atomic_add s74, s[38:39], s78 glc
    s_cmp_ge_u32 s23, 1
    s_cselect_b32 s68, -1, 15
    s_add_u32 s68, s68, s23
    s_add_u32 s68, s68, s27
    s_lshl_b32 s68, s68, 13
    s_add_u32 s68, s68, s67
    s_mov_b32 m0, 122880
    s_add_u32 s69, s68, 4096
    buffer_load_dwordx4 v12, s[40:43], s68 offen offset:0 sc1 lds
    buffer_load_dwordx4 v12, s[40:43], s68 offen offset:1024 sc1 lds
    buffer_load_dwordx4 v12, s[40:43], s68 offen offset:2048 sc1 lds
    buffer_load_dwordx4 v12, s[40:43], s68 offen offset:3072 sc1 lds
    s_mov_b32 m0, 126976
    s_nop 0
    buffer_load_dwordx4 v12, s[40:43], s69 offen offset:0 sc1 lds
    buffer_load_dwordx4 v12, s[40:43], s69 offen offset:1024 sc1 lds
    buffer_load_dwordx4 v12, s[40:43], s69 offen offset:2048 sc1 lds
    buffer_load_dwordx4 v12, s[40:43], s69 offen offset:3072 sc1 lds
    s_waitcnt vmcnt(24)
    s_barrier
    s_add_u32 s68, s26, 0
    s_add_u32 s68, s68, s30
    s_lshl_b32 s68, s68, 13
    s_add_u32 s68, s68, s67
    s_mov_b32 m0, 114688
    s_add_u32 s69, s68, 4096
    buffer_load_dwordx4 v12, s[40:43], s68 offen offset:0 sc1 lds
    buffer_load_dwordx4 v12, s[40:43], s68 offen offset:1024 sc1 lds
    buffer_load_dwordx4 v12, s[40:43], s68 offen offset:2048 sc1 lds
    buffer_load_dwordx4 v12, s[40:43], s68 offen offset:3072 sc1 lds
    s_mov_b32 m0, 118784
    s_nop 0
    buffer_load_dwordx4 v12, s[40:43], s69 offen offset:0 sc1 lds
    buffer_load_dwordx4 v12, s[40:43], s69 offen offset:1024 sc1 lds
    buffer_load_dwordx4 v12, s[40:43], s69 offen offset:2048 sc1 lds
    buffer_load_dwordx4 v12, s[40:43], s69 offen offset:3072 sc1 lds
    s_waitcnt vmcnt(24)
    s_barrier
    s_cmp_ge_u32 s26, 15
    s_cselect_b32 s68, -15, 1
    s_add_u32 s68, s68, s26
    s_add_u32 s68, s68, s30
    s_lshl_b32 s68, s68, 13
    s_add_u32 s68, s68, s67
    s_mov_b32 m0, 147456
    s_add_u32 s69, s68, 4096
    buffer_load_dwordx4 v12, s[40:43], s68 offen offset:0 sc1 lds
    buffer_load_dwordx4 v12, s[40:43], s68 offen offset:1024 sc1 lds
    buffer_load_dwordx4 v12, s[40:43], s68 offen offset:2048 sc1 lds
    buffer_load_dwordx4 v12, s[40:43], s68 offen offset:3072 sc1 lds
    s_mov_b32 m0, 151552
    s_nop 0
    buffer_load_dwordx4 v12, s[40:43], s69 offen offset:0 sc1 lds
    buffer_load_dwordx4 v12, s[40:43], s69 offen offset:1024 sc1 lds
    buffer_load_dwordx4 v12, s[40:43], s69 offen offset:2048 sc1 lds
    buffer_load_dwordx4 v12, s[40:43], s69 offen offset:3072 sc1 lds
    s_waitcnt vmcnt(24)
    s_barrier
    s_cmp_ge_u32 s26, 14
    s_cselect_b32 s68, -14, 2
    s_add_u32 s68, s68, s26
    s_add_u32 s68, s68, s30
    s_lshl_b32 s68, s68, 13
    s_add_u32 s68, s68, s67
    s_mov_b32 m0, 139264
    s_add_u32 s69, s68, 4096
    buffer_load_dwordx4 v12, s[40:43], s68 offen offset:0 sc1 lds
    buffer_load_dwordx4 v12, s[40:43], s68 offen offset:1024 sc1 lds
    buffer_load_dwordx4 v12, s[40:43], s68 offen offset:2048 sc1 lds
    buffer_load_dwordx4 v12, s[40:43], s68 offen offset:3072 sc1 lds
    s_mov_b32 m0, 143360
    s_nop 0
    buffer_load_dwordx4 v12, s[40:43], s69 offen offset:0 sc1 lds
    buffer_load_dwordx4 v12, s[40:43], s69 offen offset:1024 sc1 lds
    buffer_load_dwordx4 v12, s[40:43], s69 offen offset:2048 sc1 lds
    buffer_load_dwordx4 v12, s[40:43], s69 offen offset:3072 sc1 lds
    s_mov_b32 s75, 200000
    s_branch fl_kv_chk
fl_kv:
    s_mov_b32 s74, 0
    s_atomic_add s74, s[38:39], s78 glc
fl_kv_chk:
    s_waitcnt lgkmcnt(0)
    s_cmp_eq_u32 s74, 32
    s_cbranch_scc1 fl_kv_ok
    s_sub_u32 s75, s75, 1
    s_cmp_lg_u32 s75, 0
    s_cbranch_scc1 fl_kv
fl_kv_ok:
    s_mul_i32 s68, s7, 4352
    s_add_u32 s68, s68, 0x620000
    s_mov_b32 m0, 155648
    s_nop 0
    buffer_load_dwordx4 v12, s[40:43], s68 offen offset:0 sc1 lds
    buffer_load_dwordx4 v12, s[40:43], s68 offen offset:1024 sc1 lds
    buffer_load_dwordx4 v12, s[40:43], s68 offen offset:2048 sc1 lds
    buffer_load_dwordx4 v12, s[40:43], s68 offen offset:3072 sc1 lds
    s_add_u32 s68, s68, 4096
    s_mov_b32 m0, 159744
    s_nop 0
    buffer_load_dwordx4 v12, s[40:43], s68 offen sc1 lds
    s_waitcnt vmcnt(29)
    s_barrier
    s_cmp_ge_u32 s26, 13
    s_cselect_b32 s68, -13, 3
    s_add_u32 s68, s68, s26
    s_add_u32 s68, s68, s30
    s_lshl_b32 s68, s68, 13
    s_add_u32 s68, s68, s67
    s_mov_b32 m0, 131072
    s_add_u32 s69, s68, 4096
    buffer_load_dwordx4 v12, s[40:43], s68 offen offset:0 sc1 lds
    buffer_load_dwordx4 v12, s[40:43], s68 offen offset:1024 sc1 lds
    buffer_load_dwordx4 v12, s[40:43], s68 offen offset:2048 sc1 lds
    buffer_load_dwordx4 v12, s[40:43], s68 offen offset:3072 sc1 lds
    s_mov_b32 m0, 135168
    s_nop 0
    buffer_load_dwordx4 v12, s[40:43], s69 offen offset:0 sc1 lds
    buffer_load_dwordx4 v12, s[40:43], s69 offen offset:1024 sc1 lds
    buffer_load_dwordx4 v12, s[40:43], s69 offen offset:2048 sc1 lds
    buffer_load_dwordx4 v12, s[40:43], s69 offen offset:3072 sc1 lds
    s_waitcnt vmcnt(29)
    s_barrier
    s_cmp_ge_u32 s26, 12
    s_cselect_b32 s68, -12, 4
    s_add_u32 s68, s68, s26
    s_add_u32 s68, s68, s30
    s_lshl_b32 s68, s68, 13
    s_add_u32 s68, s68, s67
    s_mov_b32 m0, 122880
    s_add_u32 s69, s68, 4096
    buffer_load_dwordx4 v12, s[40:43], s68 offen offset:0 sc1 lds
    buffer_load_dwordx4 v12, s[40:43], s68 offen offset:1024 sc1 lds
    buffer_load_dwordx4 v12, s[40:43], s68 offen offset:2048 sc1 lds
    buffer_load_dwordx4 v12, s[40:43], s68 offen offset:3072 sc1 lds
    s_mov_b32 m0, 126976
    s_nop 0
    buffer_load_dwordx4 v12, s[40:43], s69 offen offset:0 sc1 lds
    buffer_load_dwordx4 v12, s[40:43], s69 offen offset:1024 sc1 lds
    buffer_load_dwordx4 v12, s[40:43], s69 offen offset:2048 sc1 lds
    buffer_load_dwordx4 v12, s[40:43], s69 offen offset:3072 sc1 lds
    s_waitcnt vmcnt(29)
    s_barrier
    s_cmp_ge_u32 s26, 11
    s_cselect_b32 s68, -11, 5
    s_add_u32 s68, s68, s26
    s_add_u32 s68, s68, s30
    s_lshl_b32 s68, s68, 13
    s_add_u32 s68, s68, s67
    s_mov_b32 m0, 114688
    s_add_u32 s69, s68, 4096
    buffer_load_dwordx4 v12, s[40:43], s68 offen offset:0 sc1 lds
    buffer_load_dwordx4 v12, s[40:43], s68 offen offset:1024 sc1 lds
    buffer_load_dwordx4 v12, s[40:43], s68 offen offset:2048 sc1 lds
    buffer_load_dwordx4 v12, s[40:43], s68 offen offset:3072 sc1 lds
    s_mov_b32 m0, 118784
    s_nop 0
    buffer_load_dwordx4 v12, s[40:43], s69 offen offset:0 sc1 lds
    buffer_load_dwordx4 v12, s[40:43], s69 offen offset:1024 sc1 lds
    buffer_load_dwordx4 v12, s[40:43], s69 offen offset:2048 sc1 lds
    buffer_load_dwordx4 v12, s[40:43], s69 offen offset:3072 sc1 lds
    s_waitcnt vmcnt(24)
    s_barrier
    s_cmp_ge_u32 s26, 10
    s_cselect_b32 s68, -10, 6
    s_add_u32 s68, s68, s26
    s_add_u32 s68, s68, s30
    s_lshl_b32 s68, s68, 13
    s_add_u32 s68, s68, s67
    s_mov_b32 m0, 147456
    s_add_u32 s69, s68, 4096
    buffer_load_dwordx4 v12, s[40:43], s68 offen offset:0 sc1 lds
    buffer_load_dwordx4 v12, s[40:43], s68 offen offset:1024 sc1 lds
    buffer_load_dwordx4 v12, s[40:43], s68 offen offset:2048 sc1 lds
    buffer_load_dwordx4 v12, s[40:43], s68 offen offset:3072 sc1 lds
    s_mov_b32 m0, 151552
    s_nop 0
    buffer_load_dwordx4 v12, s[40:43], s69 offen offset:0 sc1 lds
    buffer_load_dwordx4 v12, s[40:43], s69 offen offset:1024 sc1 lds
    buffer_load_dwordx4 v12, s[40:43], s69 offen offset:2048 sc1 lds
    buffer_load_dwordx4 v12, s[40:43], s69 offen offset:3072 sc1 lds
    s_waitcnt vmcnt(24)
    s_barrier
    s_cmp_ge_u32 s26, 9
    s_cselect_b32 s68, -9, 7
    s_add_u32 s68, s68, s26
    s_add_u32 s68, s68, s30
    s_lshl_b32 s68, s68, 13
    s_add_u32 s68, s68, s67
    s_mov_b32 m0, 139264
    s_add_u32 s69, s68, 4096
    buffer_load_dwordx4 v12, s[40:43], s68 offen offset:0 sc1 lds
    buffer_load_dwordx4 v12, s[40:43], s68 offen offset:1024 sc1 lds
    buffer_load_dwordx4 v12, s[40:43], s68 offen offset:2048 sc1 lds
    buffer_load_dwordx4 v12, s[40:43], s68 offen offset:3072 sc1 lds
    s_mov_b32 m0, 143360
    s_nop 0
    buffer_load_dwordx4 v12, s[40:43], s69 offen offset:0 sc1 lds
    buffer_load_dwordx4 v12, s[40:43], s69 offen offset:1024 sc1 lds
    buffer_load_dwordx4 v12, s[40:43], s69 offen offset:2048 sc1 lds
    buffer_load_dwordx4 v12, s[40:43], s69 offen offset:3072 sc1 lds
    s_waitcnt vmcnt(24)
    s_barrier
    s_cmp_ge_u32 s26, 8
    s_cselect_b32 s68, -8, 8
    s_add_u32 s68, s68, s26
    s_add_u32 s68, s68, s30
    s_lshl_b32 s68, s68, 13
    s_add_u32 s68, s68, s67
    s_mov_b32 m0, 131072
    s_add_u32 s69, s68, 4096
    buffer_load_dwordx4 v12, s[40:43], s68 offen offset:0 sc1 lds
    buffer_load_dwordx4 v12, s[40:43], s68 offen offset:1024 sc1 lds
    buffer_load_dwordx4 v12, s[40:43], s68 offen offset:2048 sc1 lds
    buffer_load_dwordx4 v12, s[40:43], s68 offen offset:3072 sc1 lds
    s_mov_b32 m0, 135168
    s_nop 0
    buffer_load_dwordx4 v12, s[40:43], s69 offen offset:0 sc1 lds
    buffer_load_dwordx4 v12, s[40:43], s69 offen offset:1024 sc1 lds
    buffer_load_dwordx4 v12, s[40:43], s69 offen offset:2048 sc1 lds
    buffer_load_dwordx4 v12, s[40:43], s69 offen offset:3072 sc1 lds
    s_waitcnt vmcnt(24)
    s_barrier
    s_cmp_ge_u32 s26, 7
    s_cselect_b32 s68, -7, 9
    s_add_u32 s68, s68, s26
    s_add_u32 s68, s68, s30
    s_lshl_b32 s68, s68, 13
    s_add_u32 s68, s68, s67
    s_mov_b32 m0, 122880
    s_add_u32 s69, s68, 4096
    buffer_load_dwordx4 v12, s[40:43], s68 offen offset:0 sc1 lds
    buffer_load_dwordx4 v12, s[40:43], s68 offen offset:1024 sc1 lds
    buffer_load_dwordx4 v12, s[40:43], s68 offen offset:2048 sc1 lds
    buffer_load_dwordx4 v12, s[40:43], s68 offen offset:3072 sc1 lds
    s_mov_b32 m0, 126976
    s_nop 0
    buffer_load_dwordx4 v12, s[40:43], s69 offen offset:0 sc1 lds
    buffer_load_dwordx4 v12, s[40:43], s69 offen offset:1024 sc1 lds
    buffer_load_dwordx4 v12, s[40:43], s69 offen offset:2048 sc1 lds
    buffer_load_dwordx4 v12, s[40:43], s69 offen offset:3072 sc1 lds
    s_waitcnt vmcnt(24)
    s_barrier
    s_cmp_ge_u32 s26, 6
    s_cselect_b32 s68, -6, 10
    s_add_u32 s68, s68, s26
    s_add_u32 s68, s68, s30
    s_lshl_b32 s68, s68, 13
    s_add_u32 s68, s68, s67
    s_mov_b32 m0, 114688
    s_add_u32 s69, s68, 4096
    buffer_load_dwordx4 v12, s[40:43], s68 offen offset:0 sc1 lds
    buffer_load_dwordx4 v12, s[40:43], s68 offen offset:1024 sc1 lds
    buffer_load_dwordx4 v12, s[40:43], s68 offen offset:2048 sc1 lds
    buffer_load_dwordx4 v12, s[40:43], s68 offen offset:3072 sc1 lds
    s_mov_b32 m0, 118784
    s_nop 0
    buffer_load_dwordx4 v12, s[40:43], s69 offen offset:0 sc1 lds
    buffer_load_dwordx4 v12, s[40:43], s69 offen offset:1024 sc1 lds
    buffer_load_dwordx4 v12, s[40:43], s69 offen offset:2048 sc1 lds
    buffer_load_dwordx4 v12, s[40:43], s69 offen offset:3072 sc1 lds
    s_waitcnt vmcnt(24)
    s_barrier
    s_cmp_ge_u32 s26, 5
    s_cselect_b32 s68, -5, 11
    s_add_u32 s68, s68, s26
    s_add_u32 s68, s68, s30
    s_lshl_b32 s68, s68, 13
    s_add_u32 s68, s68, s67
    s_mov_b32 m0, 147456
    s_add_u32 s69, s68, 4096
    buffer_load_dwordx4 v12, s[40:43], s68 offen offset:0 sc1 lds
    buffer_load_dwordx4 v12, s[40:43], s68 offen offset:1024 sc1 lds
    buffer_load_dwordx4 v12, s[40:43], s68 offen offset:2048 sc1 lds
    buffer_load_dwordx4 v12, s[40:43], s68 offen offset:3072 sc1 lds
    s_mov_b32 m0, 151552
    s_nop 0
    buffer_load_dwordx4 v12, s[40:43], s69 offen offset:0 sc1 lds
    buffer_load_dwordx4 v12, s[40:43], s69 offen offset:1024 sc1 lds
    buffer_load_dwordx4 v12, s[40:43], s69 offen offset:2048 sc1 lds
    buffer_load_dwordx4 v12, s[40:43], s69 offen offset:3072 sc1 lds
    s_waitcnt vmcnt(24)
    s_barrier
    s_cmp_ge_u32 s26, 4
    s_cselect_b32 s68, -4, 12
    s_add_u32 s68, s68, s26
    s_add_u32 s68, s68, s30
    s_lshl_b32 s68, s68, 13
    s_add_u32 s68, s68, s67
    s_mov_b32 m0, 139264
    s_add_u32 s69, s68, 4096
    buffer_load_dwordx4 v12, s[40:43], s68 offen offset:0 sc1 lds
    buffer_load_dwordx4 v12, s[40:43], s68 offen offset:1024 sc1 lds
    buffer_load_dwordx4 v12, s[40:43], s68 offen offset:2048 sc1 lds
    buffer_load_dwordx4 v12, s[40:43], s68 offen offset:3072 sc1 lds
    s_mov_b32 m0, 143360
    s_nop 0
    buffer_load_dwordx4 v12, s[40:43], s69 offen offset:0 sc1 lds
    buffer_load_dwordx4 v12, s[40:43], s69 offen offset:1024 sc1 lds
    buffer_load_dwordx4 v12, s[40:43], s69 offen offset:2048 sc1 lds
    buffer_load_dwordx4 v12, s[40:43], s69 offen offset:3072 sc1 lds
    s_waitcnt vmcnt(24)
    s_barrier
    s_cmp_ge_u32 s26, 3
    s_cselect_b32 s68, -3, 13
    s_add_u32 s68, s68, s26
    s_add_u32 s68, s68, s30
    s_lshl_b32 s68, s68, 13
    s_add_u32 s68, s68, s67
    s_mov_b32 m0, 131072
    s_add_u32 s69, s68, 4096
    buffer_load_dwordx4 v12, s[40:43], s68 offen offset:0 sc1 lds
    buffer_load_dwordx4 v12, s[40:43], s68 offen offset:1024 sc1 lds
    buffer_load_dwordx4 v12, s[40:43], s68 offen offset:2048 sc1 lds
    buffer_load_dwordx4 v12, s[40:43], s68 offen offset:3072 sc1 lds
    s_mov_b32 m0, 135168
    s_nop 0
    buffer_load_dwordx4 v12, s[40:43], s69 offen offset:0 sc1 lds
    buffer_load_dwordx4 v12, s[40:43], s69 offen offset:1024 sc1 lds
    buffer_load_dwordx4 v12, s[40:43], s69 offen offset:2048 sc1 lds
    buffer_load_dwordx4 v12, s[40:43], s69 offen offset:3072 sc1 lds
    s_waitcnt vmcnt(24)
    s_barrier
    s_mov_b32 s73, 1
    s_atomic_add s73, s[38:39], s77
    s_cmp_ge_u32 s26, 2
    s_cselect_b32 s68, -2, 14
    s_add_u32 s68, s68, s26
    s_add_u32 s68, s68, s30
    s_lshl_b32 s68, s68, 13
    s_add_u32 s68, s68, s67
    s_mov_b32 m0, 122880
    s_add_u32 s69, s68, 4096
    buffer_load_dwordx4 v12, s[40:43], s68 offen offset:0 sc1 lds
    buffer_load_dwordx4 v12, s[40:43], s68 offen offset:1024 sc1 lds
    buffer_load_dwordx4 v12, s[40:43], s68 offen offset:2048 sc1 lds
    buffer_load_dwordx4 v12, s[40:43], s68 offen offset:3072 sc1 lds
    s_mov_b32 m0, 126976
    s_nop 0
    buffer_load_dwordx4 v12, s[40:43], s69 offen offset:0 sc1 lds
    buffer_load_dwordx4 v12, s[40:43], s69 offen offset:1024 sc1 lds
    buffer_load_dwordx4 v12, s[40:43], s69 offen offset:2048 sc1 lds
    buffer_load_dwordx4 v12, s[40:43], s69 offen offset:3072 sc1 lds
    s_waitcnt vmcnt(24)
    s_barrier
    s_cmp_ge_u32 s26, 1
    s_cselect_b32 s68, -1, 15
    s_add_u32 s68, s68, s26
    s_add_u32 s68, s68, s30
    s_lshl_b32 s68, s68, 13
    s_add_u32 s68, s68, s67
    s_mov_b32 m0, 114688
    s_add_u32 s69, s68, 4096
    buffer_load_dwordx4 v12, s[40:43], s68 offen offset:0 sc1 lds
    buffer_load_dwordx4 v12, s[40:43], s68 offen offset:1024 sc1 lds
    buffer_load_dwordx4 v12, s[40:43], s68 offen offset:2048 sc1 lds
    buffer_load_dwordx4 v12, s[40:43], s68 offen offset:3072 sc1 lds
    s_mov_b32 m0, 118784
    s_nop 0
    buffer_load_dwordx4 v12, s[40:43], s69 offen offset:0 sc1 lds
    buffer_load_dwordx4 v12, s[40:43], s69 offen offset:1024 sc1 lds
    buffer_load_dwordx4 v12, s[40:43], s69 offen offset:2048 sc1 lds
    buffer_load_dwordx4 v12, s[40:43], s69 offen offset:3072 sc1 lds
    s_waitcnt vmcnt(24)
    s_barrier
    s_waitcnt vmcnt(16)
    s_barrier
    s_mov_b32 s74, 0
    s_atomic_add s74, s[38:39], s77 glc
    s_waitcnt vmcnt(8)
    s_barrier
    s_waitcnt vmcnt(0)
    s_barrier
    s_mov_b32 s75, 200000
    s_branch fl_o_chk
fl_o:
    s_mov_b32 s74, 0
    s_atomic_add s74, s[38:39], s77 glc
fl_o_chk:
    s_waitcnt lgkmcnt(0)
    s_cmp_eq_u32 s74, 8
    s_cbranch_scc1 fl_o_ok
    s_sub_u32 s75, s75, 1
    s_cmp_lg_u32 s75, 0
    s_cbranch_scc1 fl_o
fl_o_ok:
    s_add_u32 s68, s61, 0
    s_and_b32 s68, s68, 7
    s_lshl_b32 s68, s68, 13
    s_add_u32 s68, s68, s70
    s_mov_b32 m0, 147456
    s_add_u32 s69, s68, 4096
    buffer_load_dwordx4 v12, s[40:43], s68 offen offset:0 sc1 lds
    buffer_load_dwordx4 v12, s[40:43], s68 offen offset:1024 sc1 lds
    buffer_load_dwordx4 v12, s[40:43], s68 offen offset:2048 sc1 lds
    buffer_load_dwordx4 v12, s[40:43], s68 offen offset:3072 sc1 lds
    s_mov_b32 m0, 151552
    s_nop 0
    buffer_load_dwordx4 v12, s[40:43], s69 offen offset:0 sc1 lds
    buffer_load_dwordx4 v12, s[40:43], s69 offen offset:1024 sc1 lds
    buffer_load_dwordx4 v12, s[40:43], s69 offen offset:2048 sc1 lds
    buffer_load_dwordx4 v12, s[40:43], s69 offen offset:3072 sc1 lds
    s_add_u32 s68, s61, 1
    s_and_b32 s68, s68, 7
    s_lshl_b32 s68, s68, 13
    s_add_u32 s68, s68, s70
    s_mov_b32 m0, 139264
    s_add_u32 s69, s68, 4096
    buffer_load_dwordx4 v12, s[40:43], s68 offen offset:0 sc1 lds
    buffer_load_dwordx4 v12, s[40:43], s68 offen offset:1024 sc1 lds
    buffer_load_dwordx4 v12, s[40:43], s68 offen offset:2048 sc1 lds
    buffer_load_dwordx4 v12, s[40:43], s68 offen offset:3072 sc1 lds
    s_mov_b32 m0, 143360
    s_nop 0
    buffer_load_dwordx4 v12, s[40:43], s69 offen offset:0 sc1 lds
    buffer_load_dwordx4 v12, s[40:43], s69 offen offset:1024 sc1 lds
    buffer_load_dwordx4 v12, s[40:43], s69 offen offset:2048 sc1 lds
    buffer_load_dwordx4 v12, s[40:43], s69 offen offset:3072 sc1 lds
    s_add_u32 s68, s61, 2
    s_and_b32 s68, s68, 7
    s_lshl_b32 s68, s68, 13
    s_add_u32 s68, s68, s70
    s_mov_b32 m0, 131072
    s_add_u32 s69, s68, 4096
    buffer_load_dwordx4 v12, s[40:43], s68 offen offset:0 sc1 lds
    buffer_load_dwordx4 v12, s[40:43], s68 offen offset:1024 sc1 lds
    buffer_load_dwordx4 v12, s[40:43], s68 offen offset:2048 sc1 lds
    buffer_load_dwordx4 v12, s[40:43], s68 offen offset:3072 sc1 lds
    s_mov_b32 m0, 135168
    s_nop 0
    buffer_load_dwordx4 v12, s[40:43], s69 offen offset:0 sc1 lds
    buffer_load_dwordx4 v12, s[40:43], s69 offen offset:1024 sc1 lds
    buffer_load_dwordx4 v12, s[40:43], s69 offen offset:2048 sc1 lds
    buffer_load_dwordx4 v12, s[40:43], s69 offen offset:3072 sc1 lds
    s_add_u32 s68, s61, 3
    s_and_b32 s68, s68, 7
    s_lshl_b32 s68, s68, 13
    s_add_u32 s68, s68, s70
    s_mov_b32 m0, 122880
    s_add_u32 s69, s68, 4096
    buffer_load_dwordx4 v12, s[40:43], s68 offen offset:0 sc1 lds
    buffer_load_dwordx4 v12, s[40:43], s68 offen offset:1024 sc1 lds
    buffer_load_dwordx4 v12, s[40:43], s68 offen offset:2048 sc1 lds
    buffer_load_dwordx4 v12, s[40:43], s68 offen offset:3072 sc1 lds
    s_mov_b32 m0, 126976
    s_nop 0
    buffer_load_dwordx4 v12, s[40:43], s69 offen offset:0 sc1 lds
    buffer_load_dwordx4 v12, s[40:43], s69 offen offset:1024 sc1 lds
    buffer_load_dwordx4 v12, s[40:43], s69 offen offset:2048 sc1 lds
    buffer_load_dwordx4 v12, s[40:43], s69 offen offset:3072 sc1 lds
    s_branch fl_q
fl_spare:
    s_waitcnt vmcnt(17)
    s_barrier
    s_add_u32 s68, s60, 3
    s_and_b32 s68, s68, 3
    s_or_b32 s68, s68, s62
    s_xor_b32 s68, s68, 4
    s_lshl_b32 s68, s68, 7
    s_add_u32 s68, s68, s66
    s_mov_b32 m0, 131072
    s_add_u32 s69, s68, 32768
    buffer_load_dwordx4 v8, s[48:51], s68 offen offset:0 lds
    buffer_load_dwordx4 v9, s[48:51], s68 offen offset:1024 lds
    buffer_load_dwordx4 v10, s[48:51], s68 offen offset:2048 lds
    buffer_load_dwordx4 v11, s[48:51], s68 offen offset:3072 lds
    s_mov_b32 m0, 135168
    s_nop 0
    buffer_load_dwordx4 v8, s[48:51], s69 offen offset:0 lds
    buffer_load_dwordx4 v9, s[48:51], s69 offen offset:1024 lds
    buffer_load_dwordx4 v10, s[48:51], s69 offen offset:2048 lds
    buffer_load_dwordx4 v11, s[48:51], s69 offen offset:3072 lds
    s_add_u32 s68, s60, 3
    s_and_b32 s68, s68, 3
    s_or_b32 s68, s68, s62
    s_xor_b32 s68, s68, 4
    s_mul_i32 s68, s68, 196608
    s_add_u32 s68, s68, s65
    s_mov_b32 m0, 122880
    s_add_u32 s69, s68, 98304
    buffer_load_dwordx4 v4, s[44:47], s68 offen offset:0 lds
    buffer_load_dwordx4 v5, s[44:47], s68 offen offset:1024 lds
    buffer_load_dwordx4 v6, s[44:47], s68 offen offset:2048 lds
    buffer_load_dwordx4 v7, s[44:47], s68 offen offset:3072 lds
    s_mov_b32 m0, 126976
    s_nop 0
    buffer_load_dwordx4 v4, s[44:47], s69 offen offset:0 lds
    buffer_load_dwordx4 v5, s[44:47], s69 offen offset:1024 lds
    buffer_load_dwordx4 v6, s[44:47], s69 offen offset:2048 lds
    buffer_load_dwordx4 v7, s[44:47], s69 offen offset:3072 lds
    s_waitcnt vmcnt(17)
    s_barrier
    s_mov_b32 s75, 200000
    s_waitcnt vmcnt(16)
    s_branch fl_hf1_chk
fl_hf1:
    buffer_load_dwordx4 v[14:17], v13, s[40:43], s15 offen sc1
    s_waitcnt vmcnt(0)
fl_hf1_chk:
    v_xor_b32 v14, s11, v14
    v_xor_b32 v15, s11, v15
    v_xor_b32 v16, s11, v16
    v_xor_b32 v17, s11, v17
    v_or3_b32 v14, v14, v15, v16
    v_or_b32 v14, v14, v17
    v_cmp_ne_u32 vcc, 0, v14
    s_nop 0
    s_cmp_eq_u64 vcc, 0
    s_cbranch_scc1 fl_hf1_ok
    s_sub_u32 s75, s75, 1
    s_cmp_lg_u32 s75, 0
    s_cbranch_scc1 fl_hf1
fl_hf1_ok:
    s_waitcnt vmcnt(0)
    s_barrier
    s_barrier
    s_mov_b32 s75, 200000
fl_os:
    s_mov_b32 s74, 0
    s_atomic_add s74, s[38:39], s77 glc
fl_os_chk:
    s_waitcnt lgkmcnt(0)
    s_cmp_eq_u32 s74, 8
    s_cbranch_scc1 fl_os_ok
    s_sleep 2
    s_sub_u32 s75, s75, 1
    s_cmp_lg_u32 s75, 0
    s_cbranch_scc1 fl_os
fl_os_ok:
    s_add_u32 s68, s61, 0
    s_and_b32 s68, s68, 7
    s_lshl_b32 s68, s68, 13
    s_add_u32 s68, s68, s70
    s_mov_b32 m0, 147456
    s_add_u32 s69, s68, 4096
    buffer_load_dwordx4 v12, s[40:43], s68 offen offset:0 sc1 lds
    buffer_load_dwordx4 v12, s[40:43], s68 offen offset:1024 sc1 lds
    buffer_load_dwordx4 v12, s[40:43], s68 offen offset:2048 sc1 lds
    buffer_load_dwordx4 v12, s[40:43], s68 offen offset:3072 sc1 lds
    s_mov_b32 m0, 151552
    s_nop 0
    buffer_load_dwordx4 v12, s[40:43], s69 offen offset:0 sc1 lds
    buffer_load_dwordx4 v12, s[40:43], s69 offen offset:1024 sc1 lds
    buffer_load_dwordx4 v12, s[40:43], s69 offen offset:2048 sc1 lds
    buffer_load_dwordx4 v12, s[40:43], s69 offen offset:3072 sc1 lds
    s_add_u32 s68, s61, 1
    s_and_b32 s68, s68, 7
    s_lshl_b32 s68, s68, 13
    s_add_u32 s68, s68, s70
    s_mov_b32 m0, 139264
    s_add_u32 s69, s68, 4096
    buffer_load_dwordx4 v12, s[40:43], s68 offen offset:0 sc1 lds
    buffer_load_dwordx4 v12, s[40:43], s68 offen offset:1024 sc1 lds
    buffer_load_dwordx4 v12, s[40:43], s68 offen offset:2048 sc1 lds
    buffer_load_dwordx4 v12, s[40:43], s68 offen offset:3072 sc1 lds
    s_mov_b32 m0, 143360
    s_nop 0
    buffer_load_dwordx4 v12, s[40:43], s69 offen offset:0 sc1 lds
    buffer_load_dwordx4 v12, s[40:43], s69 offen offset:1024 sc1 lds
    buffer_load_dwordx4 v12, s[40:43], s69 offen offset:2048 sc1 lds
    buffer_load_dwordx4 v12, s[40:43], s69 offen offset:3072 sc1 lds
    s_add_u32 s68, s61, 2
    s_and_b32 s68, s68, 7
    s_lshl_b32 s68, s68, 13
    s_add_u32 s68, s68, s70
    s_mov_b32 m0, 131072
    s_add_u32 s69, s68, 4096
    buffer_load_dwordx4 v12, s[40:43], s68 offen offset:0 sc1 lds
    buffer_load_dwordx4 v12, s[40:43], s68 offen offset:1024 sc1 lds
    buffer_load_dwordx4 v12, s[40:43], s68 offen offset:2048 sc1 lds
    buffer_load_dwordx4 v12, s[40:43], s68 offen offset:3072 sc1 lds
    s_mov_b32 m0, 135168
    s_nop 0
    buffer_load_dwordx4 v12, s[40:43], s69 offen offset:0 sc1 lds
    buffer_load_dwordx4 v12, s[40:43], s69 offen offset:1024 sc1 lds
    buffer_load_dwordx4 v12, s[40:43], s69 offen offset:2048 sc1 lds
    buffer_load_dwordx4 v12, s[40:43], s69 offen offset:3072 sc1 lds
    s_add_u32 s68, s61, 3
    s_and_b32 s68, s68, 7
    s_lshl_b32 s68, s68, 13
    s_add_u32 s68, s68, s70
    s_mov_b32 m0, 122880
    s_add_u32 s69, s68, 4096
    buffer_load_dwordx4 v12, s[40:43], s68 offen offset:0 sc1 lds
    buffer_load_dwordx4 v12, s[40:43], s68 offen offset:1024 sc1 lds
    buffer_load_dwordx4 v12, s[40:43], s68 offen offset:2048 sc1 lds
    buffer_load_dwordx4 v12, s[40:43], s68 offen offset:3072 sc1 lds
    s_mov_b32 m0, 126976
    s_nop 0
    buffer_load_dwordx4 v12, s[40:43], s69 offen offset:0 sc1 lds
    buffer_load_dwordx4 v12, s[40:43], s69 offen offset:1024 sc1 lds
    buffer_load_dwordx4 v12, s[40:43], s69 offen offset:2048 sc1 lds
    buffer_load_dwordx4 v12, s[40:43], s69 offen offset:3072 sc1 lds
fl_q:
    s_barrier
    s_add_u32 s53, s53, 4
    s_add_u32 s54, s54, 4
    s_waitcnt vmcnt(24)
    s_barrier
    s_cmp_ge_u32 s5, 28
    s_cbranch_scc1 fl_nou
    s_mov_b32 s73, 1
    s_atomic_add s73, s[38:39], s72
fl_nou:
    s_add_u32 s68, s61, 4
    s_and_b32 s68, s68, 7
    s_lshl_b32 s68, s68, 13
    s_add_u32 s68, s68, s70
    s_mov_b32 m0, 114688
    s_add_u32 s69, s68, 4096
    buffer_load_dwordx4 v12, s[40:43], s68 offen offset:0 sc1 lds
    buffer_load_dwordx4 v12, s[40:43], s68 offen offset:1024 sc1 lds
    buffer_load_dwordx4 v12, s[40:43], s68 offen offset:2048 sc1 lds
    buffer_load_dwordx4 v12, s[40:43], s68 offen offset:3072 sc1 lds
    s_mov_b32 m0, 118784
    s_nop 0
    buffer_load_dwordx4 v12, s[40:43], s69 offen offset:0 sc1 lds
    buffer_load_dwordx4 v12, s[40:43], s69 offen offset:1024 sc1 lds
    buffer_load_dwordx4 v12, s[40:43], s69 offen offset:2048 sc1 lds
    buffer_load_dwordx4 v12, s[40:43], s69 offen offset:3072 sc1 lds
    s_waitcnt vmcnt(24)
    s_barrier
    s_add_u32 s68, s61, 5
    s_and_b32 s68, s68, 7
    s_lshl_b32 s68, s68, 13
    s_add_u32 s68, s68, s70
    s_mov_b32 m0, 147456
    s_add_u32 s69, s68, 4096
    buffer_load_dwordx4 v12, s[40:43], s68 offen offset:0 sc1 lds
    buffer_load_dwordx4 v12, s[40:43], s68 offen offset:1024 sc1 lds
    buffer_load_dwordx4 v12, s[40:43], s68 offen offset:2048 sc1 lds
    buffer_load_dwordx4 v12, s[40:43], s68 offen offset:3072 sc1 lds
    s_mov_b32 m0, 151552
    s_nop 0
    buffer_load_dwordx4 v12, s[40:43], s69 offen offset:0 sc1 lds
    buffer_load_dwordx4 v12, s[40:43], s69 offen offset:1024 sc1 lds
    buffer_load_dwordx4 v12, s[40:43], s69 offen offset:2048 sc1 lds
    buffer_load_dwordx4 v12, s[40:43], s69 offen offset:3072 sc1 lds
    s_waitcnt vmcnt(24)
    s_barrier
    s_add_u32 s68, s61, 6
    s_and_b32 s68, s68, 7
    s_lshl_b32 s68, s68, 13
    s_add_u32 s68, s68, s70
    s_mov_b32 m0, 139264
    s_add_u32 s69, s68, 4096
    buffer_load_dwordx4 v12, s[40:43], s68 offen offset:0 sc1 lds
    buffer_load_dwordx4 v12, s[40:43], s68 offen offset:1024 sc1 lds
    buffer_load_dwordx4 v12, s[40:43], s68 offen offset:2048 sc1 lds
    buffer_load_dwordx4 v12, s[40:43], s68 offen offset:3072 sc1 lds
    s_mov_b32 m0, 143360
    s_nop 0
    buffer_load_dwordx4 v12, s[40:43], s69 offen offset:0 sc1 lds
    buffer_load_dwordx4 v12, s[40:43], s69 offen offset:1024 sc1 lds
    buffer_load_dwordx4 v12, s[40:43], s69 offen offset:2048 sc1 lds
    buffer_load_dwordx4 v12, s[40:43], s69 offen offset:3072 sc1 lds
    s_waitcnt vmcnt(24)
    s_barrier
    s_add_u32 s68, s61, 7
    s_and_b32 s68, s68, 7
    s_lshl_b32 s68, s68, 13
    s_add_u32 s68, s68, s70
    s_mov_b32 m0, 131072
    s_add_u32 s69, s68, 4096
    buffer_load_dwordx4 v12, s[40:43], s68 offen offset:0 sc1 lds
    buffer_load_dwordx4 v12, s[40:43], s68 offen offset:1024 sc1 lds
    buffer_load_dwordx4 v12, s[40:43], s68 offen offset:2048 sc1 lds
    buffer_load_dwordx4 v12, s[40:43], s68 offen offset:3072 sc1 lds
    s_mov_b32 m0, 135168
    s_nop 0
    buffer_load_dwordx4 v12, s[40:43], s69 offen offset:0 sc1 lds
    buffer_load_dwordx4 v12, s[40:43], s69 offen offset:1024 sc1 lds
    buffer_load_dwordx4 v12, s[40:43], s69 offen offset:2048 sc1 lds
    buffer_load_dwordx4 v12, s[40:43], s69 offen offset:3072 sc1 lds
    s_waitcnt vmcnt(24)
    s_barrier
    s_mov_b32 s74, 0
    s_atomic_add s74, s[38:39], s72 glc
    s_waitcnt vmcnt(16)
    s_barrier
    s_waitcnt vmcnt(8)
    s_barrier
    s_mov_b32 s75, 200000
    s_branch fl_u_chk
fl_u:
    s_mov_b32 s74, 0
    s_atomic_add s74, s[38:39], s72 glc
fl_u_chk:
    s_waitcnt lgkmcnt(0)
    s_cmp_eq_u32 s74, 28
    s_cbranch_scc1 fl_u_ok
    s_sub_u32 s75, s75, 1
    s_cmp_lg_u32 s75, 0
    s_cbranch_scc1 fl_u
fl_u_ok:
    s_add_u32 s68, s32, 0
    s_add_u32 s68, s68, s34
    s_lshl_b32 s68, s68, 13
    s_add_u32 s68, s68, s71
    s_mov_b32 m0, 147456
    s_add_u32 s69, s68, 4096
    buffer_load_dwordx4 v12, s[40:43], s68 offen offset:0 sc1 lds
    buffer_load_dwordx4 v12, s[40:43], s68 offen offset:1024 sc1 lds
    buffer_load_dwordx4 v12, s[40:43], s68 offen offset:2048 sc1 lds
    buffer_load_dwordx4 v12, s[40:43], s68 offen offset:3072 sc1 lds
    s_mov_b32 m0, 151552
    s_nop 0
    buffer_load_dwordx4 v12, s[40:43], s69 offen offset:0 sc1 lds
    buffer_load_dwordx4 v12, s[40:43], s69 offen offset:1024 sc1 lds
    buffer_load_dwordx4 v12, s[40:43], s69 offen offset:2048 sc1 lds
    buffer_load_dwordx4 v12, s[40:43], s69 offen offset:3072 sc1 lds
    s_cmp_ge_u32 s32, 13
    s_cselect_b32 s68, -13, 1
    s_add_u32 s68, s68, s32
    s_add_u32 s68, s68, s34
    s_lshl_b32 s68, s68, 13
    s_add_u32 s68, s68, s71
    s_mov_b32 m0, 122880
    s_add_u32 s69, s68, 4096
    buffer_load_dwordx4 v12, s[40:43], s68 offen offset:0 sc1 lds
    buffer_load_dwordx4 v12, s[40:43], s68 offen offset:1024 sc1 lds
    buffer_load_dwordx4 v12, s[40:43], s68 offen offset:2048 sc1 lds
    buffer_load_dwordx4 v12, s[40:43], s68 offen offset:3072 sc1 lds
    s_mov_b32 m0, 126976
    s_nop 0
    buffer_load_dwordx4 v12, s[40:43], s69 offen offset:0 sc1 lds
    buffer_load_dwordx4 v12, s[40:43], s69 offen offset:1024 sc1 lds
    buffer_load_dwordx4 v12, s[40:43], s69 offen offset:2048 sc1 lds
    buffer_load_dwordx4 v12, s[40:43], s69 offen offset:3072 sc1 lds
    s_cmp_ge_u32 s32, 12
    s_cselect_b32 s68, -12, 2
    s_add_u32 s68, s68, s32
    s_add_u32 s68, s68, s34
    s_lshl_b32 s68, s68, 13
    s_add_u32 s68, s68, s71
    s_mov_b32 m0, 114688
    s_add_u32 s69, s68, 4096
    buffer_load_dwordx4 v12, s[40:43], s68 offen offset:0 sc1 lds
    buffer_load_dwordx4 v12, s[40:43], s68 offen offset:1024 sc1 lds
    buffer_load_dwordx4 v12, s[40:43], s68 offen offset:2048 sc1 lds
    buffer_load_dwordx4 v12, s[40:43], s68 offen offset:3072 sc1 lds
    s_mov_b32 m0, 118784
    s_nop 0
    buffer_load_dwordx4 v12, s[40:43], s69 offen offset:0 sc1 lds
    buffer_load_dwordx4 v12, s[40:43], s69 offen offset:1024 sc1 lds
    buffer_load_dwordx4 v12, s[40:43], s69 offen offset:2048 sc1 lds
    buffer_load_dwordx4 v12, s[40:43], s69 offen offset:3072 sc1 lds
    s_cmp_ge_u32 s32, 11
    s_cselect_b32 s68, -11, 3
    s_add_u32 s68, s68, s32
    s_add_u32 s68, s68, s34
    s_lshl_b32 s68, s68, 13
    s_add_u32 s68, s68, s71
    s_mov_b32 m0, 106496
    s_add_u32 s69, s68, 4096
    buffer_load_dwordx4 v12, s[40:43], s68 offen offset:0 sc1 lds
    buffer_load_dwordx4 v12, s[40:43], s68 offen offset:1024 sc1 lds
    buffer_load_dwordx4 v12, s[40:43], s68 offen offset:2048 sc1 lds
    buffer_load_dwordx4 v12, s[40:43], s68 offen offset:3072 sc1 lds
    s_mov_b32 m0, 110592
    s_nop 0
    buffer_load_dwordx4 v12, s[40:43], s69 offen offset:0 sc1 lds
    buffer_load_dwordx4 v12, s[40:43], s69 offen offset:1024 sc1 lds
    buffer_load_dwordx4 v12, s[40:43], s69 offen offset:2048 sc1 lds
    buffer_load_dwordx4 v12, s[40:43], s69 offen offset:3072 sc1 lds
    s_waitcnt vmcnt(32)
    s_barrier
    s_waitcnt vmcnt(24)
    s_barrier
    s_cmp_ge_u32 s32, 10
    s_cselect_b32 s68, -10, 4
    s_add_u32 s68, s68, s32
    s_add_u32 s68, s68, s34
    s_lshl_b32 s68, s68, 13
    s_add_u32 s68, s68, s71
    s_mov_b32 m0, 139264
    s_add_u32 s69, s68, 4096
    buffer_load_dwordx4 v12, s[40:43], s68 offen offset:0 sc1 lds
    buffer_load_dwordx4 v12, s[40:43], s68 offen offset:1024 sc1 lds
    buffer_load_dwordx4 v12, s[40:43], s68 offen offset:2048 sc1 lds
    buffer_load_dwordx4 v12, s[40:43], s68 offen offset:3072 sc1 lds
    s_mov_b32 m0, 143360
    s_nop 0
    buffer_load_dwordx4 v12, s[40:43], s69 offen offset:0 sc1 lds
    buffer_load_dwordx4 v12, s[40:43], s69 offen offset:1024 sc1 lds
    buffer_load_dwordx4 v12, s[40:43], s69 offen offset:2048 sc1 lds
    buffer_load_dwordx4 v12, s[40:43], s69 offen offset:3072 sc1 lds
    s_waitcnt vmcnt(24)
    s_barrier
    s_cmp_ge_u32 s32, 9
    s_cselect_b32 s68, -9, 5
    s_add_u32 s68, s68, s32
    s_add_u32 s68, s68, s34
    s_lshl_b32 s68, s68, 13
    s_add_u32 s68, s68, s71
    s_mov_b32 m0, 147456
    s_add_u32 s69, s68, 4096
    buffer_load_dwordx4 v12, s[40:43], s68 offen offset:0 sc1 lds
    buffer_load_dwordx4 v12, s[40:43], s68 offen offset:1024 sc1 lds
    buffer_load_dwordx4 v12, s[40:43], s68 offen offset:2048 sc1 lds
    buffer_load_dwordx4 v12, s[40:43], s68 offen offset:3072 sc1 lds
    s_mov_b32 m0, 151552
    s_nop 0
    buffer_load_dwordx4 v12, s[40:43], s69 offen offset:0 sc1 lds
    buffer_load_dwordx4 v12, s[40:43], s69 offen offset:1024 sc1 lds
    buffer_load_dwordx4 v12, s[40:43], s69 offen offset:2048 sc1 lds
    buffer_load_dwordx4 v12, s[40:43], s69 offen offset:3072 sc1 lds
    s_waitcnt vmcnt(24)
    s_barrier
    s_cmp_ge_u32 s32, 8
    s_cselect_b32 s68, -8, 6
    s_add_u32 s68, s68, s32
    s_add_u32 s68, s68, s34
    s_lshl_b32 s68, s68, 13
    s_add_u32 s68, s68, s71
    s_mov_b32 m0, 131072
    s_add_u32 s69, s68, 4096
    buffer_load_dwordx4 v12, s[40:43], s68 offen offset:0 sc1 lds
    buffer_load_dwordx4 v12, s[40:43], s68 offen offset:1024 sc1 lds
    buffer_load_dwordx4 v12, s[40:43], s68 offen offset:2048 sc1 lds
    buffer_load_dwordx4 v12, s[40:43], s68 offen offset:3072 sc1 lds
    s_mov_b32 m0, 135168
    s_nop 0
    buffer_load_dwordx4 v12, s[40:43], s69 offen offset:0 sc1 lds
    buffer_load_dwordx4 v12, s[40:43], s69 offen offset:1024 sc1 lds
    buffer_load_dwordx4 v12, s[40:43], s69 offen offset:2048 sc1 lds
    buffer_load_dwordx4 v12, s[40:43], s69 offen offset:3072 sc1 lds
    s_waitcnt vmcnt(24)
    s_barrier
    s_cmp_ge_u32 s32, 7
    s_cselect_b32 s68, -7, 7
    s_add_u32 s68, s68, s32
    s_add_u32 s68, s68, s34
    s_lshl_b32 s68, s68, 13
    s_add_u32 s68, s68, s71
    s_mov_b32 m0, 122880
    s_add_u32 s69, s68, 4096
    buffer_load_dwordx4 v12, s[40:43], s68 offen offset:0 sc1 lds
    buffer_load_dwordx4 v12, s[40:43], s68 offen offset:1024 sc1 lds
    buffer_load_dwordx4 v12, s[40:43], s68 offen offset:2048 sc1 lds
    buffer_load_dwordx4 v12, s[40:43], s68 offen offset:3072 sc1 lds
    s_mov_b32 m0, 126976
    s_nop 0
    buffer_load_dwordx4 v12, s[40:43], s69 offen offset:0 sc1 lds
    buffer_load_dwordx4 v12, s[40:43], s69 offen offset:1024 sc1 lds
    buffer_load_dwordx4 v12, s[40:43], s69 offen offset:2048 sc1 lds
    buffer_load_dwordx4 v12, s[40:43], s69 offen offset:3072 sc1 lds
    s_waitcnt vmcnt(24)
    s_barrier
    s_cmp_ge_u32 s32, 6
    s_cselect_b32 s68, -6, 8
    s_add_u32 s68, s68, s32
    s_add_u32 s68, s68, s34
    s_lshl_b32 s68, s68, 13
    s_add_u32 s68, s68, s71
    s_mov_b32 m0, 114688
    s_add_u32 s69, s68, 4096
    buffer_load_dwordx4 v12, s[40:43], s68 offen offset:0 sc1 lds
    buffer_load_dwordx4 v12, s[40:43], s68 offen offset:1024 sc1 lds
    buffer_load_dwordx4 v12, s[40:43], s68 offen offset:2048 sc1 lds
    buffer_load_dwordx4 v12, s[40:43], s68 offen offset:3072 sc1 lds
    s_mov_b32 m0, 118784
    s_nop 0
    buffer_load_dwordx4 v12, s[40:43], s69 offen offset:0 sc1 lds
    buffer_load_dwordx4 v12, s[40:43], s69 offen offset:1024 sc1 lds
    buffer_load_dwordx4 v12, s[40:43], s69 offen offset:2048 sc1 lds
    buffer_load_dwordx4 v12, s[40:43], s69 offen offset:3072 sc1 lds
    s_waitcnt vmcnt(24)
    s_barrier
    s_cmp_ge_u32 s32, 5
    s_cselect_b32 s68, -5, 9
    s_add_u32 s68, s68, s32
    s_add_u32 s68, s68, s34
    s_lshl_b32 s68, s68, 13
    s_add_u32 s68, s68, s71
    s_mov_b32 m0, 139264
    s_add_u32 s69, s68, 4096
    buffer_load_dwordx4 v12, s[40:43], s68 offen offset:0 sc1 lds
    buffer_load_dwordx4 v12, s[40:43], s68 offen offset:1024 sc1 lds
    buffer_load_dwordx4 v12, s[40:43], s68 offen offset:2048 sc1 lds
    buffer_load_dwordx4 v12, s[40:43], s68 offen offset:3072 sc1 lds
    s_mov_b32 m0, 143360
    s_nop 0
    buffer_load_dwordx4 v12, s[40:43], s69 offen offset:0 sc1 lds
    buffer_load_dwordx4 v12, s[40:43], s69 offen offset:1024 sc1 lds
    buffer_load_dwordx4 v12, s[40:43], s69 offen offset:2048 sc1 lds
    buffer_load_dwordx4 v12, s[40:43], s69 offen offset:3072 sc1 lds
    s_waitcnt vmcnt(24)
    s_barrier
    s_cmp_ge_u32 s32, 4
    s_cselect_b32 s68, -4, 10
    s_add_u32 s68, s68, s32
    s_add_u32 s68, s68, s34
    s_lshl_b32 s68, s68, 13
    s_add_u32 s68, s68, s71
    s_mov_b32 m0, 147456
    s_add_u32 s69, s68, 4096
    buffer_load_dwordx4 v12, s[40:43], s68 offen offset:0 sc1 lds
    buffer_load_dwordx4 v12, s[40:43], s68 offen offset:1024 sc1 lds
    buffer_load_dwordx4 v12, s[40:43], s68 offen offset:2048 sc1 lds
    buffer_load_dwordx4 v12, s[40:43], s68 offen offset:3072 sc1 lds
    s_mov_b32 m0, 151552
    s_nop 0
    buffer_load_dwordx4 v12, s[40:43], s69 offen offset:0 sc1 lds
    buffer_load_dwordx4 v12, s[40:43], s69 offen offset:1024 sc1 lds
    buffer_load_dwordx4 v12, s[40:43], s69 offen offset:2048 sc1 lds
    buffer_load_dwordx4 v12, s[40:43], s69 offen offset:3072 sc1 lds
    s_waitcnt vmcnt(24)
    s_barrier
    s_cmp_ge_u32 s32, 3
    s_cselect_b32 s68, -3, 11
    s_add_u32 s68, s68, s32
    s_add_u32 s68, s68, s34
    s_lshl_b32 s68, s68, 13
    s_add_u32 s68, s68, s71
    s_mov_b32 m0, 131072
    s_add_u32 s69, s68, 4096
    buffer_load_dwordx4 v12, s[40:43], s68 offen offset:0 sc1 lds
    buffer_load_dwordx4 v12, s[40:43], s68 offen offset:1024 sc1 lds
    buffer_load_dwordx4 v12, s[40:43], s68 offen offset:2048 sc1 lds
    buffer_load_dwordx4 v12, s[40:43], s68 offen offset:3072 sc1 lds
    s_mov_b32 m0, 135168
    s_nop 0
    buffer_load_dwordx4 v12, s[40:43], s69 offen offset:0 sc1 lds
    buffer_load_dwordx4 v12, s[40:43], s69 offen offset:1024 sc1 lds
    buffer_load_dwordx4 v12, s[40:43], s69 offen offset:2048 sc1 lds
    buffer_load_dwordx4 v12, s[40:43], s69 offen offset:3072 sc1 lds
    s_waitcnt vmcnt(24)
    s_barrier
    s_cmp_ge_u32 s32, 2
    s_cselect_b32 s68, -2, 12
    s_add_u32 s68, s68, s32
    s_add_u32 s68, s68, s34
    s_lshl_b32 s68, s68, 13
    s_add_u32 s68, s68, s71
    s_mov_b32 m0, 122880
    s_add_u32 s69, s68, 4096
    buffer_load_dwordx4 v12, s[40:43], s68 offen offset:0 sc1 lds
    buffer_load_dwordx4 v12, s[40:43], s68 offen offset:1024 sc1 lds
    buffer_load_dwordx4 v12, s[40:43], s68 offen offset:2048 sc1 lds
    buffer_load_dwordx4 v12, s[40:43], s68 offen offset:3072 sc1 lds
    s_mov_b32 m0, 126976
    s_nop 0
    buffer_load_dwordx4 v12, s[40:43], s69 offen offset:0 sc1 lds
    buffer_load_dwordx4 v12, s[40:43], s69 offen offset:1024 sc1 lds
    buffer_load_dwordx4 v12, s[40:43], s69 offen offset:2048 sc1 lds
    buffer_load_dwordx4 v12, s[40:43], s69 offen offset:3072 sc1 lds
    s_waitcnt vmcnt(24)
    s_barrier
    s_cmp_ge_u32 s32, 1
    s_cselect_b32 s68, -1, 13
    s_add_u32 s68, s68, s32
    s_add_u32 s68, s68, s34
    s_lshl_b32 s68, s68, 13
    s_add_u32 s68, s68, s71
    s_mov_b32 m0, 114688
    s_add_u32 s69, s68, 4096
    buffer_load_dwordx4 v12, s[40:43], s68 offen offset:0 sc1 lds
    buffer_load_dwordx4 v12, s[40:43], s68 offen offset:1024 sc1 lds
    buffer_load_dwordx4 v12, s[40:43], s68 offen offset:2048 sc1 lds
    buffer_load_dwordx4 v12, s[40:43], s68 offen offset:3072 sc1 lds
    s_mov_b32 m0, 118784
    s_nop 0
    buffer_load_dwordx4 v12, s[40:43], s69 offen offset:0 sc1 lds
    buffer_load_dwordx4 v12, s[40:43], s69 offen offset:1024 sc1 lds
    buffer_load_dwordx4 v12, s[40:43], s69 offen offset:2048 sc1 lds
    buffer_load_dwordx4 v12, s[40:43], s69 offen offset:3072 sc1 lds
    s_waitcnt vmcnt(24)
    s_barrier
    s_add_u32 s68, s33, 0
    s_add_u32 s68, s68, s35
    s_lshl_b32 s68, s68, 13
    s_add_u32 s68, s68, s71
    s_mov_b32 m0, 139264
    s_add_u32 s69, s68, 4096
    buffer_load_dwordx4 v12, s[40:43], s68 offen offset:0 sc1 lds
    buffer_load_dwordx4 v12, s[40:43], s68 offen offset:1024 sc1 lds
    buffer_load_dwordx4 v12, s[40:43], s68 offen offset:2048 sc1 lds
    buffer_load_dwordx4 v12, s[40:43], s68 offen offset:3072 sc1 lds
    s_mov_b32 m0, 143360
    s_nop 0
    buffer_load_dwordx4 v12, s[40:43], s69 offen offset:0 sc1 lds
    buffer_load_dwordx4 v12, s[40:43], s69 offen offset:1024 sc1 lds
    buffer_load_dwordx4 v12, s[40:43], s69 offen offset:2048 sc1 lds
    buffer_load_dwordx4 v12, s[40:43], s69 offen offset:3072 sc1 lds
    s_waitcnt vmcnt(24)
    s_barrier
    s_cmp_ge_u32 s33, 13
    s_cselect_b32 s68, -13, 1
    s_add_u32 s68, s68, s33
    s_add_u32 s68, s68, s35
    s_lshl_b32 s68, s68, 13
    s_add_u32 s68, s68, s71
    s_mov_b32 m0, 147456
    s_add_u32 s69, s68, 4096
    buffer_load_dwordx4 v12, s[40:43], s68 offen offset:0 sc1 lds
    buffer_load_dwordx4 v12, s[40:43], s68 offen offset:1024 sc1 lds
    buffer_load_dwordx4 v12, s[40:43], s68 offen offset:2048 sc1 lds
    buffer_load_dwordx4 v12, s[40:43], s68 offen offset:3072 sc1 lds
    s_mov_b32 m0, 151552
    s_nop 0
    buffer_load_dwordx4 v12, s[40:43], s69 offen offset:0 sc1 lds
    buffer_load_dwordx4 v12, s[40:43], s69 offen offset:1024 sc1 lds
    buffer_load_dwordx4 v12, s[40:43], s69 offen offset:2048 sc1 lds
    buffer_load_dwordx4 v12, s[40:43], s69 offen offset:3072 sc1 lds
    s_waitcnt vmcnt(24)
    s_barrier
    s_cmp_ge_u32 s33, 12
    s_cselect_b32 s68, -12, 2
    s_add_u32 s68, s68, s33
    s_add_u32 s68, s68, s35
    s_lshl_b32 s68, s68, 13
    s_add_u32 s68, s68, s71
    s_mov_b32 m0, 131072
    s_add_u32 s69, s68, 4096
    buffer_load_dwordx4 v12, s[40:43], s68 offen offset:0 sc1 lds
    buffer_load_dwordx4 v12, s[40:43], s68 offen offset:1024 sc1 lds
    buffer_load_dwordx4 v12, s[40:43], s68 offen offset:2048 sc1 lds
    buffer_load_dwordx4 v12, s[40:43], s68 offen offset:3072 sc1 lds
    s_mov_b32 m0, 135168
    s_nop 0
    buffer_load_dwordx4 v12, s[40:43], s69 offen offset:0 sc1 lds
    buffer_load_dwordx4 v12, s[40:43], s69 offen offset:1024 sc1 lds
    buffer_load_dwordx4 v12, s[40:43], s69 offen offset:2048 sc1 lds
    buffer_load_dwordx4 v12, s[40:43], s69 offen offset:3072 sc1 lds
    s_waitcnt vmcnt(24)
    s_barrier
    s_cmp_ge_u32 s33, 11
    s_cselect_b32 s68, -11, 3
    s_add_u32 s68, s68, s33
    s_add_u32 s68, s68, s35
    s_lshl_b32 s68, s68, 13
    s_add_u32 s68, s68, s71
    s_mov_b32 m0, 122880
    s_add_u32 s69, s68, 4096
    buffer_load_dwordx4 v12, s[40:43], s68 offen offset:0 sc1 lds
    buffer_load_dwordx4 v12, s[40:43], s68 offen offset:1024 sc1 lds
    buffer_load_dwordx4 v12, s[40:43], s68 offen offset:2048 sc1 lds
    buffer_load_dwordx4 v12, s[40:43], s68 offen offset:3072 sc1 lds
    s_mov_b32 m0, 126976
    s_nop 0
    buffer_load_dwordx4 v12, s[40:43], s69 offen offset:0 sc1 lds
    buffer_load_dwordx4 v12, s[40:43], s69 offen offset:1024 sc1 lds
    buffer_load_dwordx4 v12, s[40:43], s69 offen offset:2048 sc1 lds
    buffer_load_dwordx4 v12, s[40:43], s69 offen offset:3072 sc1 lds
    s_waitcnt vmcnt(24)
    s_barrier
    s_cmp_ge_u32 s33, 10
    s_cselect_b32 s68, -10, 4
    s_add_u32 s68, s68, s33
    s_add_u32 s68, s68, s35
    s_lshl_b32 s68, s68, 13
    s_add_u32 s68, s68, s71
    s_mov_b32 m0, 114688
    s_add_u32 s69, s68, 4096
    buffer_load_dwordx4 v12, s[40:43], s68 offen offset:0 sc1 lds
    buffer_load_dwordx4 v12, s[40:43], s68 offen offset:1024 sc1 lds
    buffer_load_dwordx4 v12, s[40:43], s68 offen offset:2048 sc1 lds
    buffer_load_dwordx4 v12, s[40:43], s68 offen offset:3072 sc1 lds
    s_mov_b32 m0, 118784
    s_nop 0
    buffer_load_dwordx4 v12, s[40:43], s69 offen offset:0 sc1 lds
    buffer_load_dwordx4 v12, s[40:43], s69 offen offset:1024 sc1 lds
    buffer_load_dwordx4 v12, s[40:43], s69 offen offset:2048 sc1 lds
    buffer_load_dwordx4 v12, s[40:43], s69 offen offset:3072 sc1 lds
    s_waitcnt vmcnt(24)
    s_barrier
    s_cmp_ge_u32 s33, 9
    s_cselect_b32 s68, -9, 5
    s_add_u32 s68, s68, s33
    s_add_u32 s68, s68, s35
    s_lshl_b32 s68, s68, 13
    s_add_u32 s68, s68, s71
    s_mov_b32 m0, 139264
    s_add_u32 s69, s68, 4096
    buffer_load_dwordx4 v12, s[40:43], s68 offen offset:0 sc1 lds
    buffer_load_dwordx4 v12, s[40:43], s68 offen offset:1024 sc1 lds
    buffer_load_dwordx4 v12, s[40:43], s68 offen offset:2048 sc1 lds
    buffer_load_dwordx4 v12, s[40:43], s68 offen offset:3072 sc1 lds
    s_mov_b32 m0, 143360
    s_nop 0
    buffer_load_dwordx4 v12, s[40:43], s69 offen offset:0 sc1 lds
    buffer_load_dwordx4 v12, s[40:43], s69 offen offset:1024 sc1 lds
    buffer_load_dwordx4 v12, s[40:43], s69 offen offset:2048 sc1 lds
    buffer_load_dwordx4 v12, s[40:43], s69 offen offset:3072 sc1 lds
    s_waitcnt vmcnt(24)
    s_barrier
    s_cmp_ge_u32 s33, 8
    s_cselect_b32 s68, -8, 6
    s_add_u32 s68, s68, s33
    s_add_u32 s68, s68, s35
    s_lshl_b32 s68, s68, 13
    s_add_u32 s68, s68, s71
    s_mov_b32 m0, 147456
    s_add_u32 s69, s68, 4096
    buffer_load_dwordx4 v12, s[40:43], s68 offen offset:0 sc1 lds
    buffer_load_dwordx4 v12, s[40:43], s68 offen offset:1024 sc1 lds
    buffer_load_dwordx4 v12, s[40:43], s68 offen offset:2048 sc1 lds
    buffer_load_dwordx4 v12, s[40:43], s68 offen offset:3072 sc1 lds
    s_mov_b32 m0, 151552
    s_nop 0
    buffer_load_dwordx4 v12, s[40:43], s69 offen offset:0 sc1 lds
    buffer_load_dwordx4 v12, s[40:43], s69 offen offset:1024 sc1 lds
    buffer_load_dwordx4 v12, s[40:43], s69 offen offset:2048 sc1 lds
    buffer_load_dwordx4 v12, s[40:43], s69 offen offset:3072 sc1 lds
    s_waitcnt vmcnt(24)
    s_barrier
    s_cmp_ge_u32 s33, 7
    s_cselect_b32 s68, -7, 7
    s_add_u32 s68, s68, s33
    s_add_u32 s68, s68, s35
    s_lshl_b32 s68, s68, 13
    s_add_u32 s68, s68, s71
    s_mov_b32 m0, 131072
    s_add_u32 s69, s68, 4096
    buffer_load_dwordx4 v12, s[40:43], s68 offen offset:0 sc1 lds
    buffer_load_dwordx4 v12, s[40:43], s68 offen offset:1024 sc1 lds
    buffer_load_dwordx4 v12, s[40:43], s68 offen offset:2048 sc1 lds
    buffer_load_dwordx4 v12, s[40:43], s68 offen offset:3072 sc1 lds
    s_mov_b32 m0, 135168
    s_nop 0
    buffer_load_dwordx4 v12, s[40:43], s69 offen offset:0 sc1 lds
    buffer_load_dwordx4 v12, s[40:43], s69 offen offset:1024 sc1 lds
    buffer_load_dwordx4 v12, s[40:43], s69 offen offset:2048 sc1 lds
    buffer_load_dwordx4 v12, s[40:43], s69 offen offset:3072 sc1 lds
    s_waitcnt vmcnt(24)
    s_barrier
    s_cmp_ge_u32 s33, 6
    s_cselect_b32 s68, -6, 8
    s_add_u32 s68, s68, s33
    s_add_u32 s68, s68, s35
    s_lshl_b32 s68, s68, 13
    s_add_u32 s68, s68, s71
    s_mov_b32 m0, 122880
    s_add_u32 s69, s68, 4096
    buffer_load_dwordx4 v12, s[40:43], s68 offen offset:0 sc1 lds
    buffer_load_dwordx4 v12, s[40:43], s68 offen offset:1024 sc1 lds
    buffer_load_dwordx4 v12, s[40:43], s68 offen offset:2048 sc1 lds
    buffer_load_dwordx4 v12, s[40:43], s68 offen offset:3072 sc1 lds
    s_mov_b32 m0, 126976
    s_nop 0
    buffer_load_dwordx4 v12, s[40:43], s69 offen offset:0 sc1 lds
    buffer_load_dwordx4 v12, s[40:43], s69 offen offset:1024 sc1 lds
    buffer_load_dwordx4 v12, s[40:43], s69 offen offset:2048 sc1 lds
    buffer_load_dwordx4 v12, s[40:43], s69 offen offset:3072 sc1 lds
    s_waitcnt vmcnt(24)
    s_barrier
    s_cmp_ge_u32 s33, 5
    s_cselect_b32 s68, -5, 9
    s_add_u32 s68, s68, s33
    s_add_u32 s68, s68, s35
    s_lshl_b32 s68, s68, 13
    s_add_u32 s68, s68, s71
    s_mov_b32 m0, 114688
    s_add_u32 s69, s68, 4096
    buffer_load_dwordx4 v12, s[40:43], s68 offen offset:0 sc1 lds
    buffer_load_dwordx4 v12, s[40:43], s68 offen offset:1024 sc1 lds
    buffer_load_dwordx4 v12, s[40:43], s68 offen offset:2048 sc1 lds
    buffer_load_dwordx4 v12, s[40:43], s68 offen offset:3072 sc1 lds
    s_mov_b32 m0, 118784
    s_nop 0
    buffer_load_dwordx4 v12, s[40:43], s69 offen offset:0 sc1 lds
    buffer_load_dwordx4 v12, s[40:43], s69 offen offset:1024 sc1 lds
    buffer_load_dwordx4 v12, s[40:43], s69 offen offset:2048 sc1 lds
    buffer_load_dwordx4 v12, s[40:43], s69 offen offset:3072 sc1 lds
    s_waitcnt vmcnt(24)
    s_barrier
    s_cmp_ge_u32 s33, 4
    s_cselect_b32 s68, -4, 10
    s_add_u32 s68, s68, s33
    s_add_u32 s68, s68, s35
    s_lshl_b32 s68, s68, 13
    s_add_u32 s68, s68, s71
    s_mov_b32 m0, 139264
    s_add_u32 s69, s68, 4096
    buffer_load_dwordx4 v12, s[40:43], s68 offen offset:0 sc1 lds
    buffer_load_dwordx4 v12, s[40:43], s68 offen offset:1024 sc1 lds
    buffer_load_dwordx4 v12, s[40:43], s68 offen offset:2048 sc1 lds
    buffer_load_dwordx4 v12, s[40:43], s68 offen offset:3072 sc1 lds
    s_mov_b32 m0, 143360
    s_nop 0
    buffer_load_dwordx4 v12, s[40:43], s69 offen offset:0 sc1 lds
    buffer_load_dwordx4 v12, s[40:43], s69 offen offset:1024 sc1 lds
    buffer_load_dwordx4 v12, s[40:43], s69 offen offset:2048 sc1 lds
    buffer_load_dwordx4 v12, s[40:43], s69 offen offset:3072 sc1 lds
    s_waitcnt vmcnt(24)
    s_barrier
    s_cmp_ge_u32 s33, 3
    s_cselect_b32 s68, -3, 11
    s_add_u32 s68, s68, s33
    s_add_u32 s68, s68, s35
    s_lshl_b32 s68, s68, 13
    s_add_u32 s68, s68, s71
    s_mov_b32 m0, 147456
    s_add_u32 s69, s68, 4096
    buffer_load_dwordx4 v12, s[40:43], s68 offen offset:0 sc1 lds
    buffer_load_dwordx4 v12, s[40:43], s68 offen offset:1024 sc1 lds
    buffer_load_dwordx4 v12, s[40:43], s68 offen offset:2048 sc1 lds
    buffer_load_dwordx4 v12, s[40:43], s68 offen offset:3072 sc1 lds
    s_mov_b32 m0, 151552
    s_nop 0
    buffer_load_dwordx4 v12, s[40:43], s69 offen offset:0 sc1 lds
    buffer_load_dwordx4 v12, s[40:43], s69 offen offset:1024 sc1 lds
    buffer_load_dwordx4 v12, s[40:43], s69 offen offset:2048 sc1 lds
    buffer_load_dwordx4 v12, s[40:43], s69 offen offset:3072 sc1 lds
    s_waitcnt vmcnt(24)
    s_barrier
    s_cmp_ge_u32 s33, 2
    s_cselect_b32 s68, -2, 12
    s_add_u32 s68, s68, s33
    s_add_u32 s68, s68, s35
    s_lshl_b32 s68, s68, 13
    s_add_u32 s68, s68, s71
    s_mov_b32 m0, 131072
    s_add_u32 s69, s68, 4096
    buffer_load_dwordx4 v12, s[40:43], s68 offen offset:0 sc1 lds
    buffer_load_dwordx4 v12, s[40:43], s68 offen offset:1024 sc1 lds
    buffer_load_dwordx4 v12, s[40:43], s68 offen offset:2048 sc1 lds
    buffer_load_dwordx4 v12, s[40:43], s68 offen offset:3072 sc1 lds
    s_mov_b32 m0, 135168
    s_nop 0
    buffer_load_dwordx4 v12, s[40:43], s69 offen offset:0 sc1 lds
    buffer_load_dwordx4 v12, s[40:43], s69 offen offset:1024 sc1 lds
    buffer_load_dwordx4 v12, s[40:43], s69 offen offset:2048 sc1 lds
    buffer_load_dwordx4 v12, s[40:43], s69 offen offset:3072 sc1 lds
    s_waitcnt vmcnt(24)
    s_barrier
    s_cmp_ge_u32 s33, 1
    s_cselect_b32 s68, -1, 13
    s_add_u32 s68, s68, s33
    s_add_u32 s68, s68, s35
    s_lshl_b32 s68, s68, 13
    s_add_u32 s68, s68, s71
    s_mov_b32 m0, 122880
    s_add_u32 s69, s68, 4096
    buffer_load_dwordx4 v12, s[40:43], s68 offen offset:0 sc1 lds
    buffer_load_dwordx4 v12, s[40:43], s68 offen offset:1024 sc1 lds
    buffer_load_dwordx4 v12, s[40:43], s68 offen offset:2048 sc1 lds
    buffer_load_dwordx4 v12, s[40:43], s68 offen offset:3072 sc1 lds
    s_mov_b32 m0, 126976
    s_nop 0
    buffer_load_dwordx4 v12, s[40:43], s69 offen offset:0 sc1 lds
    buffer_load_dwordx4 v12, s[40:43], s69 offen offset:1024 sc1 lds
    buffer_load_dwordx4 v12, s[40:43], s69 offen offset:2048 sc1 lds
    buffer_load_dwordx4 v12, s[40:43], s69 offen offset:3072 sc1 lds
    s_waitcnt vmcnt(24)
    s_barrier
    s_waitcnt vmcnt(16)
    s_barrier
    s_waitcnt vmcnt(8)
    s_barrier
    s_waitcnt vmcnt(0)
    s_barrier
    s_endpgm
k_end:
.section .rodata,"a"
.p2align 6
.amdhsa_kernel gated_mix__linear_attn_block__mixer_token_mlp__prompt_kernel
  .amdhsa_next_free_vgpr 256
  .amdhsa_next_free_sgpr 102
  .amdhsa_accum_offset 256
  .amdhsa_group_segment_fixed_size 0
  .amdhsa_kernarg_size 96
  .amdhsa_user_sgpr_count 2
  .amdhsa_user_sgpr_kernarg_segment_ptr 1
  .amdhsa_system_sgpr_workgroup_id_x 1
.end_amdhsa_kernel
```
